```python
import torch

def _softmax(x, axis=-1):
    return torch.softmax(x, dim=axis)

def _gelu(x):
    return torch.nn.functional.gelu(x, approximate='tanh')

def _silu(x):
    return torch.nn.functional.silu(x)

def _sigmoid(x):
    return torch.sigmoid(x)

def _layernorm(x, axis=-1, eps=1e-05):
    m = x.mean(dim=axis, keepdim=True)
    v = x.var(dim=axis, keepdim=True, unbiased=False)
    return (x - m) / torch.sqrt(v + eps)

def _scatter_add(tgt, idx, src, axis=0):
    return tgt.clone().index_add_(axis, idx, src)

def _segment_sum(src, seg, n):
    out = torch.zeros((n,) + src.shape[1:], dtype=src.dtype)
    return out.index_add_(0, seg, src)

def _pad(x, pw):
    flat = tuple((v for pair in reversed(pw) for v in pair))
    return torch.nn.functional.pad(x, flat)
kernel_name = 'adaLN_cond__ssm_conv_h3__glu_gated_reglu__prompt'

def setup_inputs():

    _w = lambda a: (lambda t: t.to(torch.bfloat16) if t.is_floating_point() else t)(torch.as_tensor(a))

    def _A_setup():
        B, S, D = (1, 2048, 640)
        ks = 4
        return {'q': _w((lambda *s: torch.randn(*s, dtype=torch.bfloat16) * 0.05)(B, S, D)), 'k': _w((lambda *s: torch.randn(*s, dtype=torch.bfloat16) * 1.6)(B, S, D)), 'v': _w((lambda *s: torch.randn(*s, dtype=torch.bfloat16) * 1.6)(B, S, D)), 'shift_k': _w((lambda *s: torch.randn(*s, dtype=torch.bfloat16) * 1.6)(D, ks) * 0.5), 'ssm_k': _w((lambda *s: torch.randn(*s, dtype=torch.bfloat16) * 1.6)(D, S) * (1.0 / S ** 0.5)), 'ssm_D': _w((lambda *s: torch.randn(*s, dtype=torch.bfloat16) * 1.6)(D))}
    _A_in = _A_setup()

    def _B_setup():
        B, S, D, F = (1, 2048, 640, 1728)
        return {'x': _w((lambda *s: torch.randn(*s, dtype=torch.bfloat16) * 0.05)(B, S, D)), 'W_gate': _w((lambda *s: torch.randn(*s, dtype=torch.bfloat16) * 3.2)(D, F) * (2.0 / D) ** 0.5), 'W_up': _w((lambda *s: torch.randn(*s, dtype=torch.bfloat16) * 3.2)(D, F) * (2.0 / D) ** 0.5), 'W_down': _w((lambda *s: torch.randn(*s, dtype=torch.bfloat16) * 3.2)(F, D) * (1.0 / F) ** 0.5)}
    _B_in = _B_setup()
    return {'A_q': _A_in['q'], 'A_k': _A_in['k'], 'A_v': _A_in['v'], 'A_shift_k': _A_in['shift_k'], 'A_ssm_k': _A_in['ssm_k'], 'A_ssm_D': _A_in['ssm_D'], 'B_x': _B_in['x'], 'B_W_gate': _B_in['W_gate'], 'B_W_up': _B_in['W_up'], 'B_W_down': _B_in['W_down'], 'c': _w((lambda *s: torch.randn(*s, dtype=torch.bfloat16) * 0.1)(1, 640) * 8.0), 'w_mod': _w((lambda *s: torch.randn(*s, dtype=torch.bfloat16) * 0.1)(640, 6 * 640) * 640 ** (-0.5) * 8.0)}

def reference(A_q, A_k, A_v, A_shift_k, A_ssm_k, A_ssm_D, B_x, B_W_gate, B_W_up, B_W_down, c, w_mod):

    def _A_ref(q, k, v, shift_k, ssm_k, ssm_D):
        B, S, D = q.shape
        ks = shift_k.shape[-1]
        k_pad = _pad(k, ((0, 0), (ks - 1, 0), (0, 0)))
        k_shift = torch.zeros_like(k)
        for t in range(ks):
            k_shift = k_shift + k_pad[:, t:t + S, :] * shift_k[:, ks - 1 - t][None, None, :]
        kv = k_shift * v
        L = 2 * S
        kv_pad = _pad(kv, ((0, 0), (0, S), (0, 0)))
        kf_pad = _pad(ssm_k, ((0, 0), (0, S)))
        kv_f = (lambda x, axes=(-2, -1): torch.fft.rfft2(x.float(), dim=axes))(kv_pad[:, None, :, :], axes=(1, 2))
        kf_f = (lambda x, axes=(-2, -1): torch.fft.rfft2(x.float(), dim=axes))(kf_pad[:, None, :], axes=(1, 2))
        kf_f = (lambda x, *d: x.permute(*d))(kf_f, 1, 2, 0)
        y_f = kv_f * kf_f[None, :, :, :]
        y = (lambda x, s, axes=(-2, -1): torch.fft.irfft2(x, s=s, dim=axes).to(torch.bfloat16))(y_f, (1, L), axes=(1, 2))[:, 0, :S, :]
        y = y + kv * ssm_D[None, None, :]
        return q * y

    def _B_ref(x, W_gate, W_up, W_down):
        gate = torch.einsum('bsd,df->bsf', x, W_gate)
        up = torch.einsum('bsd,df->bsf', x, W_up)
        gate = gate * (lambda x, dt: x.to(dt))(gate > 0, gate.dtype)
        h = gate * up
        return torch.einsum('bsf,fd->bsd', h, W_down)
    x = A_q
    mod = (_silu(c) @ w_mod).reshape(c.shape[0], 6, 1, -1)
    sa, ca, ga, sb, cb, gb = (mod[:, 0].clone(), mod[:, 1].clone(), mod[:, 2].clone(), mod[:, 3].clone(), mod[:, 4].clone(), mod[:, 5].clone())
    h = _layernorm(x, axis=-1) * (1 + ca) + sa
    x = x + ga * _A_ref(h, A_k, A_v, A_shift_k, A_ssm_k, A_ssm_D)
    h = _layernorm(x, axis=-1) * (1 + cb) + sb
    x = x + gb * _B_ref(h, B_W_gate, B_W_up, B_W_down)
    return x
```

```asm
; @launch grid=(256,1,1) block=(256,1,1) lds=163840
    .amdgcn_target "amdgcn-amd-amdhsa--gfx950"
    .text
    .globl adaLN_cond__ssm_conv_h3__glu_gated_reglu__prompt_kernel
    .p2align 8
    .type adaLN_cond__ssm_conv_h3__glu_gated_reglu__prompt_kernel,@function
adaLN_cond__ssm_conv_h3__glu_gated_reglu__prompt_kernel:
    s_cmp_ge_u32 s2, 256
    s_cbranch_scc1 end_1
    s_load_dwordx2 s[12:13], s[0:1], 112
    s_load_dwordx2 s[72:73], s[0:1], 104
    v_lshrrev_b32 v1, 6, v0
    v_and_b32 v0, 63, v0
    v_readfirstlane_b32 s3, v1
    s_mov_b32 s69, 0xffff0000
    s_cmp_lg_u32 s2, 255
    s_cbranch_scc1 notag_4
    s_cmp_lg_u32 s3, 0
    s_cbranch_scc1 notag_4
    s_memrealtime s[70:71]
    v_mov_b32 v4, 0
    s_waitcnt lgkmcnt(0)
    s_or_b32 s70, s70, 1
    v_mov_b32 v2, s70
    v_mov_b32 v3, s71
    s_mov_b64 exec, 1
    global_store_dwordx2 v4, v[2:3], s[72:73] sc1
    s_mov_b64 exec, -1
notag_4:
    s_cmp_ge_u32 s2, 160
    s_cbranch_scc1 aux_2
    s_load_dwordx4 s[4:7], s[0:1], 0
    s_load_dwordx4 s[8:11], s[0:1], 16
    s_load_dwordx4 s[36:39], s[0:1], 32
    s_load_dwordx4 s[40:43], s[0:1], 80
    s_lshr_b32 s44, s2, 4
    s_and_b32 s45, s2, 15
    v_lshrrev_b32 v4, 3, v0
    v_and_b32 v5, 7, v0
    v_mul_u32_u24 v2, 1280, v4
    v_lshl_add_u32 v2, v5, 4, v2
    s_lshl_b32 s14, s45, 4
    s_add_u32 s14, s14, s3
    s_mul_i32 s14, s14, 10240
    s_lshl_b32 s15, s44, 7
    s_add_u32 s14, s14, s15
    v_add_u32 v2, s14, v2
    v_add_u32 v3, 4294957056, v2
    s_lshl_b32 s14, s3, 3
    v_add_u32 v6, s14, v4
    s_lshl_b32 s14, s44, 9
    v_lshl_add_u32 v7, v6, 4, s14
    s_mul_i32 s28, s3, 1040
    s_mov_b32 s29, 40960
    s_mov_b32 s30, 81920
    s_mov_b32 s31, 122880
    s_waitcnt lgkmcnt(0)
    s_mov_b32 s16, s6
    s_and_b32 s17, s7, 0xffff
    s_mov_b32 s18, 2621440
    s_mov_b32 s19, 0x20000
    s_mov_b32 s20, s8
    s_and_b32 s21, s9, 0xffff
    s_mov_b32 s22, 2621440
    s_mov_b32 s23, 0x20000
    s_mov_b32 s24, s4
    s_and_b32 s25, s5, 0xffff
    s_mov_b32 s26, 2621440
    s_mov_b32 s27, 0x20000
    s_cmp_lg_u32 s3, 0
    s_cbranch_scc1 nohalo_5
    s_mov_b32 m0, 68096
    s_nop 0
    buffer_load_dwordx4 v3, s[16:19], 0 offen nt lds
nohalo_5:
    s_add_u32 m0, s28, 69136
    s_nop 0
    buffer_load_dwordx4 v2, s[16:19], 0 offen nt lds
    s_add_u32 m0, s28, 73296
    s_nop 0
    buffer_load_dwordx4 v2, s[16:19], s29 offen nt lds
    s_add_u32 m0, s28, 77456
    s_nop 0
    buffer_load_dwordx4 v2, s[16:19], s30 offen nt lds
    s_add_u32 m0, s28, 81616
    s_nop 0
    buffer_load_dwordx4 v2, s[16:19], s31 offen nt lds
    s_add_u32 m0, s28, 85776
    s_nop 0
    buffer_load_dwordx4 v2, s[20:23], 0 offen nt lds
    s_add_u32 m0, s28, 89936
    s_nop 0
    buffer_load_dwordx4 v2, s[20:23], s29 offen nt lds
    s_add_u32 m0, s28, 94096
    s_nop 0
    buffer_load_dwordx4 v2, s[20:23], s30 offen nt lds
    s_add_u32 m0, s28, 98256
    s_nop 0
    buffer_load_dwordx4 v2, s[20:23], s31 offen nt lds
    global_load_dwordx4 v[8:11], v7, s[10:11]
    s_getpc_b64 s[14:15]
    s_sub_u32 s14, s14, . - adaLN_cond__ssm_conv_h3__glu_gated_reglu__prompt_kernel
    s_subb_u32 s15, s15, 0
    s_lshr_b32 s17, s2, 3
    s_lshl_b32 s17, s17, 2
    s_add_u32 s17, s17, s3
    s_min_u32 s17, s17, (code_end - adaLN_cond__ssm_conv_h3__glu_gated_reglu__prompt_kernel) / 1024 - 1
    s_lshl_b32 s17, s17, 10
    v_lshl_add_u32 v250, v0, 4, s17
    global_load_dwordx4 v[252:255], v250, s[14:15]
    s_add_u32 m0, s28, 102416
    s_nop 0
    buffer_load_dwordx4 v2, s[24:27], 0 offen nt lds
    s_add_u32 m0, s28, 106576
    s_nop 0
    buffer_load_dwordx4 v2, s[24:27], s29 offen nt lds
    s_add_u32 m0, s28, 110736
    s_nop 0
    buffer_load_dwordx4 v2, s[24:27], s30 offen nt lds
    s_add_u32 m0, s28, 114896
    s_nop 0
    buffer_load_dwordx4 v2, s[24:27], s31 offen nt lds
    v_mul_u32_u24 v242, 1040, v5
    v_lshl_add_u32 v242, v6, 2, v242
    v_add_u32 v242, 68096, v242
    v_xor_b32 v3, 7, v5
    v_mul_u32_u24 v12, 1040, v3
    v_lshl_add_u32 v12, v6, 2, v12
    v_add_u32 v12, 68096, v12
    v_lshlrev_b32 v13, 13, v6
    v_lshl_add_u32 v14, v5, 4, v13
    v_mov_b32 v13, v14
    s_lshl_b32 s14, s44, 18
    s_lshl_b32 s15, s45, 8
    s_sub_u32 s32, s14, s15
    s_add_u32 s32, s32, 990976
    s_add_u32 s34, s14, s15
    s_add_u32 s34, s34, 3612672
    s_add_u32 s32, s12, s32
    s_addc_u32 s33, s13, 0
    s_add_u32 s34, s12, s34
    s_addc_u32 s35, s13, 0
    s_lshl_b32 s8, s2, 2
    s_add_u32 s8, s8, s3
    s_mul_i32 s9, s3, 12928
    s_add_u32 s9, s9, 16384
    s_lshl_b32 s10, s8, 12
    v_lshlrev_b32 v2, 4, v0
    v_and_b32 v4, 15, v0
    v_lshrrev_b32 v5, 4, v0
    v_mov_b32 v216, 0
    v_mov_b32 v217, 0
    v_lshl_add_u32 v6, v0, 3, s9
    ds_write_b64 v6, v[216:217]
    v_lshl_add_u32 v6, v4, 2, s9
    ds_write_b32 v6, v216 offset:8704
    ds_write_b32 v6, v216 offset:12864
    s_add_u32 s36, s36, s10
    s_addc_u32 s37, s37, 0
    s_add_u32 s11, s9, 512
    s_mov_b32 m0, s11
    s_nop 0
    global_load_lds_dwordx4 v2, s[36:37] offset:0 nt
    s_mov_b32 m0, s11
    s_nop 0
    global_load_lds_dwordx4 v2, s[36:37] offset:1024 nt
    s_mov_b32 m0, s11
    s_nop 0
    global_load_lds_dwordx4 v2, s[36:37] offset:2048 nt
    s_mov_b32 m0, s11
    s_nop 0
    global_load_lds_dwordx4 v2, s[36:37] offset:3072 nt
    s_waitcnt vmcnt(9) lgkmcnt(0)
    s_barrier
    ds_read_b32 v24, v12 offset:640
    ds_read_b32 v25, v12 offset:768
    ds_read_b32 v26, v12 offset:896
    ds_read_b32 v27, v12 offset:1040
    ds_read_b32 v28, v12 offset:1168
    ds_read_b32 v29, v12 offset:1296
    ds_read_b32 v30, v12 offset:1424
    ds_read_b32 v31, v12 offset:1552
    ds_read_b32 v32, v12 offset:1680
    ds_read_b32 v33, v12 offset:1808
    ds_read_b32 v34, v12 offset:1936
    ds_read_b32 v46, v12 offset:17680
    ds_read_b32 v47, v12 offset:17808
    ds_read_b32 v48, v12 offset:17936
    ds_read_b32 v49, v12 offset:18064
    v_mov_b32 v214, 0
    s_mov_b64 exec, 1
    global_load_dwordx2 v[212:213], v214, s[72:73] sc1
    s_mov_b64 exec, -1
    s_lshl_b32 s17, s8, 1
    v_mov_b32 v218, s17
    global_load_ushort v218, v218, s[38:39]
    v_lshlrev_b32 v16, 16, v8
    v_lshlrev_b32 v17, 16, v10
    v_and_b32 v18, s69, v8
    v_and_b32 v19, s69, v10
    v_lshlrev_b32 v20, 16, v9
    v_lshlrev_b32 v21, 16, v11
    v_and_b32 v22, s69, v9
    v_and_b32 v23, s69, v11
    s_waitcnt lgkmcnt(4)
    ds_read_b32 v50, v12 offset:18192
    ds_read_b32 v51, v12 offset:18320
    ds_read_b32 v52, v12 offset:18448
    ds_read_b32 v53, v12 offset:18576
    ds_read_b32 v35, v12 offset:8960
    ds_read_b32 v36, v12 offset:9088
    ds_read_b32 v37, v12 offset:9216
    ds_read_b32 v38, v12 offset:9360
    ds_read_b32 v39, v12 offset:9488
    ds_read_b32 v40, v12 offset:9616
    ds_read_b32 v41, v12 offset:9744
    v_lshlrev_b32 v62, 16, v24
    v_and_b32 v63, s69, v24
    v_lshlrev_b32 v64, 16, v25
    v_and_b32 v65, s69, v25
    v_lshlrev_b32 v66, 16, v26
    v_and_b32 v67, s69, v26
    v_lshlrev_b32 v68, 16, v27
    v_and_b32 v69, s69, v27
    v_lshlrev_b32 v70, 16, v28
    v_and_b32 v71, s69, v28
    v_lshlrev_b32 v72, 16, v29
    v_and_b32 v73, s69, v29
    v_lshlrev_b32 v74, 16, v30
    v_and_b32 v75, s69, v30
    v_lshlrev_b32 v76, 16, v31
    v_and_b32 v77, s69, v31
    v_lshlrev_b32 v78, 16, v32
    v_and_b32 v79, s69, v32
    v_lshlrev_b32 v80, 16, v33
    v_and_b32 v81, s69, v33
    v_lshlrev_b32 v82, 16, v34
    v_and_b32 v83, s69, v34
    v_pk_mul_f32 v[100:101], v[62:63], v[22:23]
    v_pk_mul_f32 v[102:103], v[64:65], v[22:23]
    v_pk_mul_f32 v[104:105], v[66:67], v[22:23]
    v_pk_mul_f32 v[106:107], v[68:69], v[22:23]
    v_pk_mul_f32 v[108:109], v[70:71], v[22:23]
    v_pk_mul_f32 v[110:111], v[72:73], v[22:23]
    v_pk_mul_f32 v[112:113], v[74:75], v[22:23]
    v_pk_mul_f32 v[114:115], v[76:77], v[22:23]
    v_pk_fma_f32 v[100:101], v[64:65], v[20:21], v[100:101]
    v_pk_fma_f32 v[102:103], v[66:67], v[20:21], v[102:103]
    v_pk_fma_f32 v[104:105], v[68:69], v[20:21], v[104:105]
    v_pk_fma_f32 v[106:107], v[70:71], v[20:21], v[106:107]
    v_pk_fma_f32 v[108:109], v[72:73], v[20:21], v[108:109]
    v_pk_fma_f32 v[110:111], v[74:75], v[20:21], v[110:111]
    v_pk_fma_f32 v[112:113], v[76:77], v[20:21], v[112:113]
    v_pk_fma_f32 v[114:115], v[78:79], v[20:21], v[114:115]
    v_pk_fma_f32 v[100:101], v[66:67], v[18:19], v[100:101]
    v_pk_fma_f32 v[102:103], v[68:69], v[18:19], v[102:103]
    v_pk_fma_f32 v[104:105], v[70:71], v[18:19], v[104:105]
    v_pk_fma_f32 v[106:107], v[72:73], v[18:19], v[106:107]
    v_pk_fma_f32 v[108:109], v[74:75], v[18:19], v[108:109]
    v_pk_fma_f32 v[110:111], v[76:77], v[18:19], v[110:111]
    v_pk_fma_f32 v[112:113], v[78:79], v[18:19], v[112:113]
    v_pk_fma_f32 v[114:115], v[80:81], v[18:19], v[114:115]
    v_pk_fma_f32 v[100:101], v[68:69], v[16:17], v[100:101]
    v_pk_fma_f32 v[102:103], v[70:71], v[16:17], v[102:103]
    v_pk_fma_f32 v[104:105], v[72:73], v[16:17], v[104:105]
    v_pk_fma_f32 v[106:107], v[74:75], v[16:17], v[106:107]
    v_pk_fma_f32 v[108:109], v[76:77], v[16:17], v[108:109]
    v_pk_fma_f32 v[110:111], v[78:79], v[16:17], v[110:111]
    v_pk_fma_f32 v[112:113], v[80:81], v[16:17], v[112:113]
    v_pk_fma_f32 v[114:115], v[82:83], v[16:17], v[114:115]
    s_waitcnt lgkmcnt(7)
    ds_read_b32 v42, v12 offset:9872
    ds_read_b32 v43, v12 offset:10000
    ds_read_b32 v44, v12 offset:10128
    ds_read_b32 v45, v12 offset:10256
    ds_read_b32 v54, v12 offset:26000
    ds_read_b32 v55, v12 offset:26128
    ds_read_b32 v56, v12 offset:26256
    ds_read_b32 v57, v12 offset:26384
    v_lshlrev_b32 v84, 16, v46
    v_and_b32 v85, s69, v46
    v_lshlrev_b32 v86, 16, v47
    v_and_b32 v87, s69, v47
    v_lshlrev_b32 v88, 16, v48
    v_and_b32 v89, s69, v48
    v_lshlrev_b32 v90, 16, v49
    v_and_b32 v91, s69, v49
    v_lshlrev_b32 v92, 16, v50
    v_and_b32 v93, s69, v50
    v_lshlrev_b32 v94, 16, v51
    v_and_b32 v95, s69, v51
    v_lshlrev_b32 v96, 16, v52
    v_and_b32 v97, s69, v52
    v_lshlrev_b32 v98, 16, v53
    v_and_b32 v99, s69, v53
    v_pk_mul_f32 v[100:101], v[100:101], v[84:85]
    v_pk_mul_f32 v[102:103], v[102:103], v[86:87]
    v_pk_mul_f32 v[104:105], v[104:105], v[88:89]
    v_pk_mul_f32 v[106:107], v[106:107], v[90:91]
    v_pk_mul_f32 v[108:109], v[108:109], v[92:93]
    v_pk_mul_f32 v[110:111], v[110:111], v[94:95]
    v_pk_mul_f32 v[112:113], v[112:113], v[96:97]
    v_pk_mul_f32 v[114:115], v[114:115], v[98:99]
    v_cvt_pk_bf16_f32 v116, v114, v112
    v_cvt_pk_bf16_f32 v117, v110, v108
    v_cvt_pk_bf16_f32 v118, v106, v104
    v_cvt_pk_bf16_f32 v119, v102, v100
    global_store_dwordx4 v13, v[116:119], s[32:33] offset:-3968 sc1
    v_cvt_pk_bf16_f32 v120, v115, v113
    v_cvt_pk_bf16_f32 v121, v111, v109
    v_cvt_pk_bf16_f32 v122, v107, v105
    v_cvt_pk_bf16_f32 v123, v103, v101
    global_store_dwordx4 v13, v[120:123], s[32:33] offset:128 sc1
    s_waitcnt lgkmcnt(4)
    ds_read_b32 v58, v12 offset:26512
    ds_read_b32 v59, v12 offset:26640
    ds_read_b32 v60, v12 offset:26768
    ds_read_b32 v61, v12 offset:26896
    v_lshlrev_b32 v62, 16, v35
    v_and_b32 v63, s69, v35
    v_lshlrev_b32 v64, 16, v36
    v_and_b32 v65, s69, v36
    v_lshlrev_b32 v66, 16, v37
    v_and_b32 v67, s69, v37
    v_lshlrev_b32 v68, 16, v38
    v_and_b32 v69, s69, v38
    v_lshlrev_b32 v70, 16, v39
    v_and_b32 v71, s69, v39
    v_lshlrev_b32 v72, 16, v40
    v_and_b32 v73, s69, v40
    v_lshlrev_b32 v74, 16, v41
    v_and_b32 v75, s69, v41
    v_lshlrev_b32 v76, 16, v42
    v_and_b32 v77, s69, v42
    v_lshlrev_b32 v78, 16, v43
    v_and_b32 v79, s69, v43
    v_lshlrev_b32 v80, 16, v44
    v_and_b32 v81, s69, v44
    v_lshlrev_b32 v82, 16, v45
    v_and_b32 v83, s69, v45
    v_pk_mul_f32 v[100:101], v[62:63], v[22:23]
    v_pk_mul_f32 v[102:103], v[64:65], v[22:23]
    v_pk_mul_f32 v[104:105], v[66:67], v[22:23]
    v_pk_mul_f32 v[106:107], v[68:69], v[22:23]
    v_pk_mul_f32 v[108:109], v[70:71], v[22:23]
    v_pk_mul_f32 v[110:111], v[72:73], v[22:23]
    v_pk_mul_f32 v[112:113], v[74:75], v[22:23]
    v_pk_mul_f32 v[114:115], v[76:77], v[22:23]
    v_pk_fma_f32 v[100:101], v[64:65], v[20:21], v[100:101]
    v_pk_fma_f32 v[102:103], v[66:67], v[20:21], v[102:103]
    v_pk_fma_f32 v[104:105], v[68:69], v[20:21], v[104:105]
    v_pk_fma_f32 v[106:107], v[70:71], v[20:21], v[106:107]
    v_pk_fma_f32 v[108:109], v[72:73], v[20:21], v[108:109]
    v_pk_fma_f32 v[110:111], v[74:75], v[20:21], v[110:111]
    v_pk_fma_f32 v[112:113], v[76:77], v[20:21], v[112:113]
    v_pk_fma_f32 v[114:115], v[78:79], v[20:21], v[114:115]
    v_pk_fma_f32 v[100:101], v[66:67], v[18:19], v[100:101]
    v_pk_fma_f32 v[102:103], v[68:69], v[18:19], v[102:103]
    v_pk_fma_f32 v[104:105], v[70:71], v[18:19], v[104:105]
    v_pk_fma_f32 v[106:107], v[72:73], v[18:19], v[106:107]
    v_pk_fma_f32 v[108:109], v[74:75], v[18:19], v[108:109]
    v_pk_fma_f32 v[110:111], v[76:77], v[18:19], v[110:111]
    v_pk_fma_f32 v[112:113], v[78:79], v[18:19], v[112:113]
    v_pk_fma_f32 v[114:115], v[80:81], v[18:19], v[114:115]
    v_pk_fma_f32 v[100:101], v[68:69], v[16:17], v[100:101]
    v_pk_fma_f32 v[102:103], v[70:71], v[16:17], v[102:103]
    v_pk_fma_f32 v[104:105], v[72:73], v[16:17], v[104:105]
    v_pk_fma_f32 v[106:107], v[74:75], v[16:17], v[106:107]
    v_pk_fma_f32 v[108:109], v[76:77], v[16:17], v[108:109]
    v_pk_fma_f32 v[110:111], v[78:79], v[16:17], v[110:111]
    v_pk_fma_f32 v[112:113], v[80:81], v[16:17], v[112:113]
    v_pk_fma_f32 v[114:115], v[82:83], v[16:17], v[114:115]
    s_waitcnt lgkmcnt(0)
    v_lshlrev_b32 v84, 16, v54
    v_and_b32 v85, s69, v54
    v_lshlrev_b32 v86, 16, v55
    v_and_b32 v87, s69, v55
    v_lshlrev_b32 v88, 16, v56
    v_and_b32 v89, s69, v56
    v_lshlrev_b32 v90, 16, v57
    v_and_b32 v91, s69, v57
    v_lshlrev_b32 v92, 16, v58
    v_and_b32 v93, s69, v58
    v_lshlrev_b32 v94, 16, v59
    v_and_b32 v95, s69, v59
    v_lshlrev_b32 v96, 16, v60
    v_and_b32 v97, s69, v60
    v_lshlrev_b32 v98, 16, v61
    v_and_b32 v99, s69, v61
    v_pk_mul_f32 v[100:101], v[100:101], v[84:85]
    v_pk_mul_f32 v[102:103], v[102:103], v[86:87]
    v_pk_mul_f32 v[104:105], v[104:105], v[88:89]
    v_pk_mul_f32 v[106:107], v[106:107], v[90:91]
    v_pk_mul_f32 v[108:109], v[108:109], v[92:93]
    v_pk_mul_f32 v[110:111], v[110:111], v[94:95]
    v_pk_mul_f32 v[112:113], v[112:113], v[96:97]
    v_pk_mul_f32 v[114:115], v[114:115], v[98:99]
    v_cvt_pk_bf16_f32 v124, v114, v112
    v_cvt_pk_bf16_f32 v125, v110, v108
    v_cvt_pk_bf16_f32 v126, v106, v104
    v_cvt_pk_bf16_f32 v127, v102, v100
    global_store_dwordx4 v13, v[124:127], s[32:33] offset:-4096 sc1
    v_cvt_pk_bf16_f32 v128, v115, v113
    v_cvt_pk_bf16_f32 v129, v111, v109
    v_cvt_pk_bf16_f32 v130, v107, v105
    v_cvt_pk_bf16_f32 v131, v103, v101
    global_store_dwordx4 v13, v[128:131], s[32:33] offset:0 sc1
    v_and_b32 v6, 1, v4
    v_xor_b32 v6, 1, v6
    v_mul_u32_u24 v6, 4158, v6
    v_lshl_add_u32 v6, v5, 4, v6
    v_lshlrev_b32 v7, 1, v4
    v_sub_u32 v6, v6, v7
    v_add_u32 v6, s9, v6
    v_add_u32 v220, 7710, v6
    v_add_u32 v221, 6686, v6
    v_add_u32 v222, 5662, v6
    v_add_u32 v223, 4638, v6
    v_lshlrev_b32 v6, 5, v4
    v_lshl_add_u32 v15, v5, 3, v6
    v_lshl_add_u32 v6, v5, 4, v6
    v_add_u32 v6, s9, v6
    v_add_u32 v224, 32, v6
    v_add_u32 v3, s9, v2
    s_waitcnt vmcnt(4)
    v_readfirstlane_b32 s70, v212
    v_readfirstlane_b32 s71, v213
    s_cmp_lg_u64 s[70:71], 0
    s_cbranch_scc1 tagok_6
    s_mov_b32 s74, 0x100000
    v_mov_b32 v214, 0
tag_7:
    s_mov_b64 exec, 1
    global_load_dwordx2 v[212:213], v214, s[72:73] sc1
    s_mov_b64 exec, -1
    s_waitcnt vmcnt(0)
    v_readfirstlane_b32 s70, v212
    v_readfirstlane_b32 s71, v213
    s_sub_u32 s74, s74, 1
    s_cbranch_scc1 tagd_8
    s_cmp_eq_u64 s[70:71], 0
    s_cbranch_scc1 tag_7
tagd_8:
tagok_6:
    s_waitcnt vmcnt(0)
    s_barrier
    s_cmp_lg_u32 s3, 0
    s_cbranch_scc1 pubr_9
    s_lshl_b32 s74, s2, 10
    s_add_u32 s74, s74, 196608
    v_lshl_add_u32 v236, v0, 4, s74
    v_mov_b32 v232, s70
    v_mov_b32 v233, s71
    v_mov_b32 v234, s70
    v_mov_b32 v235, s71
    global_store_dwordx4 v236, v[232:235], s[12:13] sc1
    s_nop 1
pubr_9:
    ds_read_b32 v24, v242 offset:34320
    ds_read_b32 v25, v242 offset:34448
    ds_read_b32 v26, v242 offset:34576
    ds_read_b32 v27, v242 offset:34704
    ds_read_b32 v28, v242 offset:34832
    ds_read_b32 v29, v242 offset:34960
    ds_read_b32 v30, v242 offset:35088
    ds_read_b32 v31, v242 offset:35216
    s_waitcnt lgkmcnt(6)
    ds_read_b32 v32, v242 offset:42640
    ds_read_b32 v33, v242 offset:42768
    ds_read_b32 v34, v242 offset:42896
    ds_read_b32 v35, v242 offset:43024
    ds_read_b32 v36, v242 offset:43152
    ds_read_b32 v37, v242 offset:43280
    ds_read_b32 v38, v242 offset:43408
    ds_read_b32 v39, v242 offset:43536
    s_mov_b32 s14, 0x05040100
    s_mov_b32 s15, 0x07060302
    s_waitcnt lgkmcnt(8)
    v_perm_b32 v40, v25, v24, s14
    v_perm_b32 v41, v27, v26, s14
    v_perm_b32 v42, v29, v28, s14
    v_perm_b32 v43, v31, v30, s14
    global_store_dwordx4 v14, v[40:43], s[34:35] offset:-4096 sc1
    v_perm_b32 v44, v25, v24, s15
    v_perm_b32 v45, v27, v26, s15
    v_perm_b32 v46, v29, v28, s15
    v_perm_b32 v47, v31, v30, s15
    global_store_dwordx4 v14, v[44:47], s[34:35] offset:0 sc1
    s_waitcnt lgkmcnt(0)
    v_perm_b32 v48, v33, v32, s14
    v_perm_b32 v49, v35, v34, s14
    v_perm_b32 v50, v37, v36, s14
    v_perm_b32 v51, v39, v38, s14
    global_store_dwordx4 v14, v[48:51], s[34:35] offset:-3968 sc1
    v_perm_b32 v52, v33, v32, s15
    v_perm_b32 v53, v35, v34, s15
    v_perm_b32 v54, v37, v36, s15
    v_perm_b32 v55, v39, v38, s15
    global_store_dwordx4 v14, v[52:55], s[34:35] offset:128 sc1
    s_add_u32 s10, s10, 983040
    s_add_u32 s11, s9, 4608
    s_add_u32 s16, s12, s10
    s_addc_u32 s17, s13, 0
    v_lshlrev_b32 v218, 16, v218
    v_sub_u32 v11, s9, v15
    v_add_u32 v11, 5112, v11
    v_min_u32 v208, 4, v0
    v_mul_u32_u24 v208, 2560, v208
    v_lshrrev_b32 v209, 3, v0
    v_xor_b32 v209, v209, v0
    v_lshlrev_b32 v209, 4, v209
    v_and_b32 v12, 7, v4
    v_xor_b32 v12, v12, v5
    v_lshlrev_b32 v12, 4, v12
    v_lshl_add_u32 v12, v4, 7, v12
    v_xor_b32 v243, 64, v12
    v_lshlrev_b32 v10, 5, v4
    v_lshrrev_b32 v13, 1, v5
    v_lshl_add_u32 v10, v13, 4, v10
    v_and_b32 v13, 1, v5
    v_lshl_add_u32 v10, v13, 9, v10
    s_and_b32 s14, s2, 0xf0
    v_add_u32 v210, s14, v0
    v_add_u32 v211, 194, v0
    v_cmp_gt_u32 s[18:19], 16, v0
    v_mov_b32 v212, s70
    v_mov_b32 v213, s71
    v_cndmask_b32 v210, v211, v210, s[18:19]
    v_mul_u32_u24 v211, 10, v0
    v_cmp_gt_u32 s[18:19], 48, v0
    s_sub_u32 s14, s44, 320
    v_add_u32 v211, s14, v211
    v_cndmask_b32 v210, v211, v210, s[18:19]
    v_lshlrev_b32 v210, 7, v210
    v_add_u32 v210, 32768, v210
    s_lshl_b32 s14, s3, 4
    s_lshl_b64 s[28:29], 0xffff, s14
    s_and_b32 s29, s29, 0x1fffff
    s_and_b32 s74, s2, 63
    s_lshl_b32 s74, s74, 7
    s_add_u32 s74, s74, 163840
    v_mov_b32 v240, s74
    v_mov_b32 v236, s70
    v_mov_b32 v237, s71
    s_load_dwordx4 s[84:87], s[0:1], 56
    s_lshr_b32 s6, s2, 3
    s_and_b32 s5, s2, 3
    s_mul_i32 s5, s5, 27
    s_add_u32 s5, s5, s6
    s_lshr_b32 s6, s5, 2
    s_and_b32 s5, s5, 3
    s_and_b32 s89, s2, 4
    s_add_u32 s5, s5, s89
    v_lshrrev_b32 v244, 3, v0
    v_bfe_u32 v245, v0, 4, 2
    v_lshlrev_b32 v245, 1, v245
    v_and_b32 v246, 7, v0
    v_xor_b32 v245, v245, v246
    v_mul_u32_u24 v244, 3456, v244
    v_lshl_add_u32 v7, v245, 4, v244
    s_mul_i32 s88, s3, 27648
    s_lshl_b32 s89, s6, 7
    s_add_u32 s88, s88, s89
    v_add_u32 v7, s88, v7
    s_lshl_b32 s88, s3, 10
    s_add_u32 s88, s88, 69632
    s_waitcnt lgkmcnt(0)
    s_mov_b32 s80, s84
    s_and_b32 s81, s85, 0xffff
    s_mov_b32 s82, 2211840
    s_mov_b32 s83, 0x20000
    s_mov_b32 s84, s86
    s_and_b32 s85, s87, 0xffff
    s_mov_b32 s86, 2211840
    s_mov_b32 s87, 0x20000
    s_and_b32 s14, s2, 0xf0
    v_add_u32 v234, s14, v0
    s_and_b32 s74, s2, 7
    s_lshl_b32 s74, s74, 7
    s_add_u32 s74, s74, 196608
    v_lshl_add_u32 v234, v234, 10, s74
    s_mov_b32 s74, 0x100000
    s_mov_b64 exec, 0xffff
poll_10:
    global_load_dwordx2 v[232:233], v234, s[12:13] sc1
    s_waitcnt vmcnt(0)
    v_cmp_ne_u64 vcc, s[70:71], v[232:233]
    s_and_b64 exec, exec, vcc
    s_cbranch_execz polld_11
    s_sleep 1
    s_sub_u32 s74, s74, 1
    s_cbranch_scc0 poll_10
polld_11:
    s_mov_b64 exec, -1
    global_load_dwordx4 v[176:179], v2, s[16:17] offset:0 sc1
    global_load_dwordx4 v[182:185], v2, s[16:17] offset:1024 sc1
    global_load_dwordx4 v[188:191], v2, s[16:17] offset:2048 sc1
    global_load_dwordx4 v[194:197], v2, s[16:17] offset:3072 sc1
    s_waitcnt vmcnt(4)
    s_barrier
    s_cmp_lg_u32 s3, 0
    s_cbranch_scc1 pub_12
    s_lshl_b32 s74, s2, 7
    s_add_u32 s74, s74, 32768
    v_lshl_add_u32 v234, v0, 3, s74
    v_mov_b32 v232, s70
    v_mov_b32 v233, s71
    s_mov_b64 exec, 0xffff
    global_store_dwordx2 v234, v[232:233], s[12:13] sc1
    s_mov_b64 exec, -1
pub_12:
    ds_read_b128 a[64:67], v224 offset:448
    ds_read_b128 a[68:71], v224 offset:960
    ds_read_b128 a[72:75], v224 offset:1472
    ds_read_b128 a[76:79], v224 offset:1984
    ds_read_b128 a[80:83], v224 offset:2496
    ds_read_b128 a[84:87], v224 offset:3008
    ds_read_b128 a[88:91], v224 offset:3520
    ds_read_b128 a[92:95], v224 offset:4032
    s_waitcnt vmcnt(2)
    ds_write_b128 v3, v[176:179] offset:4608
    v_readlane_b32 s14, v182, 0
    v_mov_b32_dpp v180, v176 wave_shl:1 row_mask:0xf bank_mask:0xf bound_ctrl:0
    s_nop 0
    v_writelane_b32 v180, s14, 63
    v_alignbit_b32 v200, v177, v176, 16
    v_alignbit_b32 v201, v178, v177, 16
    v_alignbit_b32 v202, v179, v178, 16
    v_alignbit_b32 v203, v180, v179, 16
    ds_write_b128 v3, v[200:203] offset:8768
    s_waitcnt vmcnt(1)
    ds_write_b128 v3, v[182:185] offset:5632
    v_readlane_b32 s14, v188, 0
    v_mov_b32_dpp v186, v182 wave_shl:1 row_mask:0xf bank_mask:0xf bound_ctrl:0
    s_nop 0
    v_writelane_b32 v186, s14, 63
    v_alignbit_b32 v204, v183, v182, 16
    v_alignbit_b32 v205, v184, v183, 16
    v_alignbit_b32 v206, v185, v184, 16
    v_alignbit_b32 v207, v186, v185, 16
    ds_write_b128 v3, v[204:207] offset:9792
    s_waitcnt lgkmcnt(2)
    s_waitcnt vmcnt(0)
    ds_write_b128 v3, v[188:191] offset:6656
    v_readlane_b32 s14, v194, 0
    v_mov_b32_dpp v192, v188 wave_shl:1 row_mask:0xf bank_mask:0xf bound_ctrl:0
    s_nop 0
    v_writelane_b32 v192, s14, 63
    v_alignbit_b32 v200, v189, v188, 16
    v_alignbit_b32 v201, v190, v189, 16
    v_alignbit_b32 v202, v191, v190, 16
    v_alignbit_b32 v203, v192, v191, 16
    ds_write_b128 v3, v[200:203] offset:10816
    s_waitcnt vmcnt(0)
    ds_write_b128 v3, v[194:197] offset:7680
    v_mov_b32_dpp v198, v194 wave_shl:1 row_mask:0xf bank_mask:0xf bound_ctrl:0
    v_alignbit_b32 v204, v195, v194, 16
    v_alignbit_b32 v205, v196, v195, 16
    v_alignbit_b32 v206, v197, v196, 16
    v_alignbit_b32 v207, v198, v197, 16
    ds_write_b128 v3, v[204:207] offset:11840
    s_waitcnt lgkmcnt(0)
    ds_read2_b32 a[0:1], v220 offset0:240 offset1:241
    ds_read2_b32 a[2:3], v220 offset0:242 offset1:243
    ds_read2_b32 a[4:5], v220 offset0:112 offset1:113
    ds_read2_b32 a[6:7], v220 offset0:114 offset1:115
    ds_read2_b32 a[8:9], v221 offset0:240 offset1:241
    ds_read2_b32 a[10:11], v221 offset0:242 offset1:243
    ds_read2_b32 a[12:13], v221 offset0:112 offset1:113
    ds_read2_b32 a[14:15], v221 offset0:114 offset1:115
    ds_read2_b32 a[16:17], v222 offset0:240 offset1:241
    ds_read2_b32 a[18:19], v222 offset0:242 offset1:243
    ds_read2_b32 a[20:21], v222 offset0:112 offset1:113
    ds_read2_b32 a[22:23], v222 offset0:114 offset1:115
    ds_read2_b32 a[24:25], v223 offset0:240 offset1:241
    ds_read2_b32 a[26:27], v223 offset0:242 offset1:243
    ds_read2_b32 a[28:29], v223 offset0:112 offset1:113
    ds_read2_b32 a[30:31], v223 offset0:114 offset1:115
    s_waitcnt lgkmcnt(0)
    v_mfma_f32_16x16x32_bf16 v[16:19], a[0:3], a[64:67], 0
    ds_read_b128 a[96:99], v224 offset:384
    s_add_u32 m0, s88, 0
    s_mov_b32 s89, 0
    v_mfma_f32_16x16x32_bf16 v[20:23], a[0:3], a[68:71], 0
    buffer_load_dwordx4 v7, s[80:83], s89 offen lds
    v_mfma_f32_16x16x32_bf16 v[24:27], a[0:3], a[72:75], 0
    ds_read2_b32 a[32:33], v220 offset0:224 offset1:225
    v_mfma_f32_16x16x32_bf16 v[28:31], a[0:3], a[76:79], 0
    ds_read2_b32 a[34:35], v220 offset0:226 offset1:227
    v_mfma_f32_16x16x32_bf16 v[32:35], a[0:3], a[80:83], 0
    ds_read_b128 a[100:103], v224 offset:896
    v_mfma_f32_16x16x32_bf16 v[36:39], a[0:3], a[84:87], 0
    ds_read2_b32 a[36:37], v220 offset0:96 offset1:97
    v_mfma_f32_16x16x32_bf16 v[40:43], a[0:3], a[88:91], 0
    ds_read2_b32 a[38:39], v220 offset0:98 offset1:99
    v_mfma_f32_16x16x32_bf16 v[44:47], a[0:3], a[92:95], 0
    ds_read_b128 a[104:107], v224 offset:1408
    v_mfma_f32_16x16x32_bf16 v[20:23], a[4:7], a[64:67], v[20:23]
    ds_read2_b32 a[40:41], v221 offset0:224 offset1:225
    s_add_u32 m0, s88, 4096
    v_mfma_f32_16x16x32_bf16 v[24:27], a[4:7], a[68:71], v[24:27]
    buffer_load_dwordx4 v7, s[84:87], s89 offen lds
    v_mfma_f32_16x16x32_bf16 v[28:31], a[4:7], a[72:75], v[28:31]
    ds_read2_b32 a[42:43], v221 offset0:226 offset1:227
    v_mfma_f32_16x16x32_bf16 v[32:35], a[4:7], a[76:79], v[32:35]
    ds_read_b128 a[108:111], v224 offset:1920
    v_mfma_f32_16x16x32_bf16 v[36:39], a[4:7], a[80:83], v[36:39]
    ds_read2_b32 a[44:45], v221 offset0:96 offset1:97
    v_mfma_f32_16x16x32_bf16 v[40:43], a[4:7], a[84:87], v[40:43]
    ds_read2_b32 a[46:47], v221 offset0:98 offset1:99
    v_mfma_f32_16x16x32_bf16 v[44:47], a[4:7], a[88:91], v[44:47]
    ds_read_b128 a[112:115], v224 offset:2432
    v_mfma_f32_16x16x32_bf16 v[24:27], a[8:11], a[64:67], v[24:27]
    ds_read2_b32 a[48:49], v222 offset0:224 offset1:225
    v_mfma_f32_16x16x32_bf16 v[28:31], a[8:11], a[68:71], v[28:31]
    ds_read2_b32 a[50:51], v222 offset0:226 offset1:227
    v_mfma_f32_16x16x32_bf16 v[32:35], a[8:11], a[72:75], v[32:35]
    ds_read_b128 a[116:119], v224 offset:2944
    s_add_u32 m0, s88, 8192
    s_mov_b32 s89, 110592
    v_mfma_f32_16x16x32_bf16 v[36:39], a[8:11], a[76:79], v[36:39]
    buffer_load_dwordx4 v7, s[80:83], s89 offen lds
    v_mfma_f32_16x16x32_bf16 v[40:43], a[8:11], a[80:83], v[40:43]
    ds_read2_b32 a[52:53], v222 offset0:96 offset1:97
    v_mfma_f32_16x16x32_bf16 v[44:47], a[8:11], a[84:87], v[44:47]
    ds_read2_b32 a[54:55], v222 offset0:98 offset1:99
    v_mfma_f32_16x16x32_bf16 v[28:31], a[12:15], a[64:67], v[28:31]
    ds_read_b128 a[120:123], v224 offset:3456
    v_mfma_f32_16x16x32_bf16 v[32:35], a[12:15], a[68:71], v[32:35]
    ds_read2_b32 a[56:57], v223 offset0:224 offset1:225
    v_mfma_f32_16x16x32_bf16 v[36:39], a[12:15], a[72:75], v[36:39]
    ds_read2_b32 a[58:59], v223 offset0:226 offset1:227
    v_mfma_f32_16x16x32_bf16 v[40:43], a[12:15], a[76:79], v[40:43]
    ds_read_b128 a[124:127], v224 offset:3968
    v_mfma_f32_16x16x32_bf16 v[44:47], a[12:15], a[80:83], v[44:47]
    ds_read2_b32 a[60:61], v223 offset0:96 offset1:97
    v_mfma_f32_16x16x32_bf16 v[32:35], a[16:19], a[64:67], v[32:35]
    ds_read2_b32 a[62:63], v223 offset0:98 offset1:99
    s_add_u32 m0, s88, 12288
    v_mfma_f32_16x16x32_bf16 v[36:39], a[16:19], a[68:71], v[36:39]
    buffer_load_dwordx4 v7, s[84:87], s89 offen lds
    v_mfma_f32_16x16x32_bf16 v[40:43], a[16:19], a[72:75], v[40:43]
    ds_read_b64 v[192:193], v11 offset:3584
    v_mfma_f32_16x16x32_bf16 v[44:47], a[16:19], a[76:79], v[44:47]
    ds_read_b64 v[194:195], v11 offset:3072
    v_mfma_f32_16x16x32_bf16 v[36:39], a[20:23], a[64:67], v[36:39]
    ds_read_b64 v[196:197], v11 offset:2560
    v_mfma_f32_16x16x32_bf16 v[40:43], a[20:23], a[68:71], v[40:43]
    ds_read_b64 v[198:199], v11 offset:2048
    v_mfma_f32_16x16x32_bf16 v[44:47], a[20:23], a[72:75], v[44:47]
    ds_read_b64 v[200:201], v11 offset:1536
    v_mfma_f32_16x16x32_bf16 v[40:43], a[24:27], a[64:67], v[40:43]
    ds_read_b64 v[202:203], v11 offset:1024
    v_mfma_f32_16x16x32_bf16 v[44:47], a[24:27], a[68:71], v[44:47]
    ds_read_b64 v[204:205], v11 offset:512
    v_mfma_f32_16x16x32_bf16 v[44:47], a[28:31], a[64:67], v[44:47]
    ds_read_b64 v[206:207], v11 offset:0
    s_waitcnt lgkmcnt(0)
    v_mfma_f32_16x16x32_bf16 v[16:19], a[32:35], a[96:99], v[16:19]
    ds_read_b128 a[64:67], v224 offset:320
    s_add_u32 m0, s88, 16384
    s_mov_b32 s89, 221184
    v_and_b32 v48, s69, v193
    v_mfma_f32_16x16x32_bf16 v[20:23], a[32:35], a[100:103], v[20:23]
    buffer_load_dwordx4 v7, s[80:83], s89 offen lds
    v_mfma_f32_16x16x32_bf16 v[24:27], a[32:35], a[104:107], v[24:27]
    ds_read2_b32 a[0:1], v220 offset0:208 offset1:209
    v_lshlrev_b32 v49, 16, v193
    v_mfma_f32_16x16x32_bf16 v[28:31], a[32:35], a[108:111], v[28:31]
    ds_read2_b32 a[2:3], v220 offset0:210 offset1:211
    v_mfma_f32_16x16x32_bf16 v[32:35], a[32:35], a[112:115], v[32:35]
    ds_read_b128 a[68:71], v224 offset:832
    v_and_b32 v50, s69, v192
    v_mfma_f32_16x16x32_bf16 v[36:39], a[32:35], a[116:119], v[36:39]
    ds_read2_b32 a[4:5], v220 offset0:80 offset1:81
    s_add_u32 m0, s88, 20480
    v_lshlrev_b32 v51, 16, v192
    v_mfma_f32_16x16x32_bf16 v[40:43], a[32:35], a[120:123], v[40:43]
    buffer_load_dwordx4 v7, s[84:87], s89 offen lds
    v_mfma_f32_16x16x32_bf16 v[44:47], a[32:35], a[124:127], v[44:47]
    ds_read2_b32 a[6:7], v220 offset0:82 offset1:83
    v_mfma_f32_16x16x32_bf16 v[20:23], a[36:39], a[96:99], v[20:23]
    ds_read_b128 a[72:75], v224 offset:1344
    v_and_b32 v52, s69, v195
    v_mfma_f32_16x16x32_bf16 v[24:27], a[36:39], a[100:103], v[24:27]
    ds_read2_b32 a[8:9], v221 offset0:208 offset1:209
    v_lshlrev_b32 v53, 16, v195
    v_mfma_f32_16x16x32_bf16 v[28:31], a[36:39], a[104:107], v[28:31]
    ds_read2_b32 a[10:11], v221 offset0:210 offset1:211
    v_mfma_f32_16x16x32_bf16 v[32:35], a[36:39], a[108:111], v[32:35]
    ds_read_b128 a[76:79], v224 offset:1856
    s_add_u32 m0, s88, 24576
    s_mov_b32 s89, 331776
    v_and_b32 v54, s69, v194
    v_mfma_f32_16x16x32_bf16 v[36:39], a[36:39], a[112:115], v[36:39]
    buffer_load_dwordx4 v7, s[80:83], s89 offen lds
    v_mfma_f32_16x16x32_bf16 v[40:43], a[36:39], a[116:119], v[40:43]
    ds_read2_b32 a[12:13], v221 offset0:80 offset1:81
    v_lshlrev_b32 v55, 16, v194
    v_mfma_f32_16x16x32_bf16 v[44:47], a[36:39], a[120:123], v[44:47]
    ds_read2_b32 a[14:15], v221 offset0:82 offset1:83
    v_mfma_f32_16x16x32_bf16 v[24:27], a[40:43], a[96:99], v[24:27]
    ds_read_b128 a[80:83], v224 offset:2368
    v_and_b32 v56, s69, v197
    v_mfma_f32_16x16x32_bf16 v[28:31], a[40:43], a[100:103], v[28:31]
    ds_read2_b32 a[16:17], v222 offset0:208 offset1:209
    v_lshlrev_b32 v57, 16, v197
    v_mfma_f32_16x16x32_bf16 v[32:35], a[40:43], a[104:107], v[32:35]
    ds_read2_b32 a[18:19], v222 offset0:210 offset1:211
    s_add_u32 m0, s88, 28672
    v_mfma_f32_16x16x32_bf16 v[36:39], a[40:43], a[108:111], v[36:39]
    buffer_load_dwordx4 v7, s[84:87], s89 offen lds
    v_mfma_f32_16x16x32_bf16 v[40:43], a[40:43], a[112:115], v[40:43]
    ds_read_b128 a[84:87], v224 offset:2880
    v_and_b32 v58, s69, v196
    v_mfma_f32_16x16x32_bf16 v[44:47], a[40:43], a[116:119], v[44:47]
    ds_read2_b32 a[20:21], v222 offset0:80 offset1:81
    v_lshlrev_b32 v59, 16, v196
    v_mfma_f32_16x16x32_bf16 v[28:31], a[44:47], a[96:99], v[28:31]
    ds_read2_b32 a[22:23], v222 offset0:82 offset1:83
    v_mfma_f32_16x16x32_bf16 v[32:35], a[44:47], a[100:103], v[32:35]
    ds_read_b128 a[88:91], v224 offset:3392
    v_and_b32 v60, s69, v199
    v_mfma_f32_16x16x32_bf16 v[36:39], a[44:47], a[104:107], v[36:39]
    ds_read2_b32 a[24:25], v223 offset0:208 offset1:209
    s_add_u32 m0, s88, 32768
    s_mov_b32 s89, 442368
    v_lshlrev_b32 v61, 16, v199
    v_mfma_f32_16x16x32_bf16 v[40:43], a[44:47], a[108:111], v[40:43]
    buffer_load_dwordx4 v7, s[80:83], s89 offen lds
    v_mfma_f32_16x16x32_bf16 v[44:47], a[44:47], a[112:115], v[44:47]
    ds_read2_b32 a[26:27], v223 offset0:210 offset1:211
    v_mfma_f32_16x16x32_bf16 v[32:35], a[48:51], a[96:99], v[32:35]
    ds_read_b128 a[92:95], v224 offset:3904
    v_and_b32 v62, s69, v198
    v_mfma_f32_16x16x32_bf16 v[36:39], a[48:51], a[100:103], v[36:39]
    ds_read2_b32 a[28:29], v223 offset0:80 offset1:81
    v_lshlrev_b32 v63, 16, v198
    v_mfma_f32_16x16x32_bf16 v[40:43], a[48:51], a[104:107], v[40:43]
    ds_read2_b32 a[30:31], v223 offset0:82 offset1:83
    v_mfma_f32_16x16x32_bf16 v[44:47], a[48:51], a[108:111], v[44:47]
    s_add_u32 m0, s88, 36864
    v_and_b32 v64, s69, v201
    v_lshlrev_b32 v65, 16, v201
    v_mfma_f32_16x16x32_bf16 v[36:39], a[52:55], a[96:99], v[36:39]
    buffer_load_dwordx4 v7, s[84:87], s89 offen lds
    v_mfma_f32_16x16x32_bf16 v[40:43], a[52:55], a[100:103], v[40:43]
    v_and_b32 v66, s69, v200
    v_mfma_f32_16x16x32_bf16 v[44:47], a[52:55], a[104:107], v[44:47]
    v_lshlrev_b32 v67, 16, v200
    v_mfma_f32_16x16x32_bf16 v[40:43], a[56:59], a[96:99], v[40:43]
    v_and_b32 v68, s69, v203
    v_lshlrev_b32 v69, 16, v203
    v_mfma_f32_16x16x32_bf16 v[44:47], a[56:59], a[100:103], v[44:47]
    v_and_b32 v70, s69, v202
    v_mfma_f32_16x16x32_bf16 v[44:47], a[60:63], a[96:99], v[44:47]
    v_lshlrev_b32 v71, 16, v202
    s_waitcnt lgkmcnt(0)
    v_mfma_f32_16x16x32_bf16 v[16:19], a[0:3], a[64:67], v[16:19]
    ds_read_b128 a[96:99], v224 offset:256
    s_add_u32 m0, s88, 40960
    s_mov_b32 s89, 552960
    v_and_b32 v72, s69, v205
    v_mfma_f32_16x16x32_bf16 v[20:23], a[0:3], a[68:71], v[20:23]
    buffer_load_dwordx4 v7, s[80:83], s89 offen lds
    v_mfma_f32_16x16x32_bf16 v[24:27], a[0:3], a[72:75], v[24:27]
    ds_read2_b32 a[32:33], v220 offset0:192 offset1:193
    v_lshlrev_b32 v73, 16, v205
    v_mfma_f32_16x16x32_bf16 v[28:31], a[0:3], a[76:79], v[28:31]
    ds_read2_b32 a[34:35], v220 offset0:194 offset1:195
    v_mfma_f32_16x16x32_bf16 v[32:35], a[0:3], a[80:83], v[32:35]
    ds_read_b128 a[100:103], v224 offset:768
    v_and_b32 v74, s69, v204
    v_mfma_f32_16x16x32_bf16 v[36:39], a[0:3], a[84:87], v[36:39]
    ds_read2_b32 a[36:37], v220 offset0:64 offset1:65
    s_add_u32 m0, s88, 45056
    v_lshlrev_b32 v75, 16, v204
    v_mfma_f32_16x16x32_bf16 v[40:43], a[0:3], a[88:91], v[40:43]
    buffer_load_dwordx4 v7, s[84:87], s89 offen lds
    v_mfma_f32_16x16x32_bf16 v[44:47], a[0:3], a[92:95], v[44:47]
    ds_read2_b32 a[38:39], v220 offset0:66 offset1:67
    v_mfma_f32_16x16x32_bf16 v[20:23], a[4:7], a[64:67], v[20:23]
    ds_read_b128 a[104:107], v224 offset:1280
    v_and_b32 v76, s69, v207
    v_mfma_f32_16x16x32_bf16 v[24:27], a[4:7], a[68:71], v[24:27]
    ds_read2_b32 a[40:41], v221 offset0:192 offset1:193
    v_lshlrev_b32 v77, 16, v207
    v_mfma_f32_16x16x32_bf16 v[28:31], a[4:7], a[72:75], v[28:31]
    ds_read2_b32 a[42:43], v221 offset0:194 offset1:195
    v_mfma_f32_16x16x32_bf16 v[32:35], a[4:7], a[76:79], v[32:35]
    ds_read_b128 a[108:111], v224 offset:1792
    s_add_u32 m0, s88, 49152
    s_mov_b32 s89, 663552
    v_and_b32 v78, s69, v206
    v_mfma_f32_16x16x32_bf16 v[36:39], a[4:7], a[80:83], v[36:39]
    buffer_load_dwordx4 v7, s[80:83], s89 offen lds
    v_mfma_f32_16x16x32_bf16 v[40:43], a[4:7], a[84:87], v[40:43]
    ds_read2_b32 a[44:45], v221 offset0:64 offset1:65
    v_lshlrev_b32 v79, 16, v206
    v_mfma_f32_16x16x32_bf16 v[44:47], a[4:7], a[88:91], v[44:47]
    ds_read2_b32 a[46:47], v221 offset0:66 offset1:67
    v_mfma_f32_16x16x32_bf16 v[24:27], a[8:11], a[64:67], v[24:27]
    ds_read_b128 a[112:115], v224 offset:2304
    v_mul_f32 v48, v218, v48
    v_mfma_f32_16x16x32_bf16 v[28:31], a[8:11], a[68:71], v[28:31]
    ds_read2_b32 a[48:49], v222 offset0:192 offset1:193
    v_mul_f32 v49, v218, v49
    v_mfma_f32_16x16x32_bf16 v[32:35], a[8:11], a[72:75], v[32:35]
    ds_read2_b32 a[50:51], v222 offset0:194 offset1:195
    s_add_u32 m0, s88, 53248
    v_mfma_f32_16x16x32_bf16 v[36:39], a[8:11], a[76:79], v[36:39]
    buffer_load_dwordx4 v7, s[84:87], s89 offen lds
    v_mfma_f32_16x16x32_bf16 v[40:43], a[8:11], a[80:83], v[40:43]
    ds_read_b128 a[116:119], v224 offset:2816
    v_mul_f32 v50, v218, v50
    v_mfma_f32_16x16x32_bf16 v[44:47], a[8:11], a[84:87], v[44:47]
    ds_read2_b32 a[52:53], v222 offset0:64 offset1:65
    v_mul_f32 v51, v218, v51
    v_mfma_f32_16x16x32_bf16 v[28:31], a[12:15], a[64:67], v[28:31]
    ds_read2_b32 a[54:55], v222 offset0:66 offset1:67
    v_mfma_f32_16x16x32_bf16 v[32:35], a[12:15], a[68:71], v[32:35]
    ds_read_b128 a[120:123], v224 offset:3328
    v_mul_f32 v52, v218, v52
    v_mfma_f32_16x16x32_bf16 v[36:39], a[12:15], a[72:75], v[36:39]
    ds_read2_b32 a[56:57], v223 offset0:192 offset1:193
    s_add_u32 m0, s88, 57344
    s_mov_b32 s89, 774144
    v_mul_f32 v53, v218, v53
    v_mfma_f32_16x16x32_bf16 v[40:43], a[12:15], a[76:79], v[40:43]
    buffer_load_dwordx4 v7, s[80:83], s89 offen lds
    v_mfma_f32_16x16x32_bf16 v[44:47], a[12:15], a[80:83], v[44:47]
    ds_read2_b32 a[58:59], v223 offset0:194 offset1:195
    v_mfma_f32_16x16x32_bf16 v[32:35], a[16:19], a[64:67], v[32:35]
    ds_read_b128 a[124:127], v224 offset:3840
    v_mul_f32 v54, v218, v54
    v_mfma_f32_16x16x32_bf16 v[36:39], a[16:19], a[68:71], v[36:39]
    ds_read2_b32 a[60:61], v223 offset0:64 offset1:65
    v_mul_f32 v55, v218, v55
    v_mfma_f32_16x16x32_bf16 v[40:43], a[16:19], a[72:75], v[40:43]
    ds_read2_b32 a[62:63], v223 offset0:66 offset1:67
    v_mfma_f32_16x16x32_bf16 v[44:47], a[16:19], a[76:79], v[44:47]
    s_add_u32 m0, s88, 61440
    v_mul_f32 v56, v218, v56
    v_mul_f32 v57, v218, v57
    v_mfma_f32_16x16x32_bf16 v[36:39], a[20:23], a[64:67], v[36:39]
    buffer_load_dwordx4 v7, s[84:87], s89 offen lds
    v_mfma_f32_16x16x32_bf16 v[40:43], a[20:23], a[68:71], v[40:43]
    v_mul_f32 v58, v218, v58
    v_mfma_f32_16x16x32_bf16 v[44:47], a[20:23], a[72:75], v[44:47]
    v_mul_f32 v59, v218, v59
    v_mfma_f32_16x16x32_bf16 v[40:43], a[24:27], a[64:67], v[40:43]
    v_mul_f32 v60, v218, v60
    v_mul_f32 v61, v218, v61
    v_mfma_f32_16x16x32_bf16 v[44:47], a[24:27], a[68:71], v[44:47]
    v_mul_f32 v62, v218, v62
    v_mfma_f32_16x16x32_bf16 v[44:47], a[28:31], a[64:67], v[44:47]
    v_mul_f32 v63, v218, v63
    s_waitcnt lgkmcnt(0)
    v_mfma_f32_16x16x32_bf16 v[16:19], a[32:35], a[96:99], v[16:19]
    ds_read_b128 a[64:67], v224 offset:192
    v_mul_f32 v64, v218, v64
    v_mfma_f32_16x16x32_bf16 v[20:23], a[32:35], a[100:103], v[20:23]
    s_mov_b64 exec, s[28:29]
    global_load_dwordx2 v[212:213], v210, s[12:13] sc1
    s_mov_b64 exec, -1
    v_mfma_f32_16x16x32_bf16 v[24:27], a[32:35], a[104:107], v[24:27]
    ds_read2_b32 a[0:1], v220 offset0:176 offset1:177
    v_mfma_f32_16x16x32_bf16 v[28:31], a[32:35], a[108:111], v[28:31]
    ds_read2_b32 a[2:3], v220 offset0:178 offset1:179
    v_mul_f32 v65, v218, v65
    v_mfma_f32_16x16x32_bf16 v[32:35], a[32:35], a[112:115], v[32:35]
    ds_read_b128 a[68:71], v224 offset:704
    v_mfma_f32_16x16x32_bf16 v[36:39], a[32:35], a[116:119], v[36:39]
    ds_read2_b32 a[4:5], v220 offset0:48 offset1:49
    s_add_u32 m0, s88, 65536
    s_mov_b32 s89, 884736
    v_mul_f32 v66, v218, v66
    v_mfma_f32_16x16x32_bf16 v[40:43], a[32:35], a[120:123], v[40:43]
    buffer_load_dwordx4 v7, s[80:83], s89 offen lds
    v_mfma_f32_16x16x32_bf16 v[44:47], a[32:35], a[124:127], v[44:47]
    ds_read2_b32 a[6:7], v220 offset0:50 offset1:51
    v_mfma_f32_16x16x32_bf16 v[20:23], a[36:39], a[96:99], v[20:23]
    ds_read_b128 a[72:75], v224 offset:1216
    v_mul_f32 v67, v218, v67
    v_mfma_f32_16x16x32_bf16 v[24:27], a[36:39], a[100:103], v[24:27]
    ds_read2_b32 a[8:9], v221 offset0:176 offset1:177
    v_mfma_f32_16x16x32_bf16 v[28:31], a[36:39], a[104:107], v[28:31]
    ds_read2_b32 a[10:11], v221 offset0:178 offset1:179
    s_add_u32 m0, s88, 69632
    v_mul_f32 v68, v218, v68
    v_mfma_f32_16x16x32_bf16 v[32:35], a[36:39], a[108:111], v[32:35]
    buffer_load_dwordx4 v7, s[84:87], s89 offen lds
    v_mfma_f32_16x16x32_bf16 v[36:39], a[36:39], a[112:115], v[36:39]
    ds_read_b128 a[76:79], v224 offset:1728
    v_mfma_f32_16x16x32_bf16 v[40:43], a[36:39], a[116:119], v[40:43]
    ds_read2_b32 a[12:13], v221 offset0:48 offset1:49
    v_mul_f32 v69, v218, v69
    v_mfma_f32_16x16x32_bf16 v[44:47], a[36:39], a[120:123], v[44:47]
    ds_read2_b32 a[14:15], v221 offset0:50 offset1:51
    v_mfma_f32_16x16x32_bf16 v[24:27], a[40:43], a[96:99], v[24:27]
    ds_read_b128 a[80:83], v224 offset:2240
    s_add_u32 m0, s88, 73728
    s_mov_b32 s89, 995328
    v_mul_f32 v70, v218, v70
    v_mfma_f32_16x16x32_bf16 v[28:31], a[40:43], a[100:103], v[28:31]
    buffer_load_dwordx4 v7, s[80:83], s89 offen lds
    v_mfma_f32_16x16x32_bf16 v[32:35], a[40:43], a[104:107], v[32:35]
    ds_read2_b32 a[16:17], v222 offset0:176 offset1:177
    v_mfma_f32_16x16x32_bf16 v[36:39], a[40:43], a[108:111], v[36:39]
    ds_read2_b32 a[18:19], v222 offset0:178 offset1:179
    v_mul_f32 v71, v218, v71
    v_mfma_f32_16x16x32_bf16 v[40:43], a[40:43], a[112:115], v[40:43]
    ds_read_b128 a[84:87], v224 offset:2752
    v_mfma_f32_16x16x32_bf16 v[44:47], a[40:43], a[116:119], v[44:47]
    ds_read2_b32 a[20:21], v222 offset0:48 offset1:49
    s_add_u32 m0, s88, 77824
    v_mfma_f32_16x16x32_bf16 v[28:31], a[44:47], a[96:99], v[28:31]
    buffer_load_dwordx4 v7, s[84:87], s89 offen lds
    v_mfma_f32_16x16x32_bf16 v[32:35], a[44:47], a[100:103], v[32:35]
    ds_read2_b32 a[22:23], v222 offset0:50 offset1:51
    v_mul_f32 v72, v218, v72
    v_mfma_f32_16x16x32_bf16 v[36:39], a[44:47], a[104:107], v[36:39]
    ds_read_b128 a[88:91], v224 offset:3264
    v_mfma_f32_16x16x32_bf16 v[40:43], a[44:47], a[108:111], v[40:43]
    ds_read2_b32 a[24:25], v223 offset0:176 offset1:177
    v_mul_f32 v73, v218, v73
    v_mfma_f32_16x16x32_bf16 v[44:47], a[44:47], a[112:115], v[44:47]
    ds_read2_b32 a[26:27], v223 offset0:178 offset1:179
    s_add_u32 m0, s88, 81920
    s_mov_b32 s89, 1105920
    v_mfma_f32_16x16x32_bf16 v[32:35], a[48:51], a[96:99], v[32:35]
    buffer_load_dwordx4 v7, s[80:83], s89 offen lds
    v_mfma_f32_16x16x32_bf16 v[36:39], a[48:51], a[100:103], v[36:39]
    ds_read_b128 a[92:95], v224 offset:3776
    v_mul_f32 v74, v218, v74
    v_mfma_f32_16x16x32_bf16 v[40:43], a[48:51], a[104:107], v[40:43]
    ds_read2_b32 a[28:29], v223 offset0:48 offset1:49
    v_mfma_f32_16x16x32_bf16 v[44:47], a[48:51], a[108:111], v[44:47]
    ds_read2_b32 a[30:31], v223 offset0:50 offset1:51
    v_mul_f32 v75, v218, v75
    v_mfma_f32_16x16x32_bf16 v[36:39], a[52:55], a[96:99], v[36:39]
    s_add_u32 m0, s88, 86016
    v_mul_f32 v76, v218, v76
    v_mfma_f32_16x16x32_bf16 v[40:43], a[52:55], a[100:103], v[40:43]
    buffer_load_dwordx4 v7, s[84:87], s89 offen lds
    v_mfma_f32_16x16x32_bf16 v[44:47], a[52:55], a[104:107], v[44:47]
    v_mul_f32 v77, v218, v77
    v_mfma_f32_16x16x32_bf16 v[40:43], a[56:59], a[96:99], v[40:43]
    v_mul_f32 v78, v218, v78
    v_mfma_f32_16x16x32_bf16 v[44:47], a[56:59], a[100:103], v[44:47]
    v_mul_f32 v79, v218, v79
    v_mfma_f32_16x16x32_bf16 v[44:47], a[60:63], a[96:99], v[44:47]
    s_waitcnt lgkmcnt(0)
    s_waitcnt vmcnt(6)
    s_mov_b32 s74, 0x100000
hk_slow_14:
    v_cmp_ne_u64 vcc, s[70:71], v[212:213]
    s_cbranch_vccz hk_ok_13
    s_mov_b64 exec, s[28:29]
    global_load_dwordx2 v[212:213], v210, s[12:13] sc1
    s_mov_b64 exec, -1
    s_waitcnt vmcnt(0)
    s_sub_u32 s74, s74, 1
    s_cbranch_scc0 hk_slow_14
hk_ok_13:
    s_barrier
    v_mfma_f32_16x16x32_bf16 v[16:19], a[0:3], a[64:67], v[16:19]
    ds_read_b128 a[96:99], v224 offset:128
    s_lshl_b32 s17, s8, 2
    s_add_u32 s17, s17, 6246400
    v_add_u32 v212, s17, v208
    v_mfma_f32_16x16x32_bf16 v[20:23], a[0:3], a[68:71], v[20:23]
    s_mov_b64 exec, 0x1f
    global_load_dword v219, v212, s[12:13] sc1
    s_mov_b64 exec, -1
    v_mfma_f32_16x16x32_bf16 v[24:27], a[0:3], a[72:75], v[24:27]
    ds_read2_b32 a[32:33], v220 offset0:160 offset1:161
    s_lshl_b32 s17, s8, 12
    s_add_u32 s17, s17, 3608576
    s_add_u32 s14, s12, s17
    s_addc_u32 s15, s13, 0
    v_mfma_f32_16x16x32_bf16 v[28:31], a[0:3], a[76:79], v[28:31]
    global_load_dwordx4 v[176:179], v10, s[14:15] offset:0 sc1
    v_mfma_f32_16x16x32_bf16 v[32:35], a[0:3], a[80:83], v[32:35]
    ds_read2_b32 a[34:35], v220 offset0:162 offset1:163
    v_mfma_f32_16x16x32_bf16 v[36:39], a[0:3], a[84:87], v[36:39]
    ds_read_b128 a[100:103], v224 offset:640
    v_mfma_f32_16x16x32_bf16 v[40:43], a[0:3], a[88:91], v[40:43]
    global_load_dwordx4 v[180:183], v10, s[14:15] offset:1024 sc1
    v_mfma_f32_16x16x32_bf16 v[44:47], a[0:3], a[92:95], v[44:47]
    ds_read2_b32 a[36:37], v220 offset0:32 offset1:33
    v_mfma_f32_16x16x32_bf16 v[20:23], a[4:7], a[64:67], v[20:23]
    ds_read2_b32 a[38:39], v220 offset0:34 offset1:35
    v_mfma_f32_16x16x32_bf16 v[24:27], a[4:7], a[68:71], v[24:27]
    global_load_dwordx4 v[184:187], v10, s[14:15] offset:2048 sc1
    v_mfma_f32_16x16x32_bf16 v[28:31], a[4:7], a[72:75], v[28:31]
    ds_read_b128 a[104:107], v224 offset:1152
    v_mfma_f32_16x16x32_bf16 v[32:35], a[4:7], a[76:79], v[32:35]
    ds_read2_b32 a[40:41], v221 offset0:160 offset1:161
    v_mfma_f32_16x16x32_bf16 v[36:39], a[4:7], a[80:83], v[36:39]
    global_load_dwordx4 v[188:191], v10, s[14:15] offset:3072 sc1
    v_mfma_f32_16x16x32_bf16 v[40:43], a[4:7], a[84:87], v[40:43]
    ds_read2_b32 a[42:43], v221 offset0:162 offset1:163
    v_mfma_f32_16x16x32_bf16 v[44:47], a[4:7], a[88:91], v[44:47]
    ds_read_b128 a[108:111], v224 offset:1664
    s_lshl_b32 s16, s3, 12
    s_add_u32 s17, s16, 6230016
    s_add_u32 s14, s12, s17
    s_addc_u32 s15, s13, 0
    s_mov_b32 m0, s16
    v_mfma_f32_16x16x32_bf16 v[24:27], a[8:11], a[64:67], v[24:27]
    global_load_lds_dwordx4 v209, s[14:15] offset:0 sc1
    v_mfma_f32_16x16x32_bf16 v[28:31], a[8:11], a[68:71], v[28:31]
    ds_read2_b32 a[44:45], v221 offset0:32 offset1:33
    v_mfma_f32_16x16x32_bf16 v[32:35], a[8:11], a[72:75], v[32:35]
    ds_read2_b32 a[46:47], v221 offset0:34 offset1:35
    v_mfma_f32_16x16x32_bf16 v[36:39], a[8:11], a[76:79], v[36:39]
    global_load_lds_dwordx4 v209, s[14:15] offset:1024 sc1
    v_mfma_f32_16x16x32_bf16 v[40:43], a[8:11], a[80:83], v[40:43]
    ds_read_b128 a[112:115], v224 offset:2176
    v_mfma_f32_16x16x32_bf16 v[44:47], a[8:11], a[84:87], v[44:47]
    ds_read2_b32 a[48:49], v222 offset0:160 offset1:161
    v_mfma_f32_16x16x32_bf16 v[28:31], a[12:15], a[64:67], v[28:31]
    global_load_lds_dwordx4 v209, s[14:15] offset:2048 sc1
    v_mfma_f32_16x16x32_bf16 v[32:35], a[12:15], a[68:71], v[32:35]
    ds_read2_b32 a[50:51], v222 offset0:162 offset1:163
    v_mfma_f32_16x16x32_bf16 v[36:39], a[12:15], a[72:75], v[36:39]
    ds_read_b128 a[116:119], v224 offset:2688
    v_mfma_f32_16x16x32_bf16 v[40:43], a[12:15], a[76:79], v[40:43]
    global_load_lds_dwordx4 v209, s[14:15] offset:3072 sc1
    v_mfma_f32_16x16x32_bf16 v[44:47], a[12:15], a[80:83], v[44:47]
    ds_read2_b32 a[52:53], v222 offset0:32 offset1:33
    v_mfma_f32_16x16x32_bf16 v[32:35], a[16:19], a[64:67], v[32:35]
    ds_read2_b32 a[54:55], v222 offset0:34 offset1:35
    v_mfma_f32_16x16x32_bf16 v[36:39], a[16:19], a[68:71], v[36:39]
    v_mfma_f32_16x16x32_bf16 v[40:43], a[16:19], a[72:75], v[40:43]
    ds_read_b128 a[120:123], v224 offset:3200
    v_mfma_f32_16x16x32_bf16 v[44:47], a[16:19], a[76:79], v[44:47]
    ds_read2_b32 a[56:57], v223 offset0:160 offset1:161
    v_mfma_f32_16x16x32_bf16 v[36:39], a[20:23], a[64:67], v[36:39]
    v_mfma_f32_16x16x32_bf16 v[40:43], a[20:23], a[68:71], v[40:43]
    ds_read2_b32 a[58:59], v223 offset0:162 offset1:163
    v_mfma_f32_16x16x32_bf16 v[44:47], a[20:23], a[72:75], v[44:47]
    ds_read_b128 a[124:127], v224 offset:3712
    v_mfma_f32_16x16x32_bf16 v[40:43], a[24:27], a[64:67], v[40:43]
    v_mfma_f32_16x16x32_bf16 v[44:47], a[24:27], a[68:71], v[44:47]
    ds_read2_b32 a[60:61], v223 offset0:32 offset1:33
    v_mfma_f32_16x16x32_bf16 v[44:47], a[28:31], a[64:67], v[44:47]
    ds_read2_b32 a[62:63], v223 offset0:34 offset1:35
    s_waitcnt lgkmcnt(0)
    v_mfma_f32_16x16x32_bf16 v[16:19], a[32:35], a[96:99], v[16:19]
    ds_read_b128 a[64:67], v224 offset:64
    v_mfma_f32_16x16x32_bf16 v[20:23], a[32:35], a[100:103], v[20:23]
    ds_read2_b32 a[0:1], v220 offset0:144 offset1:145
    v_mfma_f32_16x16x32_bf16 v[24:27], a[32:35], a[104:107], v[24:27]
    ds_read2_b32 a[2:3], v220 offset0:146 offset1:147
    v_mfma_f32_16x16x32_bf16 v[28:31], a[32:35], a[108:111], v[28:31]
    ds_read_b128 a[68:71], v224 offset:576
    v_mfma_f32_16x16x32_bf16 v[32:35], a[32:35], a[112:115], v[32:35]
    ds_read2_b32 a[4:5], v220 offset0:16 offset1:17
    v_mfma_f32_16x16x32_bf16 v[36:39], a[32:35], a[116:119], v[36:39]
    ds_read2_b32 a[6:7], v220 offset0:18 offset1:19
    v_mfma_f32_16x16x32_bf16 v[40:43], a[32:35], a[120:123], v[40:43]
    ds_read_b128 a[72:75], v224 offset:1088
    v_mfma_f32_16x16x32_bf16 v[44:47], a[32:35], a[124:127], v[44:47]
    ds_read2_b32 a[8:9], v221 offset0:144 offset1:145
    v_mfma_f32_16x16x32_bf16 v[20:23], a[36:39], a[96:99], v[20:23]
    ds_read2_b32 a[10:11], v221 offset0:146 offset1:147
    v_mfma_f32_16x16x32_bf16 v[24:27], a[36:39], a[100:103], v[24:27]
    ds_read_b128 a[76:79], v224 offset:1600
    v_mfma_f32_16x16x32_bf16 v[28:31], a[36:39], a[104:107], v[28:31]
    ds_read2_b32 a[12:13], v221 offset0:16 offset1:17
    v_mfma_f32_16x16x32_bf16 v[32:35], a[36:39], a[108:111], v[32:35]
    ds_read2_b32 a[14:15], v221 offset0:18 offset1:19
    v_mfma_f32_16x16x32_bf16 v[36:39], a[36:39], a[112:115], v[36:39]
    ds_read_b128 a[80:83], v224 offset:2112
    v_mfma_f32_16x16x32_bf16 v[40:43], a[36:39], a[116:119], v[40:43]
    ds_read2_b32 a[16:17], v222 offset0:144 offset1:145
    v_mfma_f32_16x16x32_bf16 v[44:47], a[36:39], a[120:123], v[44:47]
    ds_read2_b32 a[18:19], v222 offset0:146 offset1:147
    v_mfma_f32_16x16x32_bf16 v[24:27], a[40:43], a[96:99], v[24:27]
    ds_read_b128 a[84:87], v224 offset:2624
    v_mfma_f32_16x16x32_bf16 v[28:31], a[40:43], a[100:103], v[28:31]
    ds_read2_b32 a[20:21], v222 offset0:16 offset1:17
    v_mfma_f32_16x16x32_bf16 v[32:35], a[40:43], a[104:107], v[32:35]
    ds_read2_b32 a[22:23], v222 offset0:18 offset1:19
    v_mfma_f32_16x16x32_bf16 v[36:39], a[40:43], a[108:111], v[36:39]
    ds_read_b128 a[88:91], v224 offset:3136
    v_mfma_f32_16x16x32_bf16 v[40:43], a[40:43], a[112:115], v[40:43]
    ds_read2_b32 a[24:25], v223 offset0:144 offset1:145
    v_mfma_f32_16x16x32_bf16 v[44:47], a[40:43], a[116:119], v[44:47]
    ds_read2_b32 a[26:27], v223 offset0:146 offset1:147
    v_mfma_f32_16x16x32_bf16 v[28:31], a[44:47], a[96:99], v[28:31]
    ds_read_b128 a[92:95], v224 offset:3648
    v_mfma_f32_16x16x32_bf16 v[32:35], a[44:47], a[100:103], v[32:35]
    ds_read2_b32 a[28:29], v223 offset0:16 offset1:17
    v_mfma_f32_16x16x32_bf16 v[36:39], a[44:47], a[104:107], v[36:39]
    ds_read2_b32 a[30:31], v223 offset0:18 offset1:19
    v_mfma_f32_16x16x32_bf16 v[40:43], a[44:47], a[108:111], v[40:43]
    v_mfma_f32_16x16x32_bf16 v[44:47], a[44:47], a[112:115], v[44:47]
    v_mfma_f32_16x16x32_bf16 v[32:35], a[48:51], a[96:99], v[32:35]
    v_mfma_f32_16x16x32_bf16 v[36:39], a[48:51], a[100:103], v[36:39]
    v_mfma_f32_16x16x32_bf16 v[40:43], a[48:51], a[104:107], v[40:43]
    v_mfma_f32_16x16x32_bf16 v[44:47], a[48:51], a[108:111], v[44:47]
    v_mfma_f32_16x16x32_bf16 v[36:39], a[52:55], a[96:99], v[36:39]
    v_mfma_f32_16x16x32_bf16 v[40:43], a[52:55], a[100:103], v[40:43]
    v_mfma_f32_16x16x32_bf16 v[44:47], a[52:55], a[104:107], v[44:47]
    v_mfma_f32_16x16x32_bf16 v[40:43], a[56:59], a[96:99], v[40:43]
    v_mfma_f32_16x16x32_bf16 v[44:47], a[56:59], a[100:103], v[44:47]
    v_mfma_f32_16x16x32_bf16 v[44:47], a[60:63], a[96:99], v[44:47]
    s_waitcnt lgkmcnt(0)
    s_waitcnt vmcnt(4)
    v_mfma_f32_16x16x32_bf16 v[16:19], a[0:3], a[64:67], v[16:19]
    ds_read_b128 a[96:99], v224 offset:0
    v_add_f32 v214, 1.0, v219
    v_mfma_f32_16x16x32_bf16 v[20:23], a[0:3], a[68:71], v[20:23]
    ds_read2_b32 a[32:33], v220 offset0:128 offset1:129
    v_readlane_b32 s20, v219, 0
    v_mfma_f32_16x16x32_bf16 v[24:27], a[0:3], a[72:75], v[24:27]
    ds_read2_b32 a[34:35], v220 offset0:130 offset1:131
    v_cvt_pk_bf16_f32 v214, v214, v214
    v_mfma_f32_16x16x32_bf16 v[28:31], a[0:3], a[76:79], v[28:31]
    ds_read_b128 a[100:103], v224 offset:512
    v_readlane_b32 s22, v219, 2
    v_mfma_f32_16x16x32_bf16 v[32:35], a[0:3], a[80:83], v[32:35]
    ds_read2_b32 a[36:37], v220 offset0:0 offset1:1
    v_lshlrev_b32 v214, 16, v214
    s_nop 0
    v_mfma_f32_16x16x32_bf16 v[36:39], a[0:3], a[84:87], v[36:39]
    ds_read2_b32 a[38:39], v220 offset0:2 offset1:3
    v_readlane_b32 s21, v214, 1
    v_mfma_f32_16x16x32_bf16 v[40:43], a[0:3], a[88:91], v[40:43]
    ds_read_b128 a[104:107], v224 offset:1024
    v_readlane_b32 s23, v214, 4
    v_mfma_f32_16x16x32_bf16 v[44:47], a[0:3], a[92:95], v[44:47]
    ds_read2_b32 a[40:41], v221 offset0:128 offset1:129
    v_mov_b32 v228, s22
    s_nop 0
    v_mfma_f32_16x16x32_bf16 v[20:23], a[4:7], a[64:67], v[20:23]
    ds_read2_b32 a[42:43], v221 offset0:130 offset1:131
    v_mul_f32 v226, s21, v228
    v_mfma_f32_16x16x32_bf16 v[24:27], a[4:7], a[68:71], v[24:27]
    ds_read_b128 a[108:111], v224 offset:1536
    v_mul_f32 v228, s20, v228
    v_mfma_f32_16x16x32_bf16 v[28:31], a[4:7], a[72:75], v[28:31]
    ds_read2_b32 a[44:45], v221 offset0:0 offset1:1
    v_mov_b32 v230, s23
    v_mfma_f32_16x16x32_bf16 v[32:35], a[4:7], a[76:79], v[32:35]
    ds_read2_b32 a[46:47], v221 offset0:2 offset1:3
    v_permlane16_swap_b32 v176, v178
    v_mfma_f32_16x16x32_bf16 v[36:39], a[4:7], a[80:83], v[36:39]
    ds_read_b128 a[112:115], v224 offset:2048
    v_permlane16_swap_b32 v177, v179
    v_mfma_f32_16x16x32_bf16 v[40:43], a[4:7], a[84:87], v[40:43]
    ds_read2_b32 a[48:49], v222 offset0:128 offset1:129
    v_permlane16_swap_b32 v180, v182
    v_mfma_f32_16x16x32_bf16 v[44:47], a[4:7], a[88:91], v[44:47]
    ds_read2_b32 a[50:51], v222 offset0:130 offset1:131
    v_permlane16_swap_b32 v181, v183
    v_mfma_f32_16x16x32_bf16 v[24:27], a[8:11], a[64:67], v[24:27]
    ds_read_b128 a[116:119], v224 offset:2560
    v_permlane16_swap_b32 v184, v186
    v_mfma_f32_16x16x32_bf16 v[28:31], a[8:11], a[68:71], v[28:31]
    ds_read2_b32 a[52:53], v222 offset0:0 offset1:1
    v_permlane16_swap_b32 v185, v187
    v_mfma_f32_16x16x32_bf16 v[32:35], a[8:11], a[72:75], v[32:35]
    ds_read2_b32 a[54:55], v222 offset0:2 offset1:3
    v_permlane16_swap_b32 v188, v190
    v_mfma_f32_16x16x32_bf16 v[36:39], a[8:11], a[76:79], v[36:39]
    ds_read_b128 a[120:123], v224 offset:3072
    v_permlane16_swap_b32 v189, v191
    v_mfma_f32_16x16x32_bf16 v[40:43], a[8:11], a[80:83], v[40:43]
    ds_read2_b32 a[56:57], v223 offset0:128 offset1:129
    v_lshlrev_b32 v144, 16, v176
    v_mfma_f32_16x16x32_bf16 v[44:47], a[8:11], a[84:87], v[44:47]
    ds_read2_b32 a[58:59], v223 offset0:130 offset1:131
    v_and_b32 v145, s69, v176
    v_mfma_f32_16x16x32_bf16 v[28:31], a[12:15], a[64:67], v[28:31]
    ds_read_b128 a[124:127], v224 offset:3584
    v_lshlrev_b32 v146, 16, v177
    v_mfma_f32_16x16x32_bf16 v[32:35], a[12:15], a[68:71], v[32:35]
    ds_read2_b32 a[60:61], v223 offset0:0 offset1:1
    v_and_b32 v147, s69, v177
    v_mfma_f32_16x16x32_bf16 v[36:39], a[12:15], a[72:75], v[36:39]
    ds_read2_b32 a[62:63], v223 offset0:2 offset1:3
    v_lshlrev_b32 v148, 16, v178
    v_mfma_f32_16x16x32_bf16 v[40:43], a[12:15], a[76:79], v[40:43]
    v_and_b32 v149, s69, v178
    v_lshlrev_b32 v150, 16, v179
    v_mfma_f32_16x16x32_bf16 v[44:47], a[12:15], a[80:83], v[44:47]
    v_and_b32 v151, s69, v179
    v_lshlrev_b32 v152, 16, v180
    v_mfma_f32_16x16x32_bf16 v[32:35], a[16:19], a[64:67], v[32:35]
    v_and_b32 v153, s69, v180
    v_lshlrev_b32 v154, 16, v181
    v_mfma_f32_16x16x32_bf16 v[36:39], a[16:19], a[68:71], v[36:39]
    v_and_b32 v155, s69, v181
    v_lshlrev_b32 v156, 16, v182
    v_mfma_f32_16x16x32_bf16 v[40:43], a[16:19], a[72:75], v[40:43]
    v_and_b32 v157, s69, v182
    v_lshlrev_b32 v158, 16, v183
    v_mfma_f32_16x16x32_bf16 v[44:47], a[16:19], a[76:79], v[44:47]
    v_and_b32 v159, s69, v183
    v_lshlrev_b32 v160, 16, v184
    v_mfma_f32_16x16x32_bf16 v[36:39], a[20:23], a[64:67], v[36:39]
    v_and_b32 v161, s69, v184
    v_lshlrev_b32 v162, 16, v185
    v_mfma_f32_16x16x32_bf16 v[40:43], a[20:23], a[68:71], v[40:43]
    v_and_b32 v163, s69, v185
    v_lshlrev_b32 v164, 16, v186
    v_mfma_f32_16x16x32_bf16 v[44:47], a[20:23], a[72:75], v[44:47]
    v_and_b32 v165, s69, v186
    v_lshlrev_b32 v166, 16, v187
    v_mfma_f32_16x16x32_bf16 v[40:43], a[24:27], a[64:67], v[40:43]
    v_and_b32 v167, s69, v187
    v_lshlrev_b32 v168, 16, v188
    v_mfma_f32_16x16x32_bf16 v[44:47], a[24:27], a[68:71], v[44:47]
    v_and_b32 v169, s69, v188
    v_lshlrev_b32 v170, 16, v189
    v_mfma_f32_16x16x32_bf16 v[44:47], a[28:31], a[64:67], v[44:47]
    v_and_b32 v171, s69, v189
    s_waitcnt lgkmcnt(0)
    s_waitcnt vmcnt(0)
    s_barrier
    v_mfma_f32_16x16x32_bf16 v[16:19], a[32:35], a[96:99], v[16:19]
    ds_read_b128 v[80:83], v12 offset:0
    v_lshlrev_b32 v172, 16, v190
    v_mfma_f32_16x16x32_bf16 v[20:23], a[32:35], a[100:103], v[20:23]
    s_mov_b64 exec, 1
    global_load_dwordx2 v[236:237], v240, s[12:13] sc1
    s_mov_b64 exec, -1
    v_mfma_f32_16x16x32_bf16 v[24:27], a[32:35], a[104:107], v[24:27]
    ds_read_b128 v[112:115], v243 offset:0
    v_and_b32 v173, s69, v190
    v_mfma_f32_16x16x32_bf16 v[28:31], a[32:35], a[108:111], v[28:31]
    ds_read_b128 v[84:87], v12 offset:2048
    v_lshlrev_b32 v174, 16, v191
    v_mfma_f32_16x16x32_bf16 v[32:35], a[32:35], a[112:115], v[32:35]
    ds_read_b128 v[116:119], v243 offset:2048
    v_and_b32 v175, s69, v191
    v_mfma_f32_16x16x32_bf16 v[36:39], a[32:35], a[116:119], v[36:39]
    ds_read_b128 v[88:91], v12 offset:4096
    s_lshl_b32 s17, s8, 12
    s_add_u32 s17, s17, 6262784
    s_add_u32 s14, s12, s17
    s_addc_u32 s15, s13, 0
    s_add_u32 s16, s14, 2621440
    s_addc_u32 s17, s15, 0
    v_mfma_f32_16x16x32_bf16 v[40:43], a[32:35], a[120:123], v[40:43]
    ds_read_b128 v[120:123], v243 offset:4096
    v_mfma_f32_16x16x32_bf16 v[44:47], a[32:35], a[124:127], v[44:47]
    ds_read_b128 v[92:95], v12 offset:6144
    v_mfma_f32_16x16x32_bf16 v[20:23], a[36:39], a[96:99], v[20:23]
    ds_read_b128 v[124:127], v243 offset:6144
    v_mfma_f32_16x16x32_bf16 v[24:27], a[36:39], a[100:103], v[24:27]
    ds_read_b128 v[96:99], v12 offset:8192
    v_mfma_f32_16x16x32_bf16 v[28:31], a[36:39], a[104:107], v[28:31]
    ds_read_b128 v[128:131], v243 offset:8192
    v_mfma_f32_16x16x32_bf16 v[32:35], a[36:39], a[108:111], v[32:35]
    ds_read_b128 v[100:103], v12 offset:10240
    v_mfma_f32_16x16x32_bf16 v[36:39], a[36:39], a[112:115], v[36:39]
    ds_read_b128 v[132:135], v243 offset:10240
    v_mfma_f32_16x16x32_bf16 v[40:43], a[36:39], a[116:119], v[40:43]
    ds_read_b128 v[104:107], v12 offset:12288
    v_mfma_f32_16x16x32_bf16 v[44:47], a[36:39], a[120:123], v[44:47]
    ds_read_b128 v[136:139], v243 offset:12288
    v_mfma_f32_16x16x32_bf16 v[24:27], a[40:43], a[96:99], v[24:27]
    ds_read_b128 v[108:111], v12 offset:14336
    v_mfma_f32_16x16x32_bf16 v[28:31], a[40:43], a[100:103], v[28:31]
    ds_read_b128 v[140:143], v243 offset:14336
    v_mfma_f32_16x16x32_bf16 v[32:35], a[40:43], a[104:107], v[32:35]
    s_waitcnt lgkmcnt(10)
    v_fma_f32 v80, v144, v80, v112
    v_mfma_f32_16x16x32_bf16 v[36:39], a[40:43], a[108:111], v[36:39]
    v_fma_f32 v81, v145, v81, v113
    v_fma_f32 v82, v146, v82, v114
    v_mfma_f32_16x16x32_bf16 v[40:43], a[40:43], a[112:115], v[40:43]
    v_fma_f32 v83, v147, v83, v115
    s_waitcnt lgkmcnt(8)
    v_fma_f32 v84, v148, v84, v116
    v_mfma_f32_16x16x32_bf16 v[44:47], a[40:43], a[116:119], v[44:47]
    v_fma_f32 v85, v149, v85, v117
    v_mfma_f32_16x16x32_bf16 v[28:31], a[44:47], a[96:99], v[28:31]
    v_fma_f32 v86, v150, v86, v118
    v_fma_f32 v87, v151, v87, v119
    v_mfma_f32_16x16x32_bf16 v[32:35], a[44:47], a[100:103], v[32:35]
    s_waitcnt lgkmcnt(6)
    v_fma_f32 v88, v152, v88, v120
    v_fma_f32 v89, v153, v89, v121
    v_mfma_f32_16x16x32_bf16 v[36:39], a[44:47], a[104:107], v[36:39]
    v_fma_f32 v90, v154, v90, v122
    v_fma_f32 v91, v155, v91, v123
    v_mfma_f32_16x16x32_bf16 v[40:43], a[44:47], a[108:111], v[40:43]
    s_waitcnt lgkmcnt(4)
    v_fma_f32 v92, v156, v92, v124
    v_mfma_f32_16x16x32_bf16 v[44:47], a[44:47], a[112:115], v[44:47]
    v_fma_f32 v93, v157, v93, v125
    v_fma_f32 v94, v158, v94, v126
    v_mfma_f32_16x16x32_bf16 v[32:35], a[48:51], a[96:99], v[32:35]
    v_fma_f32 v95, v159, v95, v127
    s_waitcnt lgkmcnt(2)
    v_fma_f32 v96, v160, v96, v128
    v_mfma_f32_16x16x32_bf16 v[36:39], a[48:51], a[100:103], v[36:39]
    v_fma_f32 v97, v161, v97, v129
    v_fma_f32 v98, v162, v98, v130
    v_mfma_f32_16x16x32_bf16 v[40:43], a[48:51], a[104:107], v[40:43]
    v_fma_f32 v99, v163, v99, v131
    v_mfma_f32_16x16x32_bf16 v[44:47], a[48:51], a[108:111], v[44:47]
    s_waitcnt lgkmcnt(0)
    v_fma_f32 v100, v164, v100, v132
    v_fma_f32 v101, v165, v101, v133
    v_mfma_f32_16x16x32_bf16 v[36:39], a[52:55], a[96:99], v[36:39]
    v_fma_f32 v102, v166, v102, v134
    v_fma_f32 v103, v167, v103, v135
    v_mfma_f32_16x16x32_bf16 v[40:43], a[52:55], a[100:103], v[40:43]
    s_waitcnt lgkmcnt(0)
    v_fma_f32 v104, v168, v104, v136
    v_fma_f32 v105, v169, v105, v137
    v_mfma_f32_16x16x32_bf16 v[44:47], a[52:55], a[104:107], v[44:47]
    v_fma_f32 v106, v170, v106, v138
    v_mfma_f32_16x16x32_bf16 v[40:43], a[56:59], a[96:99], v[40:43]
    v_fma_f32 v107, v171, v107, v139
    s_waitcnt lgkmcnt(0)
    v_fma_f32 v108, v172, v108, v140
    v_mfma_f32_16x16x32_bf16 v[44:47], a[56:59], a[100:103], v[44:47]
    v_fma_f32 v109, v173, v109, v141
    v_fma_f32 v110, v174, v110, v142
    v_mfma_f32_16x16x32_bf16 v[44:47], a[60:63], a[96:99], v[44:47]
    v_fma_f32 v111, v175, v111, v143
    s_waitcnt lgkmcnt(0)
    v_pk_fma_f32 v[80:81], v[80:81], v[226:227], v[228:229] op_sel_hi:[1,0,0]
    v_pk_fma_f32 v[82:83], v[82:83], v[226:227], v[228:229] op_sel_hi:[1,0,0]
    v_pk_fma_f32 v[84:85], v[84:85], v[226:227], v[228:229] op_sel_hi:[1,0,0]
    v_pk_fma_f32 v[86:87], v[86:87], v[226:227], v[228:229] op_sel_hi:[1,0,0]
    v_pk_fma_f32 v[88:89], v[88:89], v[226:227], v[228:229] op_sel_hi:[1,0,0]
    v_pk_fma_f32 v[90:91], v[90:91], v[226:227], v[228:229] op_sel_hi:[1,0,0]
    v_pk_fma_f32 v[92:93], v[92:93], v[226:227], v[228:229] op_sel_hi:[1,0,0]
    v_pk_fma_f32 v[94:95], v[94:95], v[226:227], v[228:229] op_sel_hi:[1,0,0]
    v_pk_fma_f32 v[96:97], v[96:97], v[226:227], v[228:229] op_sel_hi:[1,0,0]
    v_pk_fma_f32 v[98:99], v[98:99], v[226:227], v[228:229] op_sel_hi:[1,0,0]
    v_pk_fma_f32 v[100:101], v[100:101], v[226:227], v[228:229] op_sel_hi:[1,0,0]
    v_pk_fma_f32 v[102:103], v[102:103], v[226:227], v[228:229] op_sel_hi:[1,0,0]
    v_pk_fma_f32 v[104:105], v[104:105], v[226:227], v[228:229] op_sel_hi:[1,0,0]
    v_pk_fma_f32 v[106:107], v[106:107], v[226:227], v[228:229] op_sel_hi:[1,0,0]
    v_pk_fma_f32 v[108:109], v[108:109], v[226:227], v[228:229] op_sel_hi:[1,0,0]
    v_pk_fma_f32 v[110:111], v[110:111], v[226:227], v[228:229] op_sel_hi:[1,0,0]
    v_add_u32 v11, s9, v15
    s_nop 3
    v_pk_add_f32 v[16:17], v[16:17], v[48:49]
    v_pk_add_f32 v[18:19], v[18:19], v[50:51]
    v_pk_add_f32 v[20:21], v[20:21], v[52:53]
    v_pk_add_f32 v[22:23], v[22:23], v[54:55]
    v_pk_fma_f32 v[16:17], v[80:81], v[16:17], v[144:145]
    v_pk_fma_f32 v[18:19], v[82:83], v[18:19], v[146:147]
    v_pk_fma_f32 v[20:21], v[84:85], v[20:21], v[148:149]
    v_pk_fma_f32 v[22:23], v[86:87], v[22:23], v[150:151]
    v_pk_mul_f32 v[48:49], v[16:17], v[230:231] op_sel_hi:[1,0]
    v_pk_mul_f32 v[50:51], v[18:19], v[230:231] op_sel_hi:[1,0]
    v_pk_mul_f32 v[52:53], v[20:21], v[230:231] op_sel_hi:[1,0]
    v_pk_mul_f32 v[54:55], v[22:23], v[230:231] op_sel_hi:[1,0]
    v_cvt_pk_bf16_f32 v112, v48, v49
    v_cvt_pk_bf16_f32 v113, v50, v51
    v_cvt_pk_bf16_f32 v114, v52, v53
    v_cvt_pk_bf16_f32 v115, v54, v55
    s_nop 1
    v_permlane16_swap_b32 v112, v114
    v_permlane16_swap_b32 v113, v115
    global_store_dwordx4 v10, v[112:115], s[16:17] offset:0 sc1
    v_pk_add_f32 v[24:25], v[24:25], v[56:57]
    v_pk_add_f32 v[26:27], v[26:27], v[58:59]
    v_pk_add_f32 v[28:29], v[28:29], v[60:61]
    v_pk_add_f32 v[30:31], v[30:31], v[62:63]
    v_pk_fma_f32 v[24:25], v[88:89], v[24:25], v[152:153]
    v_pk_fma_f32 v[26:27], v[90:91], v[26:27], v[154:155]
    v_pk_fma_f32 v[28:29], v[92:93], v[28:29], v[156:157]
    v_pk_fma_f32 v[30:31], v[94:95], v[30:31], v[158:159]
    v_pk_mul_f32 v[56:57], v[24:25], v[230:231] op_sel_hi:[1,0]
    v_pk_mul_f32 v[58:59], v[26:27], v[230:231] op_sel_hi:[1,0]
    v_pk_mul_f32 v[60:61], v[28:29], v[230:231] op_sel_hi:[1,0]
    v_pk_mul_f32 v[62:63], v[30:31], v[230:231] op_sel_hi:[1,0]
    v_cvt_pk_bf16_f32 v116, v56, v57
    v_cvt_pk_bf16_f32 v117, v58, v59
    v_cvt_pk_bf16_f32 v118, v60, v61
    v_cvt_pk_bf16_f32 v119, v62, v63
    s_nop 1
    v_permlane16_swap_b32 v116, v118
    v_permlane16_swap_b32 v117, v119
    global_store_dwordx4 v10, v[116:119], s[16:17] offset:1024 sc1
    v_pk_add_f32 v[32:33], v[32:33], v[64:65]
    v_pk_add_f32 v[34:35], v[34:35], v[66:67]
    v_pk_add_f32 v[36:37], v[36:37], v[68:69]
    v_pk_add_f32 v[38:39], v[38:39], v[70:71]
    v_pk_fma_f32 v[32:33], v[96:97], v[32:33], v[160:161]
    v_pk_fma_f32 v[34:35], v[98:99], v[34:35], v[162:163]
    v_pk_fma_f32 v[36:37], v[100:101], v[36:37], v[164:165]
    v_pk_fma_f32 v[38:39], v[102:103], v[38:39], v[166:167]
    v_pk_mul_f32 v[64:65], v[32:33], v[230:231] op_sel_hi:[1,0]
    v_pk_mul_f32 v[66:67], v[34:35], v[230:231] op_sel_hi:[1,0]
    v_pk_mul_f32 v[68:69], v[36:37], v[230:231] op_sel_hi:[1,0]
    v_pk_mul_f32 v[70:71], v[38:39], v[230:231] op_sel_hi:[1,0]
    v_cvt_pk_bf16_f32 v120, v64, v65
    v_cvt_pk_bf16_f32 v121, v66, v67
    v_cvt_pk_bf16_f32 v122, v68, v69
    v_cvt_pk_bf16_f32 v123, v70, v71
    s_nop 1
    v_permlane16_swap_b32 v120, v122
    v_permlane16_swap_b32 v121, v123
    global_store_dwordx4 v10, v[120:123], s[16:17] offset:2048 sc1
    v_pk_add_f32 v[40:41], v[40:41], v[72:73]
    v_pk_add_f32 v[42:43], v[42:43], v[74:75]
    v_pk_add_f32 v[44:45], v[44:45], v[76:77]
    v_pk_add_f32 v[46:47], v[46:47], v[78:79]
    v_pk_fma_f32 v[40:41], v[104:105], v[40:41], v[168:169]
    v_pk_fma_f32 v[42:43], v[106:107], v[42:43], v[170:171]
    v_pk_fma_f32 v[44:45], v[108:109], v[44:45], v[172:173]
    v_pk_fma_f32 v[46:47], v[110:111], v[46:47], v[174:175]
    v_pk_mul_f32 v[72:73], v[40:41], v[230:231] op_sel_hi:[1,0]
    v_pk_mul_f32 v[74:75], v[42:43], v[230:231] op_sel_hi:[1,0]
    v_pk_mul_f32 v[76:77], v[44:45], v[230:231] op_sel_hi:[1,0]
    v_pk_mul_f32 v[78:79], v[46:47], v[230:231] op_sel_hi:[1,0]
    v_cvt_pk_bf16_f32 v124, v72, v73
    v_cvt_pk_bf16_f32 v125, v74, v75
    v_cvt_pk_bf16_f32 v126, v76, v77
    v_cvt_pk_bf16_f32 v127, v78, v79
    s_nop 1
    v_permlane16_swap_b32 v124, v126
    v_permlane16_swap_b32 v125, v127
    global_store_dwordx4 v10, v[124:127], s[16:17] offset:3072 sc1
    v_cvt_pk_bf16_f32 v128, v16, v17
    v_cvt_pk_bf16_f32 v129, v18, v19
    v_cvt_pk_bf16_f32 v130, v20, v21
    v_cvt_pk_bf16_f32 v131, v22, v23
    v_cvt_pk_bf16_f32 v132, v24, v25
    v_cvt_pk_bf16_f32 v133, v26, v27
    v_cvt_pk_bf16_f32 v134, v28, v29
    v_cvt_pk_bf16_f32 v135, v30, v31
    v_cvt_pk_bf16_f32 v136, v32, v33
    v_cvt_pk_bf16_f32 v137, v34, v35
    v_cvt_pk_bf16_f32 v138, v36, v37
    v_cvt_pk_bf16_f32 v139, v38, v39
    v_cvt_pk_bf16_f32 v140, v40, v41
    v_cvt_pk_bf16_f32 v141, v42, v43
    v_cvt_pk_bf16_f32 v142, v44, v45
    v_cvt_pk_bf16_f32 v143, v46, v47
    v_permlane16_swap_b32 v128, v130
    v_permlane16_swap_b32 v129, v131
    global_store_dwordx4 v10, v[128:131], s[14:15] offset:0 sc1
    v_permlane16_swap_b32 v132, v134
    v_permlane16_swap_b32 v133, v135
    global_store_dwordx4 v10, v[132:135], s[14:15] offset:1024 sc1
    v_permlane16_swap_b32 v136, v138
    v_permlane16_swap_b32 v137, v139
    global_store_dwordx4 v10, v[136:139], s[14:15] offset:2048 sc1
    v_permlane16_swap_b32 v140, v142
    v_permlane16_swap_b32 v141, v143
    global_store_dwordx4 v10, v[140:143], s[14:15] offset:3072 sc1
    s_branch g1_3
aux_2:
    s_load_dwordx2 s[4:5], s[0:1], 0
    s_load_dwordx4 s[36:39], s[0:1], 56
    s_load_dwordx2 s[6:7], s[0:1], 72
    s_load_dwordx4 s[40:43], s[0:1], 80
    s_sub_u32 s8, s2, 160
    s_mov_b32 s44, s8
    v_lshlrev_b32 v9, 4, v0
    s_waitcnt lgkmcnt(0)
    s_cmp_ge_u32 s8, 82
    s_cbranch_scc1 aux_wd_22
    s_cmp_ge_u32 s8, 50
    s_cbranch_scc1 aux_st_15
aux_mod_23:
    s_lshl_b32 s14, s3, 3
    v_lshrrev_b32 v2, 3, v0
    v_add_u32 v2, s14, v2
    v_mul_u32_u24 v3, 40, v2
    global_load_dwordx4 v[180:183], v3, s[40:41]
    global_load_dwordx4 v[184:187], v3, s[40:41] offset:16
    global_load_dwordx2 v[188:189], v3, s[40:41] offset:32
    v_mul_u32_u24 v2, 153600, v2
    v_and_b32 v3, 7, v0
    v_lshl_add_u32 v2, v3, 4, v2
    s_lshl_b32 s16, s44, 7
    s_add_u32 s14, s42, s16
    s_addc_u32 s15, s43, 0
    global_load_dwordx4 v[100:103], v2, s[14:15] nt
    s_add_u32 s14, s14, 7680
    s_addc_u32 s15, s15, 0
    global_load_dwordx4 v[104:107], v2, s[14:15] nt
    s_add_u32 s14, s14, 7680
    s_addc_u32 s15, s15, 0
    global_load_dwordx4 v[108:111], v2, s[14:15] nt
    s_add_u32 s14, s14, 7680
    s_addc_u32 s15, s15, 0
    global_load_dwordx4 v[112:115], v2, s[14:15] nt
    s_add_u32 s14, s14, 7680
    s_addc_u32 s15, s15, 0
    global_load_dwordx4 v[116:119], v2, s[14:15] nt
    s_add_u32 s14, s14, 7680
    s_addc_u32 s15, s15, 0
    global_load_dwordx4 v[120:123], v2, s[14:15] nt
    s_add_u32 s14, s14, 7680
    s_addc_u32 s15, s15, 0
    global_load_dwordx4 v[124:127], v2, s[14:15] nt
    s_add_u32 s14, s14, 7680
    s_addc_u32 s15, s15, 0
    global_load_dwordx4 v[128:131], v2, s[14:15] nt
    s_add_u32 s14, s14, 7680
    s_addc_u32 s15, s15, 0
    global_load_dwordx4 v[132:135], v2, s[14:15] nt
    s_add_u32 s14, s14, 7680
    s_addc_u32 s15, s15, 0
    global_load_dwordx4 v[136:139], v2, s[14:15] nt
    s_add_u32 s14, s14, 7680
    s_addc_u32 s15, s15, 0
    s_waitcnt vmcnt(10)
    v_lshlrev_b32 v17, 16, v180
    v_and_b32 v19, s69, v180
    v_lshlrev_b32 v21, 16, v181
    v_and_b32 v23, s69, v181
    v_lshlrev_b32 v25, 16, v182
    v_and_b32 v27, s69, v182
    v_lshlrev_b32 v29, 16, v183
    v_and_b32 v31, s69, v183
    v_lshlrev_b32 v33, 16, v184
    v_and_b32 v35, s69, v184
    v_lshlrev_b32 v37, 16, v185
    v_and_b32 v39, s69, v185
    v_lshlrev_b32 v41, 16, v186
    v_and_b32 v43, s69, v186
    v_lshlrev_b32 v45, 16, v187
    v_and_b32 v47, s69, v187
    v_lshlrev_b32 v49, 16, v188
    v_and_b32 v51, s69, v188
    v_lshlrev_b32 v53, 16, v189
    v_and_b32 v55, s69, v189
    v_mul_f32 v16, 0xbfb8aa3b, v17
    v_mul_f32 v18, 0xbfb8aa3b, v19
    v_mul_f32 v20, 0xbfb8aa3b, v21
    v_mul_f32 v22, 0xbfb8aa3b, v23
    v_mul_f32 v24, 0xbfb8aa3b, v25
    v_mul_f32 v26, 0xbfb8aa3b, v27
    v_mul_f32 v28, 0xbfb8aa3b, v29
    v_mul_f32 v30, 0xbfb8aa3b, v31
    v_mul_f32 v32, 0xbfb8aa3b, v33
    v_mul_f32 v34, 0xbfb8aa3b, v35
    v_mul_f32 v36, 0xbfb8aa3b, v37
    v_mul_f32 v38, 0xbfb8aa3b, v39
    v_mul_f32 v40, 0xbfb8aa3b, v41
    v_mul_f32 v42, 0xbfb8aa3b, v43
    v_mul_f32 v44, 0xbfb8aa3b, v45
    v_mul_f32 v46, 0xbfb8aa3b, v47
    v_mul_f32 v48, 0xbfb8aa3b, v49
    v_mul_f32 v50, 0xbfb8aa3b, v51
    v_mul_f32 v52, 0xbfb8aa3b, v53
    v_mul_f32 v54, 0xbfb8aa3b, v55
    v_exp_f32 v16, v16
    v_exp_f32 v18, v18
    v_exp_f32 v20, v20
    v_exp_f32 v22, v22
    v_exp_f32 v24, v24
    v_exp_f32 v26, v26
    v_exp_f32 v28, v28
    v_exp_f32 v30, v30
    v_exp_f32 v32, v32
    v_exp_f32 v34, v34
    v_exp_f32 v36, v36
    v_exp_f32 v38, v38
    v_exp_f32 v40, v40
    v_exp_f32 v42, v42
    v_exp_f32 v44, v44
    v_exp_f32 v46, v46
    v_exp_f32 v48, v48
    v_exp_f32 v50, v50
    v_exp_f32 v52, v52
    v_exp_f32 v54, v54
    v_add_f32 v16, 1.0, v16
    v_add_f32 v18, 1.0, v18
    v_add_f32 v20, 1.0, v20
    v_add_f32 v22, 1.0, v22
    v_add_f32 v24, 1.0, v24
    v_add_f32 v26, 1.0, v26
    v_add_f32 v28, 1.0, v28
    v_add_f32 v30, 1.0, v30
    v_add_f32 v32, 1.0, v32
    v_add_f32 v34, 1.0, v34
    v_add_f32 v36, 1.0, v36
    v_add_f32 v38, 1.0, v38
    v_add_f32 v40, 1.0, v40
    v_add_f32 v42, 1.0, v42
    v_add_f32 v44, 1.0, v44
    v_add_f32 v46, 1.0, v46
    v_add_f32 v48, 1.0, v48
    v_add_f32 v50, 1.0, v50
    v_add_f32 v52, 1.0, v52
    v_add_f32 v54, 1.0, v54
    v_rcp_f32 v16, v16
    v_rcp_f32 v18, v18
    v_rcp_f32 v20, v20
    v_rcp_f32 v22, v22
    v_rcp_f32 v24, v24
    v_rcp_f32 v26, v26
    v_rcp_f32 v28, v28
    v_rcp_f32 v30, v30
    v_rcp_f32 v32, v32
    v_rcp_f32 v34, v34
    v_rcp_f32 v36, v36
    v_rcp_f32 v38, v38
    v_rcp_f32 v40, v40
    v_rcp_f32 v42, v42
    v_rcp_f32 v44, v44
    v_rcp_f32 v46, v46
    v_rcp_f32 v48, v48
    v_rcp_f32 v50, v50
    v_rcp_f32 v52, v52
    v_rcp_f32 v54, v54
    v_mul_f32 v16, v17, v16
    v_mul_f32 v18, v19, v18
    v_mul_f32 v20, v21, v20
    v_mul_f32 v22, v23, v22
    v_mul_f32 v24, v25, v24
    v_mul_f32 v26, v27, v26
    v_mul_f32 v28, v29, v28
    v_mul_f32 v30, v31, v30
    v_mul_f32 v32, v33, v32
    v_mul_f32 v34, v35, v34
    v_mul_f32 v36, v37, v36
    v_mul_f32 v38, v39, v38
    v_mul_f32 v40, v41, v40
    v_mul_f32 v42, v43, v42
    v_mul_f32 v44, v45, v44
    v_mul_f32 v46, v47, v46
    v_mul_f32 v48, v49, v48
    v_mul_f32 v50, v51, v50
    v_mul_f32 v52, v53, v52
    v_mul_f32 v54, v55, v54
    v_cvt_pk_bf16_f32 v17, v16, v18
    v_cvt_pk_bf16_f32 v21, v20, v22
    v_cvt_pk_bf16_f32 v25, v24, v26
    v_cvt_pk_bf16_f32 v29, v28, v30
    v_cvt_pk_bf16_f32 v33, v32, v34
    v_cvt_pk_bf16_f32 v37, v36, v38
    v_cvt_pk_bf16_f32 v41, v40, v42
    v_cvt_pk_bf16_f32 v45, v44, v46
    v_cvt_pk_bf16_f32 v49, v48, v50
    v_cvt_pk_bf16_f32 v53, v52, v54
    v_lshlrev_b32 v16, 16, v17
    v_and_b32 v18, s69, v17
    v_lshlrev_b32 v20, 16, v21
    v_and_b32 v22, s69, v21
    v_lshlrev_b32 v24, 16, v25
    v_and_b32 v26, s69, v25
    v_lshlrev_b32 v28, 16, v29
    v_and_b32 v30, s69, v29
    v_lshlrev_b32 v32, 16, v33
    v_and_b32 v34, s69, v33
    v_lshlrev_b32 v36, 16, v37
    v_and_b32 v38, s69, v37
    v_lshlrev_b32 v40, 16, v41
    v_and_b32 v42, s69, v41
    v_lshlrev_b32 v44, 16, v45
    v_and_b32 v46, s69, v45
    v_lshlrev_b32 v48, 16, v49
    v_and_b32 v50, s69, v49
    v_lshlrev_b32 v52, 16, v53
    v_and_b32 v54, s69, v53
    global_load_dwordx4 v[140:143], v2, s[14:15] nt
    s_add_u32 s14, s14, 7680
    s_addc_u32 s15, s15, 0
    global_load_dwordx4 v[144:147], v2, s[14:15] nt
    s_add_u32 s14, s14, 7680
    s_addc_u32 s15, s15, 0
    global_load_dwordx4 v[148:151], v2, s[14:15] nt
    s_add_u32 s14, s14, 7680
    s_addc_u32 s15, s15, 0
    global_load_dwordx4 v[152:155], v2, s[14:15] nt
    s_add_u32 s14, s14, 7680
    s_addc_u32 s15, s15, 0
    global_load_dwordx4 v[156:159], v2, s[14:15] nt
    s_add_u32 s14, s14, 7680
    s_addc_u32 s15, s15, 0
    global_load_dwordx4 v[160:163], v2, s[14:15] nt
    s_add_u32 s14, s14, 7680
    s_addc_u32 s15, s15, 0
    global_load_dwordx4 v[164:167], v2, s[14:15] nt
    s_add_u32 s14, s14, 7680
    s_addc_u32 s15, s15, 0
    global_load_dwordx4 v[168:171], v2, s[14:15] nt
    s_add_u32 s14, s14, 7680
    s_addc_u32 s15, s15, 0
    global_load_dwordx4 v[172:175], v2, s[14:15] nt
    s_add_u32 s14, s14, 7680
    s_addc_u32 s15, s15, 0
    global_load_dwordx4 v[176:179], v2, s[14:15] nt
    v_mov_b32 v214, 0
    s_mov_b64 exec, 1
    global_load_dwordx2 v[212:213], v214, s[72:73] sc1
    s_mov_b64 exec, -1
    s_waitcnt vmcnt(20)
    v_lshlrev_b32 v64, 16, v100
    v_and_b32 v65, s69, v100
    v_lshlrev_b32 v66, 16, v101
    v_and_b32 v67, s69, v101
    v_lshlrev_b32 v68, 16, v102
    v_and_b32 v69, s69, v102
    v_lshlrev_b32 v70, 16, v103
    v_and_b32 v71, s69, v103
    v_pk_mul_f32 v[56:57], v[64:65], v[16:17] op_sel_hi:[1,0]
    v_pk_mul_f32 v[58:59], v[66:67], v[16:17] op_sel_hi:[1,0]
    v_pk_mul_f32 v[60:61], v[68:69], v[16:17] op_sel_hi:[1,0]
    v_pk_mul_f32 v[62:63], v[70:71], v[16:17] op_sel_hi:[1,0]
    s_waitcnt vmcnt(19)
    v_lshlrev_b32 v72, 16, v104
    v_and_b32 v73, s69, v104
    v_lshlrev_b32 v74, 16, v105
    v_and_b32 v75, s69, v105
    v_lshlrev_b32 v76, 16, v106
    v_and_b32 v77, s69, v106
    v_lshlrev_b32 v78, 16, v107
    v_and_b32 v79, s69, v107
    v_pk_fma_f32 v[56:57], v[72:73], v[18:19], v[56:57] op_sel_hi:[1,0,1]
    v_pk_fma_f32 v[58:59], v[74:75], v[18:19], v[58:59] op_sel_hi:[1,0,1]
    v_pk_fma_f32 v[60:61], v[76:77], v[18:19], v[60:61] op_sel_hi:[1,0,1]
    v_pk_fma_f32 v[62:63], v[78:79], v[18:19], v[62:63] op_sel_hi:[1,0,1]
    s_waitcnt vmcnt(18)
    v_lshlrev_b32 v64, 16, v108
    v_and_b32 v65, s69, v108
    v_lshlrev_b32 v66, 16, v109
    v_and_b32 v67, s69, v109
    v_lshlrev_b32 v68, 16, v110
    v_and_b32 v69, s69, v110
    v_lshlrev_b32 v70, 16, v111
    v_and_b32 v71, s69, v111
    v_pk_fma_f32 v[56:57], v[64:65], v[20:21], v[56:57] op_sel_hi:[1,0,1]
    v_pk_fma_f32 v[58:59], v[66:67], v[20:21], v[58:59] op_sel_hi:[1,0,1]
    v_pk_fma_f32 v[60:61], v[68:69], v[20:21], v[60:61] op_sel_hi:[1,0,1]
    v_pk_fma_f32 v[62:63], v[70:71], v[20:21], v[62:63] op_sel_hi:[1,0,1]
    s_waitcnt vmcnt(17)
    v_lshlrev_b32 v72, 16, v112
    v_and_b32 v73, s69, v112
    v_lshlrev_b32 v74, 16, v113
    v_and_b32 v75, s69, v113
    v_lshlrev_b32 v76, 16, v114
    v_and_b32 v77, s69, v114
    v_lshlrev_b32 v78, 16, v115
    v_and_b32 v79, s69, v115
    v_pk_fma_f32 v[56:57], v[72:73], v[22:23], v[56:57] op_sel_hi:[1,0,1]
    v_pk_fma_f32 v[58:59], v[74:75], v[22:23], v[58:59] op_sel_hi:[1,0,1]
    v_pk_fma_f32 v[60:61], v[76:77], v[22:23], v[60:61] op_sel_hi:[1,0,1]
    v_pk_fma_f32 v[62:63], v[78:79], v[22:23], v[62:63] op_sel_hi:[1,0,1]
    s_waitcnt vmcnt(16)
    v_lshlrev_b32 v64, 16, v116
    v_and_b32 v65, s69, v116
    v_lshlrev_b32 v66, 16, v117
    v_and_b32 v67, s69, v117
    v_lshlrev_b32 v68, 16, v118
    v_and_b32 v69, s69, v118
    v_lshlrev_b32 v70, 16, v119
    v_and_b32 v71, s69, v119
    v_pk_fma_f32 v[56:57], v[64:65], v[24:25], v[56:57] op_sel_hi:[1,0,1]
    v_pk_fma_f32 v[58:59], v[66:67], v[24:25], v[58:59] op_sel_hi:[1,0,1]
    v_pk_fma_f32 v[60:61], v[68:69], v[24:25], v[60:61] op_sel_hi:[1,0,1]
    v_pk_fma_f32 v[62:63], v[70:71], v[24:25], v[62:63] op_sel_hi:[1,0,1]
    s_waitcnt vmcnt(15)
    v_lshlrev_b32 v72, 16, v120
    v_and_b32 v73, s69, v120
    v_lshlrev_b32 v74, 16, v121
    v_and_b32 v75, s69, v121
    v_lshlrev_b32 v76, 16, v122
    v_and_b32 v77, s69, v122
    v_lshlrev_b32 v78, 16, v123
    v_and_b32 v79, s69, v123
    v_pk_fma_f32 v[56:57], v[72:73], v[26:27], v[56:57] op_sel_hi:[1,0,1]
    v_pk_fma_f32 v[58:59], v[74:75], v[26:27], v[58:59] op_sel_hi:[1,0,1]
    v_pk_fma_f32 v[60:61], v[76:77], v[26:27], v[60:61] op_sel_hi:[1,0,1]
    v_pk_fma_f32 v[62:63], v[78:79], v[26:27], v[62:63] op_sel_hi:[1,0,1]
    s_waitcnt vmcnt(14)
    v_lshlrev_b32 v64, 16, v124
    v_and_b32 v65, s69, v124
    v_lshlrev_b32 v66, 16, v125
    v_and_b32 v67, s69, v125
    v_lshlrev_b32 v68, 16, v126
    v_and_b32 v69, s69, v126
    v_lshlrev_b32 v70, 16, v127
    v_and_b32 v71, s69, v127
    v_pk_fma_f32 v[56:57], v[64:65], v[28:29], v[56:57] op_sel_hi:[1,0,1]
    v_pk_fma_f32 v[58:59], v[66:67], v[28:29], v[58:59] op_sel_hi:[1,0,1]
    v_pk_fma_f32 v[60:61], v[68:69], v[28:29], v[60:61] op_sel_hi:[1,0,1]
    v_pk_fma_f32 v[62:63], v[70:71], v[28:29], v[62:63] op_sel_hi:[1,0,1]
    s_waitcnt vmcnt(13)
    v_lshlrev_b32 v72, 16, v128
    v_and_b32 v73, s69, v128
    v_lshlrev_b32 v74, 16, v129
    v_and_b32 v75, s69, v129
    v_lshlrev_b32 v76, 16, v130
    v_and_b32 v77, s69, v130
    v_lshlrev_b32 v78, 16, v131
    v_and_b32 v79, s69, v131
    v_pk_fma_f32 v[56:57], v[72:73], v[30:31], v[56:57] op_sel_hi:[1,0,1]
    v_pk_fma_f32 v[58:59], v[74:75], v[30:31], v[58:59] op_sel_hi:[1,0,1]
    v_pk_fma_f32 v[60:61], v[76:77], v[30:31], v[60:61] op_sel_hi:[1,0,1]
    v_pk_fma_f32 v[62:63], v[78:79], v[30:31], v[62:63] op_sel_hi:[1,0,1]
    s_waitcnt vmcnt(12)
    v_lshlrev_b32 v64, 16, v132
    v_and_b32 v65, s69, v132
    v_lshlrev_b32 v66, 16, v133
    v_and_b32 v67, s69, v133
    v_lshlrev_b32 v68, 16, v134
    v_and_b32 v69, s69, v134
    v_lshlrev_b32 v70, 16, v135
    v_and_b32 v71, s69, v135
    v_pk_fma_f32 v[56:57], v[64:65], v[32:33], v[56:57] op_sel_hi:[1,0,1]
    v_pk_fma_f32 v[58:59], v[66:67], v[32:33], v[58:59] op_sel_hi:[1,0,1]
    v_pk_fma_f32 v[60:61], v[68:69], v[32:33], v[60:61] op_sel_hi:[1,0,1]
    v_pk_fma_f32 v[62:63], v[70:71], v[32:33], v[62:63] op_sel_hi:[1,0,1]
    s_waitcnt vmcnt(11)
    v_lshlrev_b32 v72, 16, v136
    v_and_b32 v73, s69, v136
    v_lshlrev_b32 v74, 16, v137
    v_and_b32 v75, s69, v137
    v_lshlrev_b32 v76, 16, v138
    v_and_b32 v77, s69, v138
    v_lshlrev_b32 v78, 16, v139
    v_and_b32 v79, s69, v139
    v_pk_fma_f32 v[56:57], v[72:73], v[34:35], v[56:57] op_sel_hi:[1,0,1]
    v_pk_fma_f32 v[58:59], v[74:75], v[34:35], v[58:59] op_sel_hi:[1,0,1]
    v_pk_fma_f32 v[60:61], v[76:77], v[34:35], v[60:61] op_sel_hi:[1,0,1]
    v_pk_fma_f32 v[62:63], v[78:79], v[34:35], v[62:63] op_sel_hi:[1,0,1]
    s_waitcnt vmcnt(10)
    v_lshlrev_b32 v64, 16, v140
    v_and_b32 v65, s69, v140
    v_lshlrev_b32 v66, 16, v141
    v_and_b32 v67, s69, v141
    v_lshlrev_b32 v68, 16, v142
    v_and_b32 v69, s69, v142
    v_lshlrev_b32 v70, 16, v143
    v_and_b32 v71, s69, v143
    v_pk_fma_f32 v[56:57], v[64:65], v[36:37], v[56:57] op_sel_hi:[1,0,1]
    v_pk_fma_f32 v[58:59], v[66:67], v[36:37], v[58:59] op_sel_hi:[1,0,1]
    v_pk_fma_f32 v[60:61], v[68:69], v[36:37], v[60:61] op_sel_hi:[1,0,1]
    v_pk_fma_f32 v[62:63], v[70:71], v[36:37], v[62:63] op_sel_hi:[1,0,1]
    s_waitcnt vmcnt(9)
    v_lshlrev_b32 v72, 16, v144
    v_and_b32 v73, s69, v144
    v_lshlrev_b32 v74, 16, v145
    v_and_b32 v75, s69, v145
    v_lshlrev_b32 v76, 16, v146
    v_and_b32 v77, s69, v146
    v_lshlrev_b32 v78, 16, v147
    v_and_b32 v79, s69, v147
    v_pk_fma_f32 v[56:57], v[72:73], v[38:39], v[56:57] op_sel_hi:[1,0,1]
    v_pk_fma_f32 v[58:59], v[74:75], v[38:39], v[58:59] op_sel_hi:[1,0,1]
    v_pk_fma_f32 v[60:61], v[76:77], v[38:39], v[60:61] op_sel_hi:[1,0,1]
    v_pk_fma_f32 v[62:63], v[78:79], v[38:39], v[62:63] op_sel_hi:[1,0,1]
    s_waitcnt vmcnt(8)
    v_lshlrev_b32 v64, 16, v148
    v_and_b32 v65, s69, v148
    v_lshlrev_b32 v66, 16, v149
    v_and_b32 v67, s69, v149
    v_lshlrev_b32 v68, 16, v150
    v_and_b32 v69, s69, v150
    v_lshlrev_b32 v70, 16, v151
    v_and_b32 v71, s69, v151
    v_pk_fma_f32 v[56:57], v[64:65], v[40:41], v[56:57] op_sel_hi:[1,0,1]
    v_pk_fma_f32 v[58:59], v[66:67], v[40:41], v[58:59] op_sel_hi:[1,0,1]
    v_pk_fma_f32 v[60:61], v[68:69], v[40:41], v[60:61] op_sel_hi:[1,0,1]
    v_pk_fma_f32 v[62:63], v[70:71], v[40:41], v[62:63] op_sel_hi:[1,0,1]
    s_waitcnt vmcnt(7)
    v_lshlrev_b32 v72, 16, v152
    v_and_b32 v73, s69, v152
    v_lshlrev_b32 v74, 16, v153
    v_and_b32 v75, s69, v153
    v_lshlrev_b32 v76, 16, v154
    v_and_b32 v77, s69, v154
    v_lshlrev_b32 v78, 16, v155
    v_and_b32 v79, s69, v155
    v_pk_fma_f32 v[56:57], v[72:73], v[42:43], v[56:57] op_sel_hi:[1,0,1]
    v_pk_fma_f32 v[58:59], v[74:75], v[42:43], v[58:59] op_sel_hi:[1,0,1]
    v_pk_fma_f32 v[60:61], v[76:77], v[42:43], v[60:61] op_sel_hi:[1,0,1]
    v_pk_fma_f32 v[62:63], v[78:79], v[42:43], v[62:63] op_sel_hi:[1,0,1]
    s_waitcnt vmcnt(6)
    v_lshlrev_b32 v64, 16, v156
    v_and_b32 v65, s69, v156
    v_lshlrev_b32 v66, 16, v157
    v_and_b32 v67, s69, v157
    v_lshlrev_b32 v68, 16, v158
    v_and_b32 v69, s69, v158
    v_lshlrev_b32 v70, 16, v159
    v_and_b32 v71, s69, v159
    v_pk_fma_f32 v[56:57], v[64:65], v[44:45], v[56:57] op_sel_hi:[1,0,1]
    v_pk_fma_f32 v[58:59], v[66:67], v[44:45], v[58:59] op_sel_hi:[1,0,1]
    v_pk_fma_f32 v[60:61], v[68:69], v[44:45], v[60:61] op_sel_hi:[1,0,1]
    v_pk_fma_f32 v[62:63], v[70:71], v[44:45], v[62:63] op_sel_hi:[1,0,1]
    s_waitcnt vmcnt(5)
    v_lshlrev_b32 v72, 16, v160
    v_and_b32 v73, s69, v160
    v_lshlrev_b32 v74, 16, v161
    v_and_b32 v75, s69, v161
    v_lshlrev_b32 v76, 16, v162
    v_and_b32 v77, s69, v162
    v_lshlrev_b32 v78, 16, v163
    v_and_b32 v79, s69, v163
    v_pk_fma_f32 v[56:57], v[72:73], v[46:47], v[56:57] op_sel_hi:[1,0,1]
    v_pk_fma_f32 v[58:59], v[74:75], v[46:47], v[58:59] op_sel_hi:[1,0,1]
    v_pk_fma_f32 v[60:61], v[76:77], v[46:47], v[60:61] op_sel_hi:[1,0,1]
    v_pk_fma_f32 v[62:63], v[78:79], v[46:47], v[62:63] op_sel_hi:[1,0,1]
    s_waitcnt vmcnt(4)
    v_lshlrev_b32 v64, 16, v164
    v_and_b32 v65, s69, v164
    v_lshlrev_b32 v66, 16, v165
    v_and_b32 v67, s69, v165
    v_lshlrev_b32 v68, 16, v166
    v_and_b32 v69, s69, v166
    v_lshlrev_b32 v70, 16, v167
    v_and_b32 v71, s69, v167
    v_pk_fma_f32 v[56:57], v[64:65], v[48:49], v[56:57] op_sel_hi:[1,0,1]
    v_pk_fma_f32 v[58:59], v[66:67], v[48:49], v[58:59] op_sel_hi:[1,0,1]
    v_pk_fma_f32 v[60:61], v[68:69], v[48:49], v[60:61] op_sel_hi:[1,0,1]
    v_pk_fma_f32 v[62:63], v[70:71], v[48:49], v[62:63] op_sel_hi:[1,0,1]
    s_waitcnt vmcnt(3)
    v_lshlrev_b32 v72, 16, v168
    v_and_b32 v73, s69, v168
    v_lshlrev_b32 v74, 16, v169
    v_and_b32 v75, s69, v169
    v_lshlrev_b32 v76, 16, v170
    v_and_b32 v77, s69, v170
    v_lshlrev_b32 v78, 16, v171
    v_and_b32 v79, s69, v171
    v_pk_fma_f32 v[56:57], v[72:73], v[50:51], v[56:57] op_sel_hi:[1,0,1]
    v_pk_fma_f32 v[58:59], v[74:75], v[50:51], v[58:59] op_sel_hi:[1,0,1]
    v_pk_fma_f32 v[60:61], v[76:77], v[50:51], v[60:61] op_sel_hi:[1,0,1]
    v_pk_fma_f32 v[62:63], v[78:79], v[50:51], v[62:63] op_sel_hi:[1,0,1]
    s_waitcnt vmcnt(2)
    v_lshlrev_b32 v64, 16, v172
    v_and_b32 v65, s69, v172
    v_lshlrev_b32 v66, 16, v173
    v_and_b32 v67, s69, v173
    v_lshlrev_b32 v68, 16, v174
    v_and_b32 v69, s69, v174
    v_lshlrev_b32 v70, 16, v175
    v_and_b32 v71, s69, v175
    v_pk_fma_f32 v[56:57], v[64:65], v[52:53], v[56:57] op_sel_hi:[1,0,1]
    v_pk_fma_f32 v[58:59], v[66:67], v[52:53], v[58:59] op_sel_hi:[1,0,1]
    v_pk_fma_f32 v[60:61], v[68:69], v[52:53], v[60:61] op_sel_hi:[1,0,1]
    v_pk_fma_f32 v[62:63], v[70:71], v[52:53], v[62:63] op_sel_hi:[1,0,1]
    s_waitcnt vmcnt(0)
    v_lshlrev_b32 v72, 16, v176
    v_and_b32 v73, s69, v176
    v_lshlrev_b32 v74, 16, v177
    v_and_b32 v75, s69, v177
    v_lshlrev_b32 v76, 16, v178
    v_and_b32 v77, s69, v178
    v_lshlrev_b32 v78, 16, v179
    v_and_b32 v79, s69, v179
    v_pk_fma_f32 v[56:57], v[72:73], v[54:55], v[56:57] op_sel_hi:[1,0,1]
    v_pk_fma_f32 v[58:59], v[74:75], v[54:55], v[58:59] op_sel_hi:[1,0,1]
    v_pk_fma_f32 v[60:61], v[76:77], v[54:55], v[60:61] op_sel_hi:[1,0,1]
    v_pk_fma_f32 v[62:63], v[78:79], v[54:55], v[62:63] op_sel_hi:[1,0,1]
    s_nop 1
    v_permlane32_swap_b32 v56, v60
    v_permlane32_swap_b32 v57, v61
    v_permlane32_swap_b32 v58, v62
    v_permlane32_swap_b32 v59, v63
    s_nop 0
    v_add_f32 v56, v56, v60
    v_add_f32 v57, v57, v61
    v_add_f32 v58, v58, v62
    v_add_f32 v59, v59, v63
    s_nop 1
    v_permlane16_swap_b32 v56, v58
    v_permlane16_swap_b32 v57, v59
    s_nop 0
    v_add_f32 v56, v56, v58
    v_add_f32 v57, v57, v59
    s_nop 1
    v_add_f32_dpp v56, v56, v56 row_ror:8 row_mask:0xf bank_mask:0xf
    v_add_f32_dpp v57, v57, v57 row_ror:8 row_mask:0xf bank_mask:0xf
    s_lshl_b32 s14, s3, 8
    s_add_u32 s14, s14, 159744
    v_lshrrev_b32 v4, 4, v0
    v_lshlrev_b32 v3, 5, v3
    v_lshl_add_u32 v3, v4, 3, v3
    v_add_u32 v3, s14, v3
    ds_write_b64 v3, v[56:57]
    s_waitcnt lgkmcnt(0)
    s_barrier
    s_cmp_lg_u32 s3, 0
    s_cbranch_scc1 modfin_27
    v_lshlrev_b32 v2, 2, v0
    v_add_u32 v3, 159744, v2
    ds_read2st64_b32 v[4:5], v3 offset0:0 offset1:1
    ds_read2st64_b32 v[6:7], v3 offset0:2 offset1:3
    s_lshl_b32 s14, s44, 8
    s_add_u32 s14, s14, 6246400
    v_add_u32 v2, s14, v2
    s_waitcnt lgkmcnt(0)
    v_pk_add_f32 v[4:5], v[4:5], v[6:7]
    s_nop 0
    v_add_f32 v4, v4, v5
    v_cvt_pk_bf16_f32 v4, v4, v4
    v_lshlrev_b32 v4, 16, v4
    global_store_dword v2, v4, s[12:13] sc1
modfin_27:
    s_cmp_ge_u32 s8, 82
    s_cbranch_scc1 aux_gbd_24
    s_branch aux2_16
aux_st_15:
    s_sub_u32 s45, s8, 50
    s_lshl_b32 s45, s45, 6
    s_lshl_b32 s14, s3, 4
    s_add_u32 s14, s14, s45
    s_mul_i32 s14, s14, 1280
    v_lshrrev_b32 v180, 4, v0
    v_mul_u32_u24 v180, 1024, v180
    v_lshl_add_u32 v180, v0, 4, v180
    s_add_u32 s14, s4, s14
    s_addc_u32 s15, s5, 0
    global_load_dwordx4 v[100:103], v180, s[14:15] offset:0 nt
    global_load_dwordx4 v[104:107], v180, s[14:15] offset:256 nt
    global_load_dwordx4 v[108:111], v180, s[14:15] offset:512 nt
    global_load_dwordx4 v[112:115], v180, s[14:15] offset:768 nt
    global_load_dwordx4 v[116:119], v180, s[14:15] offset:1024 nt
    s_add_u32 s14, s14, 5120
    s_addc_u32 s15, s15, 0
    global_load_dwordx4 v[120:123], v180, s[14:15] offset:0 nt
    global_load_dwordx4 v[124:127], v180, s[14:15] offset:256 nt
    global_load_dwordx4 v[128:131], v180, s[14:15] offset:512 nt
    global_load_dwordx4 v[132:135], v180, s[14:15] offset:768 nt
    global_load_dwordx4 v[136:139], v180, s[14:15] offset:1024 nt
    s_add_u32 s14, s14, 5120
    s_addc_u32 s15, s15, 0
    global_load_dwordx4 v[140:143], v180, s[14:15] offset:0 nt
    global_load_dwordx4 v[144:147], v180, s[14:15] offset:256 nt
    global_load_dwordx4 v[148:151], v180, s[14:15] offset:512 nt
    global_load_dwordx4 v[152:155], v180, s[14:15] offset:768 nt
    global_load_dwordx4 v[156:159], v180, s[14:15] offset:1024 nt
    s_add_u32 s14, s14, 5120
    s_addc_u32 s15, s15, 0
    global_load_dwordx4 v[160:163], v180, s[14:15] offset:0 nt
    global_load_dwordx4 v[164:167], v180, s[14:15] offset:256 nt
    global_load_dwordx4 v[168:171], v180, s[14:15] offset:512 nt
    global_load_dwordx4 v[172:175], v180, s[14:15] offset:768 nt
    global_load_dwordx4 v[176:179], v180, s[14:15] offset:1024 nt
    v_mov_b32 v214, 0
    s_mov_b64 exec, 1
    global_load_dwordx2 v[212:213], v214, s[72:73] sc1
    s_mov_b64 exec, -1
    s_mov_b32 s14, 0x3f803f80
    s_waitcnt vmcnt(11)
    v_dot2_f32_bf16 v180, v100, s14, 0
    v_dot2_f32_bf16 v181, v100, v100, 0
    v_dot2_f32_bf16 v182, v120, s14, 0
    v_dot2_f32_bf16 v183, v120, v120, 0
    v_dot2_f32_bf16 v180, v101, s14, v180
    v_dot2_f32_bf16 v181, v101, v101, v181
    v_dot2_f32_bf16 v182, v121, s14, v182
    v_dot2_f32_bf16 v183, v121, v121, v183
    v_dot2_f32_bf16 v180, v102, s14, v180
    v_dot2_f32_bf16 v181, v102, v102, v181
    v_dot2_f32_bf16 v182, v122, s14, v182
    v_dot2_f32_bf16 v183, v122, v122, v183
    v_dot2_f32_bf16 v180, v103, s14, v180
    v_dot2_f32_bf16 v181, v103, v103, v181
    v_dot2_f32_bf16 v182, v123, s14, v182
    v_dot2_f32_bf16 v183, v123, v123, v183
    v_dot2_f32_bf16 v180, v104, s14, v180
    v_dot2_f32_bf16 v181, v104, v104, v181
    v_dot2_f32_bf16 v182, v124, s14, v182
    v_dot2_f32_bf16 v183, v124, v124, v183
    v_dot2_f32_bf16 v180, v105, s14, v180
    v_dot2_f32_bf16 v181, v105, v105, v181
    v_dot2_f32_bf16 v182, v125, s14, v182
    v_dot2_f32_bf16 v183, v125, v125, v183
    v_dot2_f32_bf16 v180, v106, s14, v180
    v_dot2_f32_bf16 v181, v106, v106, v181
    v_dot2_f32_bf16 v182, v126, s14, v182
    v_dot2_f32_bf16 v183, v126, v126, v183
    v_dot2_f32_bf16 v180, v107, s14, v180
    v_dot2_f32_bf16 v181, v107, v107, v181
    v_dot2_f32_bf16 v182, v127, s14, v182
    v_dot2_f32_bf16 v183, v127, v127, v183
    v_dot2_f32_bf16 v180, v108, s14, v180
    v_dot2_f32_bf16 v181, v108, v108, v181
    v_dot2_f32_bf16 v182, v128, s14, v182
    v_dot2_f32_bf16 v183, v128, v128, v183
    v_dot2_f32_bf16 v180, v109, s14, v180
    v_dot2_f32_bf16 v181, v109, v109, v181
    v_dot2_f32_bf16 v182, v129, s14, v182
    v_dot2_f32_bf16 v183, v129, v129, v183
    v_dot2_f32_bf16 v180, v110, s14, v180
    v_dot2_f32_bf16 v181, v110, v110, v181
    v_dot2_f32_bf16 v182, v130, s14, v182
    v_dot2_f32_bf16 v183, v130, v130, v183
    v_dot2_f32_bf16 v180, v111, s14, v180
    v_dot2_f32_bf16 v181, v111, v111, v181
    v_dot2_f32_bf16 v182, v131, s14, v182
    v_dot2_f32_bf16 v183, v131, v131, v183
    v_dot2_f32_bf16 v180, v112, s14, v180
    v_dot2_f32_bf16 v181, v112, v112, v181
    v_dot2_f32_bf16 v182, v132, s14, v182
    v_dot2_f32_bf16 v183, v132, v132, v183
    v_dot2_f32_bf16 v180, v113, s14, v180
    v_dot2_f32_bf16 v181, v113, v113, v181
    v_dot2_f32_bf16 v182, v133, s14, v182
    v_dot2_f32_bf16 v183, v133, v133, v183
    v_dot2_f32_bf16 v180, v114, s14, v180
    v_dot2_f32_bf16 v181, v114, v114, v181
    v_dot2_f32_bf16 v182, v134, s14, v182
    v_dot2_f32_bf16 v183, v134, v134, v183
    v_dot2_f32_bf16 v180, v115, s14, v180
    v_dot2_f32_bf16 v181, v115, v115, v181
    v_dot2_f32_bf16 v182, v135, s14, v182
    v_dot2_f32_bf16 v183, v135, v135, v183
    v_dot2_f32_bf16 v180, v116, s14, v180
    v_dot2_f32_bf16 v181, v116, v116, v181
    v_dot2_f32_bf16 v182, v136, s14, v182
    v_dot2_f32_bf16 v183, v136, v136, v183
    v_dot2_f32_bf16 v180, v117, s14, v180
    v_dot2_f32_bf16 v181, v117, v117, v181
    v_dot2_f32_bf16 v182, v137, s14, v182
    v_dot2_f32_bf16 v183, v137, v137, v183
    v_dot2_f32_bf16 v180, v118, s14, v180
    v_dot2_f32_bf16 v181, v118, v118, v181
    v_dot2_f32_bf16 v182, v138, s14, v182
    v_dot2_f32_bf16 v183, v138, v138, v183
    v_dot2_f32_bf16 v180, v119, s14, v180
    v_dot2_f32_bf16 v181, v119, v119, v181
    v_dot2_f32_bf16 v182, v139, s14, v182
    v_dot2_f32_bf16 v183, v139, v139, v183
    s_waitcnt vmcnt(1)
    v_dot2_f32_bf16 v184, v140, s14, 0
    v_dot2_f32_bf16 v185, v140, v140, 0
    v_dot2_f32_bf16 v186, v160, s14, 0
    v_dot2_f32_bf16 v187, v160, v160, 0
    v_dot2_f32_bf16 v184, v141, s14, v184
    v_dot2_f32_bf16 v185, v141, v141, v185
    v_dot2_f32_bf16 v186, v161, s14, v186
    v_dot2_f32_bf16 v187, v161, v161, v187
    v_dot2_f32_bf16 v184, v142, s14, v184
    v_dot2_f32_bf16 v185, v142, v142, v185
    v_dot2_f32_bf16 v186, v162, s14, v186
    v_dot2_f32_bf16 v187, v162, v162, v187
    v_dot2_f32_bf16 v184, v143, s14, v184
    v_dot2_f32_bf16 v185, v143, v143, v185
    v_dot2_f32_bf16 v186, v163, s14, v186
    v_dot2_f32_bf16 v187, v163, v163, v187
    v_dot2_f32_bf16 v184, v144, s14, v184
    v_dot2_f32_bf16 v185, v144, v144, v185
    v_dot2_f32_bf16 v186, v164, s14, v186
    v_dot2_f32_bf16 v187, v164, v164, v187
    v_dot2_f32_bf16 v184, v145, s14, v184
    v_dot2_f32_bf16 v185, v145, v145, v185
    v_dot2_f32_bf16 v186, v165, s14, v186
    v_dot2_f32_bf16 v187, v165, v165, v187
    v_dot2_f32_bf16 v184, v146, s14, v184
    v_dot2_f32_bf16 v185, v146, v146, v185
    v_dot2_f32_bf16 v186, v166, s14, v186
    v_dot2_f32_bf16 v187, v166, v166, v187
    v_dot2_f32_bf16 v184, v147, s14, v184
    v_dot2_f32_bf16 v185, v147, v147, v185
    v_dot2_f32_bf16 v186, v167, s14, v186
    v_dot2_f32_bf16 v187, v167, v167, v187
    v_dot2_f32_bf16 v184, v148, s14, v184
    v_dot2_f32_bf16 v185, v148, v148, v185
    v_dot2_f32_bf16 v186, v168, s14, v186
    v_dot2_f32_bf16 v187, v168, v168, v187
    v_dot2_f32_bf16 v184, v149, s14, v184
    v_dot2_f32_bf16 v185, v149, v149, v185
    v_dot2_f32_bf16 v186, v169, s14, v186
    v_dot2_f32_bf16 v187, v169, v169, v187
    v_dot2_f32_bf16 v184, v150, s14, v184
    v_dot2_f32_bf16 v185, v150, v150, v185
    v_dot2_f32_bf16 v186, v170, s14, v186
    v_dot2_f32_bf16 v187, v170, v170, v187
    v_dot2_f32_bf16 v184, v151, s14, v184
    v_dot2_f32_bf16 v185, v151, v151, v185
    v_dot2_f32_bf16 v186, v171, s14, v186
    v_dot2_f32_bf16 v187, v171, v171, v187
    v_dot2_f32_bf16 v184, v152, s14, v184
    v_dot2_f32_bf16 v185, v152, v152, v185
    v_dot2_f32_bf16 v186, v172, s14, v186
    v_dot2_f32_bf16 v187, v172, v172, v187
    v_dot2_f32_bf16 v184, v153, s14, v184
    v_dot2_f32_bf16 v185, v153, v153, v185
    v_dot2_f32_bf16 v186, v173, s14, v186
    v_dot2_f32_bf16 v187, v173, v173, v187
    v_dot2_f32_bf16 v184, v154, s14, v184
    v_dot2_f32_bf16 v185, v154, v154, v185
    v_dot2_f32_bf16 v186, v174, s14, v186
    v_dot2_f32_bf16 v187, v174, v174, v187
    v_dot2_f32_bf16 v184, v155, s14, v184
    v_dot2_f32_bf16 v185, v155, v155, v185
    v_dot2_f32_bf16 v186, v175, s14, v186
    v_dot2_f32_bf16 v187, v175, v175, v187
    v_dot2_f32_bf16 v184, v156, s14, v184
    v_dot2_f32_bf16 v185, v156, v156, v185
    v_dot2_f32_bf16 v186, v176, s14, v186
    v_dot2_f32_bf16 v187, v176, v176, v187
    v_dot2_f32_bf16 v184, v157, s14, v184
    v_dot2_f32_bf16 v185, v157, v157, v185
    v_dot2_f32_bf16 v186, v177, s14, v186
    v_dot2_f32_bf16 v187, v177, v177, v187
    v_dot2_f32_bf16 v184, v158, s14, v184
    v_dot2_f32_bf16 v185, v158, v158, v185
    v_dot2_f32_bf16 v186, v178, s14, v186
    v_dot2_f32_bf16 v187, v178, v178, v187
    v_dot2_f32_bf16 v184, v159, s14, v184
    v_dot2_f32_bf16 v185, v159, v159, v185
    v_dot2_f32_bf16 v186, v179, s14, v186
    v_dot2_f32_bf16 v187, v179, v179, v187
    s_nop 2
    v_add_f32_dpp v180, v180, v180 row_ror:8 row_mask:0xf bank_mask:0xf
    v_add_f32_dpp v181, v181, v181 row_ror:8 row_mask:0xf bank_mask:0xf
    v_add_f32_dpp v182, v182, v182 row_ror:8 row_mask:0xf bank_mask:0xf
    v_add_f32_dpp v183, v183, v183 row_ror:8 row_mask:0xf bank_mask:0xf
    v_add_f32_dpp v184, v184, v184 row_ror:8 row_mask:0xf bank_mask:0xf
    v_add_f32_dpp v185, v185, v185 row_ror:8 row_mask:0xf bank_mask:0xf
    v_add_f32_dpp v186, v186, v186 row_ror:8 row_mask:0xf bank_mask:0xf
    v_add_f32_dpp v187, v187, v187 row_ror:8 row_mask:0xf bank_mask:0xf
    v_add_f32_dpp v180, v180, v180 row_ror:4 row_mask:0xf bank_mask:0xf
    v_add_f32_dpp v181, v181, v181 row_ror:4 row_mask:0xf bank_mask:0xf
    v_add_f32_dpp v182, v182, v182 row_ror:4 row_mask:0xf bank_mask:0xf
    v_add_f32_dpp v183, v183, v183 row_ror:4 row_mask:0xf bank_mask:0xf
    v_add_f32_dpp v184, v184, v184 row_ror:4 row_mask:0xf bank_mask:0xf
    v_add_f32_dpp v185, v185, v185 row_ror:4 row_mask:0xf bank_mask:0xf
    v_add_f32_dpp v186, v186, v186 row_ror:4 row_mask:0xf bank_mask:0xf
    v_add_f32_dpp v187, v187, v187 row_ror:4 row_mask:0xf bank_mask:0xf
    v_add_f32_dpp v180, v180, v180 row_ror:2 row_mask:0xf bank_mask:0xf
    v_add_f32_dpp v181, v181, v181 row_ror:2 row_mask:0xf bank_mask:0xf
    v_add_f32_dpp v182, v182, v182 row_ror:2 row_mask:0xf bank_mask:0xf
    v_add_f32_dpp v183, v183, v183 row_ror:2 row_mask:0xf bank_mask:0xf
    v_add_f32_dpp v184, v184, v184 row_ror:2 row_mask:0xf bank_mask:0xf
    v_add_f32_dpp v185, v185, v185 row_ror:2 row_mask:0xf bank_mask:0xf
    v_add_f32_dpp v186, v186, v186 row_ror:2 row_mask:0xf bank_mask:0xf
    v_add_f32_dpp v187, v187, v187 row_ror:2 row_mask:0xf bank_mask:0xf
    v_add_f32_dpp v180, v180, v180 row_ror:1 row_mask:0xf bank_mask:0xf
    v_add_f32_dpp v181, v181, v181 row_ror:1 row_mask:0xf bank_mask:0xf
    v_add_f32_dpp v182, v182, v182 row_ror:1 row_mask:0xf bank_mask:0xf
    v_add_f32_dpp v183, v183, v183 row_ror:1 row_mask:0xf bank_mask:0xf
    v_add_f32_dpp v184, v184, v184 row_ror:1 row_mask:0xf bank_mask:0xf
    v_add_f32_dpp v185, v185, v185 row_ror:1 row_mask:0xf bank_mask:0xf
    v_add_f32_dpp v186, v186, v186 row_ror:1 row_mask:0xf bank_mask:0xf
    v_add_f32_dpp v187, v187, v187 row_ror:1 row_mask:0xf bank_mask:0xf
    v_and_b32 v100, 3, v0
    v_cmp_eq_u32 vcc, 1, v100
    v_cmp_eq_u32 s[14:15], 2, v100
    v_cmp_eq_u32 s[16:17], 3, v100
    v_lshrrev_b32 v101, 4, v0
    v_lshl_add_u32 v100, v100, 2, v101
    v_cndmask_b32 v180, v180, v182, vcc
    v_cndmask_b32 v181, v181, v183, vcc
    v_cndmask_b32 v180, v180, v184, s[14:15]
    v_cndmask_b32 v181, v181, v185, s[14:15]
    v_cndmask_b32 v180, v180, v186, s[16:17]
    v_cndmask_b32 v181, v181, v187, s[16:17]
    v_mul_f32 v180, 0.00156250000, v180
    v_mul_f32 v181, 0.00156250000, v181
    v_fma_f32 v181, -v180, v180, v181
    v_max_f32 v181, 0, v181
    v_add_f32 v181, 0x3727c5ac, v181
    v_rsq_f32 v181, v181
    s_lshl_b32 s14, s3, 4
    s_add_u32 s14, s14, s45
    s_lshl_b32 s14, s14, 3
    s_add_u32 s14, s14, 6230016
    v_mul_f32 v180, -v180, v181
    v_and_b32 v101, 4, v0
    v_cmp_eq_u32 vcc, 0, v101
    v_lshl_add_u32 v100, v100, 2, s14
    v_lshl_add_u32 v100, v101, 4, v100
    v_cndmask_b32 v180, v180, v181, vcc
    s_mov_b32 exec_lo, 0xff00ff
    s_mov_b32 exec_hi, 0xff00ff
    global_store_dword v100, v180, s[12:13] sc1
    s_mov_b64 exec, -1
aux2_16:
    s_waitcnt vmcnt(1)
    v_readfirstlane_b32 s70, v212
    v_readfirstlane_b32 s71, v213
    s_cmp_lg_u64 s[70:71], 0
    s_cbranch_scc1 tagok_28
    s_mov_b32 s74, 0x100000
    v_mov_b32 v214, 0
tag_29:
    s_mov_b64 exec, 1
    global_load_dwordx2 v[212:213], v214, s[72:73] sc1
    s_mov_b64 exec, -1
    s_waitcnt vmcnt(0)
    v_readfirstlane_b32 s70, v212
    v_readfirstlane_b32 s71, v213
    s_sub_u32 s74, s74, 1
    s_cbranch_scc1 tagd_30
    s_cmp_eq_u64 s[70:71], 0
    s_cbranch_scc1 tag_29
tagd_30:
tagok_28:
    s_cmp_ge_u32 s8, 56
    s_cbranch_scc1 aux_wd_22
    s_and_b32 s10, s8, 3
    s_mul_i32 s10, s10, 7
    s_lshr_b32 s11, s8, 3
    s_add_u32 s10, s10, s11
    s_min_u32 s10, s10, 26
    s_bfe_u32 s9, s8, 0x10002
    s_cmp_eq_u32 s9, 1
    s_cselect_b32 s36, s38, s36
    s_cselect_b32 s37, s39, s37
    v_lshrrev_b32 v2, 3, v0
    v_bfe_u32 v3, v0, 4, 2
    v_lshlrev_b32 v3, 1, v3
    v_and_b32 v4, 7, v0
    v_xor_b32 v3, v3, v4
    v_mul_u32_u24 v2, 3456, v2
    v_lshl_add_u32 v2, v3, 4, v2
    s_lshl_b32 s11, s10, 7
    s_mul_i32 s16, s3, 110592
    s_add_u32 s11, s11, s16
    v_add_u32 v2, s11, v2
    s_mul_i32 s16, s3, 20480
    s_cmp_eq_u32 s3, 3
    s_cselect_b32 s16, 135168, s16
    s_mov_b32 s20, s36
    s_and_b32 s21, s37, 0xffff
    s_mov_b32 s22, 2211840
    s_mov_b32 s23, 0x20000
    s_add_u32 m0, s16, 0
    s_mov_b32 s17, 0
    buffer_load_dwordx4 v2, s[20:23], s17 offen lds
    s_add_u32 m0, s16, 1024
    s_mov_b32 s17, 27648
    buffer_load_dwordx4 v2, s[20:23], s17 offen lds
    s_add_u32 m0, s16, 2048
    s_mov_b32 s17, 55296
    buffer_load_dwordx4 v2, s[20:23], s17 offen lds
    s_add_u32 m0, s16, 3072
    s_mov_b32 s17, 82944
    buffer_load_dwordx4 v2, s[20:23], s17 offen lds
    s_add_u32 m0, s16, 4096
    s_mov_b32 s17, 442368
    buffer_load_dwordx4 v2, s[20:23], s17 offen lds
    s_add_u32 m0, s16, 5120
    s_mov_b32 s17, 470016
    buffer_load_dwordx4 v2, s[20:23], s17 offen lds
    s_waitcnt vmcnt(6)
    s_barrier
    s_cmp_lg_u32 s3, 0
    s_cbranch_scc1 pub_31
    s_lshl_b32 s74, s2, 7
    s_add_u32 s74, s74, 32768
    v_lshl_add_u32 v18, v0, 3, s74
    v_mov_b32 v16, s70
    v_mov_b32 v17, s71
    s_mov_b64 exec, 0xffff
    global_store_dwordx2 v18, v[16:17], s[12:13] sc1
    s_mov_b64 exec, -1
pub_31:
    s_add_u32 m0, s16, 6144
    s_mov_b32 s17, 497664
    buffer_load_dwordx4 v2, s[20:23], s17 offen lds
    s_add_u32 m0, s16, 7168
    s_mov_b32 s17, 525312
    buffer_load_dwordx4 v2, s[20:23], s17 offen lds
    s_add_u32 m0, s16, 8192
    s_mov_b32 s17, 884736
    buffer_load_dwordx4 v2, s[20:23], s17 offen lds
    s_add_u32 m0, s16, 9216
    s_mov_b32 s17, 912384
    buffer_load_dwordx4 v2, s[20:23], s17 offen lds
    s_add_u32 m0, s16, 10240
    s_mov_b32 s17, 940032
    buffer_load_dwordx4 v2, s[20:23], s17 offen lds
    s_add_u32 m0, s16, 11264
    s_mov_b32 s17, 967680
    buffer_load_dwordx4 v2, s[20:23], s17 offen lds
    s_add_u32 m0, s16, 12288
    s_mov_b32 s17, 1327104
    buffer_load_dwordx4 v2, s[20:23], s17 offen lds
    s_add_u32 m0, s16, 13312
    s_mov_b32 s17, 1354752
    buffer_load_dwordx4 v2, s[20:23], s17 offen lds
    s_add_u32 m0, s16, 14336
    s_mov_b32 s17, 1382400
    buffer_load_dwordx4 v2, s[20:23], s17 offen lds
    s_add_u32 m0, s16, 15360
    s_mov_b32 s17, 1410048
    buffer_load_dwordx4 v2, s[20:23], s17 offen lds
    s_add_u32 m0, s16, 16384
    s_mov_b32 s17, 1769472
    buffer_load_dwordx4 v2, s[20:23], s17 offen lds
    s_add_u32 m0, s16, 17408
    s_mov_b32 s17, 1797120
    buffer_load_dwordx4 v2, s[20:23], s17 offen lds
    s_add_u32 m0, s16, 18432
    s_mov_b32 s17, 1824768
    buffer_load_dwordx4 v2, s[20:23], s17 offen lds
    s_add_u32 m0, s16, 19456
    s_mov_b32 s17, 1852416
    buffer_load_dwordx4 v2, s[20:23], s17 offen lds
    v_lshrrev_b32 v2, 2, v0
    v_bfe_u32 v3, v0, 3, 2
    v_and_b32 v4, 3, v0
    v_lshlrev_b32 v2, 7, v2
    v_lshl_add_u32 v2, v4, 3, v2
    v_add_u32 v2, s16, v2
    v_xor_b32 v4, 0, v3
    v_lshl_add_u32 v10, v4, 5, v2
    v_xor_b32 v4, 1, v3
    v_lshl_add_u32 v11, v4, 5, v2
    v_xor_b32 v4, 2, v3
    v_lshl_add_u32 v12, v4, 5, v2
    v_xor_b32 v4, 3, v3
    v_lshl_add_u32 v13, v4, 5, v2
    v_lshrrev_b32 v14, 4, v0
    v_lshlrev_b32 v14, 4, v14
    s_lshl_b32 s16, s3, 7
    s_add_u32 s16, s16, 61440
    v_add_u32 v14, s16, v14
    s_mul_i32 s16, s3, 1280
    s_add_u32 s17, s16, 6254080
    v_add_u32 v15, s17, v9
    s_add_u32 s18, s16, 61440
    s_and_b32 s74, s2, 63
    s_lshl_b32 s74, s74, 7
    s_add_u32 s74, s74, 163840
    v_mov_b32 v240, s74
    v_mov_b32 v236, s70
    v_mov_b32 v237, s71
    v_writelane_b32 v236, 0, 0
    s_load_dwordx4 s[84:87], s[0:1], 56
    s_lshr_b32 s6, s2, 3
    s_and_b32 s5, s2, 3
    s_mul_i32 s5, s5, 27
    s_add_u32 s5, s5, s6
    s_lshr_b32 s6, s5, 2
    s_and_b32 s5, s5, 3
    s_and_b32 s89, s2, 4
    s_add_u32 s5, s5, s89
    v_lshrrev_b32 v244, 3, v0
    v_bfe_u32 v245, v0, 4, 2
    v_lshlrev_b32 v245, 1, v245
    v_and_b32 v246, 7, v0
    v_xor_b32 v245, v245, v246
    v_mul_u32_u24 v244, 3456, v244
    v_lshl_add_u32 v7, v245, 4, v244
    s_mul_i32 s88, s3, 27648
    s_lshl_b32 s89, s6, 7
    s_add_u32 s88, s88, s89
    v_add_u32 v7, s88, v7
    s_lshl_b32 s88, s3, 10
    s_add_u32 s88, s88, 69632
    s_waitcnt lgkmcnt(0)
    s_mov_b32 s80, s84
    s_and_b32 s81, s85, 0xffff
    s_mov_b32 s82, 2211840
    s_mov_b32 s83, 0x20000
    s_mov_b32 s84, s86
    s_and_b32 s85, s87, 0xffff
    s_mov_b32 s86, 2211840
    s_mov_b32 s87, 0x20000
    v_add_u32 v18, 190, v0
    v_lshlrev_b32 v18, 7, v18
    v_add_u32 v18, 32768, v18
    s_mov_b32 s74, 0x100000
    s_mov_b64 exec, 0xfffff
poll_32:
    global_load_dwordx2 v[16:17], v18, s[12:13] sc1
    s_waitcnt vmcnt(0)
    v_cmp_ne_u64 vcc, s[70:71], v[16:17]
    s_and_b64 exec, exec, vcc
    s_cbranch_execz polld_33
    s_sleep 1
    s_sub_u32 s74, s74, 1
    s_cbranch_scc0 poll_32
polld_33:
    s_mov_b64 exec, -1
    s_mov_b32 m0, s18
    s_nop 0
    global_load_lds_dwordx4 v15, s[12:13] sc1
    s_mov_b64 exec, 0xffff
    global_load_lds_dwordx4 v15, s[12:13] offset:1024 sc1
    s_mov_b64 exec, -1
    s_add_u32 m0, s88, 0
    s_mov_b32 s89, 0
    s_nop 0
    buffer_load_dwordx4 v7, s[80:83], s89 offen lds
    s_add_u32 m0, s88, 4096
    s_nop 0
    buffer_load_dwordx4 v7, s[84:87], s89 offen lds
    s_add_u32 m0, s88, 8192
    s_mov_b32 s89, 110592
    s_nop 0
    buffer_load_dwordx4 v7, s[80:83], s89 offen lds
    s_add_u32 m0, s88, 12288
    s_nop 0
    buffer_load_dwordx4 v7, s[84:87], s89 offen lds
    s_add_u32 m0, s88, 16384
    s_mov_b32 s89, 221184
    s_nop 0
    buffer_load_dwordx4 v7, s[80:83], s89 offen lds
    s_add_u32 m0, s88, 20480
    s_nop 0
    buffer_load_dwordx4 v7, s[84:87], s89 offen lds
    s_add_u32 m0, s88, 24576
    s_mov_b32 s89, 331776
    s_nop 0
    buffer_load_dwordx4 v7, s[80:83], s89 offen lds
    s_add_u32 m0, s88, 28672
    s_nop 0
    buffer_load_dwordx4 v7, s[84:87], s89 offen lds
    ds_read_b64_tr_b16 v[128:129], v10 offset:0
    ds_read_b64_tr_b16 v[130:131], v10 offset:2048
    ds_read_b64_tr_b16 v[132:133], v11 offset:0
    ds_read_b64_tr_b16 v[134:135], v11 offset:2048
    ds_read_b64_tr_b16 v[136:137], v12 offset:0
    ds_read_b64_tr_b16 v[138:139], v12 offset:2048
    ds_read_b64_tr_b16 v[140:141], v13 offset:0
    ds_read_b64_tr_b16 v[142:143], v13 offset:2048
    s_waitcnt lgkmcnt(4)
    ds_read_b64_tr_b16 v[144:145], v10 offset:4096
    ds_read_b64_tr_b16 v[146:147], v10 offset:6144
    ds_read_b64_tr_b16 v[148:149], v11 offset:4096
    ds_read_b64_tr_b16 v[150:151], v11 offset:6144
    ds_read_b64_tr_b16 v[152:153], v12 offset:4096
    ds_read_b64_tr_b16 v[154:155], v12 offset:6144
    ds_read_b64_tr_b16 v[156:157], v13 offset:4096
    ds_read_b64_tr_b16 v[158:159], v13 offset:6144
    s_waitcnt lgkmcnt(4)
    ds_read_b64_tr_b16 v[160:161], v10 offset:8192
    ds_read_b64_tr_b16 v[162:163], v10 offset:10240
    ds_read_b64_tr_b16 v[164:165], v11 offset:8192
    ds_read_b64_tr_b16 v[166:167], v11 offset:10240
    ds_read_b64_tr_b16 v[168:169], v12 offset:8192
    ds_read_b64_tr_b16 v[170:171], v12 offset:10240
    ds_read_b64_tr_b16 v[172:173], v13 offset:8192
    ds_read_b64_tr_b16 v[174:175], v13 offset:10240
    s_waitcnt lgkmcnt(4)
    ds_read_b64_tr_b16 v[176:177], v10 offset:12288
    ds_read_b64_tr_b16 v[178:179], v10 offset:14336
    ds_read_b64_tr_b16 v[180:181], v11 offset:12288
    ds_read_b64_tr_b16 v[182:183], v11 offset:14336
    ds_read_b64_tr_b16 v[184:185], v12 offset:12288
    ds_read_b64_tr_b16 v[186:187], v12 offset:14336
    ds_read_b64_tr_b16 v[188:189], v13 offset:12288
    ds_read_b64_tr_b16 v[190:191], v13 offset:14336
    s_waitcnt lgkmcnt(4)
    ds_read_b64_tr_b16 v[192:193], v10 offset:16384
    ds_read_b64_tr_b16 v[194:195], v10 offset:18432
    ds_read_b64_tr_b16 v[196:197], v11 offset:16384
    ds_read_b64_tr_b16 v[198:199], v11 offset:18432
    ds_read_b64_tr_b16 v[200:201], v12 offset:16384
    ds_read_b64_tr_b16 v[202:203], v12 offset:18432
    ds_read_b64_tr_b16 v[204:205], v13 offset:16384
    ds_read_b64_tr_b16 v[206:207], v13 offset:18432
    s_waitcnt lgkmcnt(4)
    s_waitcnt vmcnt(8) lgkmcnt(0)
    s_barrier
    ds_read_b128 v[16:19], v14 offset:0
    ds_read_b128 v[24:27], v14 offset:2560
    ds_read_b128 v[20:23], v14 offset:64
    ds_read_b128 v[28:31], v14 offset:2624
    ds_read_b128 v[32:35], v14 offset:512
    ds_read_b128 v[40:43], v14 offset:3072
    ds_read_b128 v[36:39], v14 offset:576
    ds_read_b128 v[44:47], v14 offset:3136
    ds_read_b128 v[48:51], v14 offset:1024
    ds_read_b128 v[56:59], v14 offset:3584
    ds_read_b128 v[52:55], v14 offset:1088
    ds_read_b128 v[60:63], v14 offset:3648
    s_waitcnt lgkmcnt(4)
    ds_read_b128 v[64:67], v14 offset:1536
    ds_read_b128 v[72:75], v14 offset:4096
    ds_read_b128 v[68:71], v14 offset:1600
    ds_read_b128 v[76:79], v14 offset:4160
    ds_read_b128 v[80:83], v14 offset:2048
    ds_read_b128 v[88:91], v14 offset:4608
    ds_read_b128 v[84:87], v14 offset:2112
    ds_read_b128 v[92:95], v14 offset:4672
    s_add_u32 m0, s88, 32768
    s_mov_b32 s89, 442368
    s_nop 0
    buffer_load_dwordx4 v7, s[80:83], s89 offen lds
    s_add_u32 m0, s88, 36864
    s_nop 0
    buffer_load_dwordx4 v7, s[84:87], s89 offen lds
    s_add_u32 m0, s88, 40960
    s_mov_b32 s89, 552960
    s_nop 0
    buffer_load_dwordx4 v7, s[80:83], s89 offen lds
    s_add_u32 m0, s88, 45056
    s_nop 0
    buffer_load_dwordx4 v7, s[84:87], s89 offen lds
    s_add_u32 m0, s88, 49152
    s_mov_b32 s89, 663552
    s_nop 0
    buffer_load_dwordx4 v7, s[80:83], s89 offen lds
    s_add_u32 m0, s88, 53248
    s_nop 0
    buffer_load_dwordx4 v7, s[84:87], s89 offen lds
    s_add_u32 m0, s88, 57344
    s_mov_b32 s89, 774144
    s_nop 0
    buffer_load_dwordx4 v7, s[80:83], s89 offen lds
    s_add_u32 m0, s88, 61440
    s_nop 0
    buffer_load_dwordx4 v7, s[84:87], s89 offen lds
    s_add_u32 m0, s88, 65536
    s_mov_b32 s89, 884736
    s_nop 0
    buffer_load_dwordx4 v7, s[80:83], s89 offen lds
    s_add_u32 m0, s88, 69632
    s_nop 0
    buffer_load_dwordx4 v7, s[84:87], s89 offen lds
    s_add_u32 m0, s88, 73728
    s_mov_b32 s89, 995328
    s_nop 0
    buffer_load_dwordx4 v7, s[80:83], s89 offen lds
    s_add_u32 m0, s88, 77824
    s_nop 0
    buffer_load_dwordx4 v7, s[84:87], s89 offen lds
    s_add_u32 m0, s88, 81920
    s_mov_b32 s89, 1105920
    s_nop 0
    buffer_load_dwordx4 v7, s[80:83], s89 offen lds
    s_add_u32 m0, s88, 86016
    s_nop 0
    buffer_load_dwordx4 v7, s[84:87], s89 offen lds
    s_waitcnt lgkmcnt(0)
    v_cvt_pk_bf16_f32 v96, v16, v17
    v_cvt_pk_bf16_f32 v97, v18, v19
    v_cvt_pk_bf16_f32 v98, v20, v21
    v_cvt_pk_bf16_f32 v99, v22, v23
    v_add_f32 v24, 1.0, v24
    v_add_f32 v25, 1.0, v25
    v_add_f32 v26, 1.0, v26
    v_add_f32 v27, 1.0, v27
    v_add_f32 v28, 1.0, v28
    v_add_f32 v29, 1.0, v29
    v_add_f32 v30, 1.0, v30
    v_add_f32 v31, 1.0, v31
    v_cvt_pk_bf16_f32 v100, v24, v25
    v_cvt_pk_bf16_f32 v101, v26, v27
    v_cvt_pk_bf16_f32 v102, v28, v29
    v_cvt_pk_bf16_f32 v103, v30, v31
    v_mfma_f32_16x16x32_bf16 v[112:115], v[128:131], v[96:99], 0
    v_mfma_f32_16x16x32_bf16 v[116:119], v[132:135], v[96:99], 0
    v_mfma_f32_16x16x32_bf16 v[120:123], v[136:139], v[96:99], 0
    v_mfma_f32_16x16x32_bf16 v[124:127], v[140:143], v[96:99], 0
    v_mfma_f32_16x16x32_bf16 v[208:211], v[128:131], v[100:103], 0
    v_mfma_f32_16x16x32_bf16 v[212:215], v[132:135], v[100:103], 0
    v_mfma_f32_16x16x32_bf16 v[216:219], v[136:139], v[100:103], 0
    v_mfma_f32_16x16x32_bf16 v[220:223], v[140:143], v[100:103], 0
    v_cvt_pk_bf16_f32 v104, v32, v33
    v_cvt_pk_bf16_f32 v105, v34, v35
    v_cvt_pk_bf16_f32 v106, v36, v37
    v_cvt_pk_bf16_f32 v107, v38, v39
    v_add_f32 v40, 1.0, v40
    v_add_f32 v41, 1.0, v41
    v_add_f32 v42, 1.0, v42
    v_add_f32 v43, 1.0, v43
    v_add_f32 v44, 1.0, v44
    v_add_f32 v45, 1.0, v45
    v_add_f32 v46, 1.0, v46
    v_add_f32 v47, 1.0, v47
    v_cvt_pk_bf16_f32 v108, v40, v41
    v_cvt_pk_bf16_f32 v109, v42, v43
    v_cvt_pk_bf16_f32 v110, v44, v45
    v_cvt_pk_bf16_f32 v111, v46, v47
    v_mfma_f32_16x16x32_bf16 v[112:115], v[144:147], v[104:107], v[112:115]
    v_mfma_f32_16x16x32_bf16 v[116:119], v[148:151], v[104:107], v[116:119]
    v_mfma_f32_16x16x32_bf16 v[120:123], v[152:155], v[104:107], v[120:123]
    v_mfma_f32_16x16x32_bf16 v[124:127], v[156:159], v[104:107], v[124:127]
    v_mfma_f32_16x16x32_bf16 v[208:211], v[144:147], v[108:111], v[208:211]
    v_mfma_f32_16x16x32_bf16 v[212:215], v[148:151], v[108:111], v[212:215]
    v_mfma_f32_16x16x32_bf16 v[216:219], v[152:155], v[108:111], v[216:219]
    v_mfma_f32_16x16x32_bf16 v[220:223], v[156:159], v[108:111], v[220:223]
    v_cvt_pk_bf16_f32 v96, v48, v49
    v_cvt_pk_bf16_f32 v97, v50, v51
    v_cvt_pk_bf16_f32 v98, v52, v53
    v_cvt_pk_bf16_f32 v99, v54, v55
    v_add_f32 v56, 1.0, v56
    v_add_f32 v57, 1.0, v57
    v_add_f32 v58, 1.0, v58
    v_add_f32 v59, 1.0, v59
    v_add_f32 v60, 1.0, v60
    v_add_f32 v61, 1.0, v61
    v_add_f32 v62, 1.0, v62
    v_add_f32 v63, 1.0, v63
    v_cvt_pk_bf16_f32 v100, v56, v57
    v_cvt_pk_bf16_f32 v101, v58, v59
    v_cvt_pk_bf16_f32 v102, v60, v61
    v_cvt_pk_bf16_f32 v103, v62, v63
    v_mfma_f32_16x16x32_bf16 v[112:115], v[160:163], v[96:99], v[112:115]
    v_mfma_f32_16x16x32_bf16 v[116:119], v[164:167], v[96:99], v[116:119]
    v_mfma_f32_16x16x32_bf16 v[120:123], v[168:171], v[96:99], v[120:123]
    v_mfma_f32_16x16x32_bf16 v[124:127], v[172:175], v[96:99], v[124:127]
    v_mfma_f32_16x16x32_bf16 v[208:211], v[160:163], v[100:103], v[208:211]
    v_mfma_f32_16x16x32_bf16 v[212:215], v[164:167], v[100:103], v[212:215]
    v_mfma_f32_16x16x32_bf16 v[216:219], v[168:171], v[100:103], v[216:219]
    v_mfma_f32_16x16x32_bf16 v[220:223], v[172:175], v[100:103], v[220:223]
    v_cvt_pk_bf16_f32 v104, v64, v65
    v_cvt_pk_bf16_f32 v105, v66, v67
    v_cvt_pk_bf16_f32 v106, v68, v69
    v_cvt_pk_bf16_f32 v107, v70, v71
    v_add_f32 v72, 1.0, v72
    v_add_f32 v73, 1.0, v73
    v_add_f32 v74, 1.0, v74
    v_add_f32 v75, 1.0, v75
    v_add_f32 v76, 1.0, v76
    v_add_f32 v77, 1.0, v77
    v_add_f32 v78, 1.0, v78
    v_add_f32 v79, 1.0, v79
    v_cvt_pk_bf16_f32 v108, v72, v73
    v_cvt_pk_bf16_f32 v109, v74, v75
    v_cvt_pk_bf16_f32 v110, v76, v77
    v_cvt_pk_bf16_f32 v111, v78, v79
    v_mfma_f32_16x16x32_bf16 v[112:115], v[176:179], v[104:107], v[112:115]
    v_mfma_f32_16x16x32_bf16 v[116:119], v[180:183], v[104:107], v[116:119]
    v_mfma_f32_16x16x32_bf16 v[120:123], v[184:187], v[104:107], v[120:123]
    v_mfma_f32_16x16x32_bf16 v[124:127], v[188:191], v[104:107], v[124:127]
    v_mfma_f32_16x16x32_bf16 v[208:211], v[176:179], v[108:111], v[208:211]
    v_mfma_f32_16x16x32_bf16 v[212:215], v[180:183], v[108:111], v[212:215]
    v_mfma_f32_16x16x32_bf16 v[216:219], v[184:187], v[108:111], v[216:219]
    v_mfma_f32_16x16x32_bf16 v[220:223], v[188:191], v[108:111], v[220:223]
    v_cvt_pk_bf16_f32 v96, v80, v81
    v_cvt_pk_bf16_f32 v97, v82, v83
    v_cvt_pk_bf16_f32 v98, v84, v85
    v_cvt_pk_bf16_f32 v99, v86, v87
    v_add_f32 v88, 1.0, v88
    v_add_f32 v89, 1.0, v89
    v_add_f32 v90, 1.0, v90
    v_add_f32 v91, 1.0, v91
    v_add_f32 v92, 1.0, v92
    v_add_f32 v93, 1.0, v93
    v_add_f32 v94, 1.0, v94
    v_add_f32 v95, 1.0, v95
    v_cvt_pk_bf16_f32 v100, v88, v89
    v_cvt_pk_bf16_f32 v101, v90, v91
    v_cvt_pk_bf16_f32 v102, v92, v93
    v_cvt_pk_bf16_f32 v103, v94, v95
    v_mfma_f32_16x16x32_bf16 v[112:115], v[192:195], v[96:99], v[112:115]
    v_mfma_f32_16x16x32_bf16 v[116:119], v[196:199], v[96:99], v[116:119]
    v_mfma_f32_16x16x32_bf16 v[120:123], v[200:203], v[96:99], v[120:123]
    v_mfma_f32_16x16x32_bf16 v[124:127], v[204:207], v[96:99], v[124:127]
    v_mfma_f32_16x16x32_bf16 v[208:211], v[192:195], v[100:103], v[208:211]
    v_mfma_f32_16x16x32_bf16 v[212:215], v[196:199], v[100:103], v[212:215]
    v_mfma_f32_16x16x32_bf16 v[216:219], v[200:203], v[100:103], v[216:219]
    v_mfma_f32_16x16x32_bf16 v[220:223], v[204:207], v[100:103], v[220:223]
    s_lshl_b32 s16, s3, 9
    s_add_u32 s16, s16, 161792
    v_add_u32 v2, s16, v0
    s_mov_b32 exec_lo, 0x10001
    s_mov_b32 exec_hi, 0x10001
    s_nop 2
    ds_write_b128 v2, v[112:115] offset:256
    ds_write_b128 v2, v[116:119] offset:320
    ds_write_b128 v2, v[120:123] offset:384
    ds_write_b128 v2, v[124:127] offset:448
    ds_write_b128 v2, v[208:211] offset:0
    ds_write_b128 v2, v[212:215] offset:64
    ds_write_b128 v2, v[216:219] offset:128
    ds_write_b128 v2, v[220:223] offset:192
    s_mov_b64 exec, -1
    s_waitcnt lgkmcnt(0)
    s_barrier
    s_cmp_ge_u32 s3, 2
    s_cbranch_scc1 aux_we_21
    s_lshl_b32 s16, s3, 8
    s_add_u32 s16, s16, 161792
    v_lshlrev_b32 v3, 2, v0
    v_add_u32 v2, s16, v3
    ds_read2st64_b32 v[4:5], v2 offset0:0 offset1:2
    ds_read2st64_b32 v[16:17], v2 offset0:4 offset1:6
    s_lshl_b32 s16, s9, 1
    s_add_u32 s16, s16, s3
    s_mul_i32 s16, s16, 6912
    s_lshl_b32 s17, s10, 8
    s_add_u32 s16, s16, s17
    s_add_u32 s16, s16, 11522048
    s_add_u32 s14, s12, s16
    s_addc_u32 s15, s13, 0
    s_waitcnt lgkmcnt(0)
    v_add_f32 v4, v4, v5
    v_add_f32 v16, v16, v17
    v_add_f32 v4, v4, v16
    global_store_dword v3, v4, s[14:15] sc1
    s_waitcnt vmcnt(0)
aux_we_21:
    s_branch g1_3
aux_wd_22:
    s_lshl_b32 s46, s8, 2
    s_add_u32 s46, s46, s3
    s_sub_u32 s17, s46, 328
    s_sub_u32 s46, s46, 59
    s_cmp_eq_u32 s17, 55
    s_cselect_b32 s17, 269, s17
    s_cmp_ge_u32 s8, 82
    s_cselect_b32 s46, s17, s46
    v_lshrrev_b32 v2, 4, v0
    v_and_b32 v3, 15, v0
    v_lshlrev_b32 v4, 1, v2
    v_xor_b32 v4, v4, v3
    v_mul_u32_u24 v2, 1280, v2
    v_lshl_add_u32 v5, v4, 4, v2
    v_xor_b32 v4, 8, v4
    v_lshl_add_u32 v6, v4, 4, v2
    v_add_u32 v6, 5120, v6
    s_mul_i32 s16, s3, 24576
    s_mul_i32 s17, s46, 52429
    s_lshr_b32 s17, s17, 18
    s_mul_i32 s11, s17, 5
    s_sub_u32 s11, s46, s11
    s_mul_i32 s17, s17, 40960
    s_lshl_b32 s11, s11, 8
    s_add_u32 s17, s17, s11
    v_add_u32 v5, s17, v5
    v_add_u32 v6, s17, v6
    s_mov_b32 s20, s6
    s_and_b32 s21, s7, 0xffff
    s_mov_b32 s22, 2211840
    s_mov_b32 s23, 0x20000
    s_add_u32 s14, s12, 11550720
    s_addc_u32 s15, s13, 0
    s_mov_b32 s24, s14
    s_and_b32 s25, s15, 0xffff
    s_mov_b32 s26, 2211840
    s_mov_b32 s27, 0x20000
    s_add_u32 m0, s16, 0
    s_mov_b32 s17, 0
    buffer_load_dwordx4 v5, s[20:23], s17 offen nt lds
    s_add_u32 m0, s16, 1024
    s_mov_b32 s17, 0
    buffer_load_dwordx4 v6, s[20:23], s17 offen nt lds
    s_add_u32 m0, s16, 2048
    s_mov_b32 s17, 10240
    buffer_load_dwordx4 v5, s[20:23], s17 offen nt lds
    s_add_u32 m0, s16, 3072
    s_mov_b32 s17, 10240
    buffer_load_dwordx4 v6, s[20:23], s17 offen nt lds
    s_add_u32 m0, s16, 4096
    s_mov_b32 s17, 20480
    buffer_load_dwordx4 v5, s[20:23], s17 offen nt lds
    s_add_u32 m0, s16, 5120
    s_mov_b32 s17, 20480
    buffer_load_dwordx4 v6, s[20:23], s17 offen nt lds
    s_cmp_ge_u32 s8, 82
    s_cbranch_scc1 aux_np1_25
    s_waitcnt vmcnt(6)
    s_barrier
    s_cmp_lg_u32 s3, 0
    s_cbranch_scc1 pub_34
    s_lshl_b32 s74, s2, 7
    s_add_u32 s74, s74, 32768
    v_lshl_add_u32 v18, v0, 3, s74
    v_mov_b32 v16, s70
    v_mov_b32 v17, s71
    s_mov_b64 exec, 0xffff
    global_store_dwordx2 v18, v[16:17], s[12:13] sc1
    s_mov_b64 exec, -1
pub_34:
aux_np1_25:
    s_add_u32 m0, s16, 6144
    s_mov_b32 s17, 30720
    buffer_load_dwordx4 v5, s[20:23], s17 offen nt lds
    s_add_u32 m0, s16, 7168
    s_mov_b32 s17, 30720
    buffer_load_dwordx4 v6, s[20:23], s17 offen nt lds
    s_cmp_ge_u32 s8, 82
    s_cselect_b32 s22, s22, 0
    s_add_u32 m0, s16, 8192
    s_mov_b32 s17, 450560
    buffer_load_dwordx4 v5, s[20:23], s17 offen nt lds
    s_add_u32 m0, s16, 9216
    s_mov_b32 s17, 450560
    buffer_load_dwordx4 v6, s[20:23], s17 offen nt lds
    s_add_u32 m0, s16, 10240
    s_mov_b32 s17, 460800
    buffer_load_dwordx4 v5, s[20:23], s17 offen nt lds
    s_add_u32 m0, s16, 11264
    s_mov_b32 s17, 460800
    buffer_load_dwordx4 v6, s[20:23], s17 offen nt lds
    s_add_u32 m0, s16, 12288
    s_mov_b32 s17, 471040
    buffer_load_dwordx4 v5, s[20:23], s17 offen nt lds
    s_add_u32 m0, s16, 13312
    s_mov_b32 s17, 471040
    buffer_load_dwordx4 v6, s[20:23], s17 offen nt lds
    s_add_u32 m0, s16, 14336
    s_mov_b32 s17, 481280
    buffer_load_dwordx4 v5, s[20:23], s17 offen nt lds
    s_add_u32 m0, s16, 15360
    s_mov_b32 s17, 481280
    buffer_load_dwordx4 v6, s[20:23], s17 offen nt lds
    s_add_u32 m0, s16, 16384
    s_mov_b32 s17, 901120
    buffer_load_dwordx4 v5, s[20:23], s17 offen nt lds
    s_add_u32 m0, s16, 17408
    s_mov_b32 s17, 901120
    buffer_load_dwordx4 v6, s[20:23], s17 offen nt lds
    s_add_u32 m0, s16, 18432
    s_mov_b32 s17, 911360
    buffer_load_dwordx4 v5, s[20:23], s17 offen nt lds
    s_add_u32 m0, s16, 19456
    s_mov_b32 s17, 911360
    buffer_load_dwordx4 v6, s[20:23], s17 offen nt lds
    s_add_u32 m0, s16, 20480
    s_mov_b32 s17, 921600
    buffer_load_dwordx4 v5, s[20:23], s17 offen nt lds
    s_add_u32 m0, s16, 21504
    s_mov_b32 s17, 921600
    buffer_load_dwordx4 v6, s[20:23], s17 offen nt lds
    s_add_u32 m0, s16, 22528
    s_mov_b32 s17, 931840
    buffer_load_dwordx4 v5, s[20:23], s17 offen nt lds
    s_add_u32 m0, s16, 23552
    s_mov_b32 s17, 931840
    buffer_load_dwordx4 v6, s[20:23], s17 offen nt lds
    v_mov_b32 v214, 0
    s_mov_b64 exec, 1
    global_load_dwordx2 v[212:213], v214, s[72:73] sc1
    s_mov_b64 exec, -1
    v_lshrrev_b32 v2, 2, v0
    v_and_b32 v3, 7, v2
    v_lshlrev_b32 v3, 1, v3
    v_bfe_u32 v4, v0, 1, 1
    v_or_b32 v3, v3, v4
    v_lshlrev_b32 v2, 8, v2
    v_and_b32 v4, 1, v0
    v_lshl_add_u32 v2, v4, 3, v2
    v_add_u32 v2, s16, v2
    v_xor_b32 v4, 0, v3
    v_lshl_add_u32 v48, v4, 4, v2
    v_xor_b32 v4, 2, v3
    v_lshl_add_u32 v49, v4, 4, v2
    v_xor_b32 v4, 4, v3
    v_lshl_add_u32 v50, v4, 4, v2
    v_xor_b32 v4, 6, v3
    v_lshl_add_u32 v51, v4, 4, v2
    v_xor_b32 v4, 8, v3
    v_lshl_add_u32 v52, v4, 4, v2
    v_xor_b32 v4, 10, v3
    v_lshl_add_u32 v53, v4, 4, v2
    v_xor_b32 v4, 12, v3
    v_lshl_add_u32 v54, v4, 4, v2
    v_xor_b32 v4, 14, v3
    v_lshl_add_u32 v55, v4, 4, v2
    s_lshl_b32 s17, s46, 13
    v_add_u32 v7, s17, v9
    s_waitcnt vmcnt(17)
    ds_read_b64_tr_b16 v[100:101], v48 offset:0
    ds_read_b64_tr_b16 v[102:103], v48 offset:4096
    ds_read_b64_tr_b16 v[104:105], v49 offset:0
    ds_read_b64_tr_b16 v[106:107], v49 offset:4096
    ds_read_b64_tr_b16 v[108:109], v50 offset:0
    ds_read_b64_tr_b16 v[110:111], v50 offset:4096
    ds_read_b64_tr_b16 v[112:113], v51 offset:0
    ds_read_b64_tr_b16 v[114:115], v51 offset:4096
    ds_read_b64_tr_b16 v[116:117], v52 offset:0
    ds_read_b64_tr_b16 v[118:119], v52 offset:4096
    ds_read_b64_tr_b16 v[120:121], v53 offset:0
    ds_read_b64_tr_b16 v[122:123], v53 offset:4096
    ds_read_b64_tr_b16 v[124:125], v54 offset:0
    ds_read_b64_tr_b16 v[126:127], v54 offset:4096
    ds_read_b64_tr_b16 v[128:129], v55 offset:0
    ds_read_b64_tr_b16 v[130:131], v55 offset:4096
    s_waitcnt lgkmcnt(8)
    s_mov_b32 s17, 0
    buffer_store_dwordx4 v[100:103], v7, s[24:27], s17 offen offset:0 sc1
    buffer_store_dwordx4 v[104:107], v7, s[24:27], s17 offen offset:1024 sc1
    buffer_store_dwordx4 v[108:111], v7, s[24:27], s17 offen offset:2048 sc1
    buffer_store_dwordx4 v[112:115], v7, s[24:27], s17 offen offset:3072 sc1
    s_waitcnt lgkmcnt(0)
    s_mov_b32 s17, 4096
    buffer_store_dwordx4 v[116:119], v7, s[24:27], s17 offen offset:0 sc1
    buffer_store_dwordx4 v[120:123], v7, s[24:27], s17 offen offset:1024 sc1
    buffer_store_dwordx4 v[124:127], v7, s[24:27], s17 offen offset:2048 sc1
    buffer_store_dwordx4 v[128:131], v7, s[24:27], s17 offen offset:3072 sc1
    s_cmp_lt_u32 s8, 82
    s_cbranch_scc1 aux_tg_26
    s_waitcnt vmcnt(17)
    ds_read_b64_tr_b16 v[132:133], v48 offset:8192
    ds_read_b64_tr_b16 v[134:135], v48 offset:12288
    ds_read_b64_tr_b16 v[136:137], v49 offset:8192
    ds_read_b64_tr_b16 v[138:139], v49 offset:12288
    ds_read_b64_tr_b16 v[140:141], v50 offset:8192
    ds_read_b64_tr_b16 v[142:143], v50 offset:12288
    ds_read_b64_tr_b16 v[144:145], v51 offset:8192
    ds_read_b64_tr_b16 v[146:147], v51 offset:12288
    ds_read_b64_tr_b16 v[148:149], v52 offset:8192
    ds_read_b64_tr_b16 v[150:151], v52 offset:12288
    ds_read_b64_tr_b16 v[152:153], v53 offset:8192
    ds_read_b64_tr_b16 v[154:155], v53 offset:12288
    ds_read_b64_tr_b16 v[156:157], v54 offset:8192
    ds_read_b64_tr_b16 v[158:159], v54 offset:12288
    ds_read_b64_tr_b16 v[160:161], v55 offset:8192
    ds_read_b64_tr_b16 v[162:163], v55 offset:12288
    s_waitcnt lgkmcnt(8)
    s_mov_b32 s17, 450560
    buffer_store_dwordx4 v[132:135], v7, s[24:27], s17 offen offset:0 sc1
    buffer_store_dwordx4 v[136:139], v7, s[24:27], s17 offen offset:1024 sc1
    buffer_store_dwordx4 v[140:143], v7, s[24:27], s17 offen offset:2048 sc1
    buffer_store_dwordx4 v[144:147], v7, s[24:27], s17 offen offset:3072 sc1
    s_waitcnt lgkmcnt(0)
    s_mov_b32 s17, 454656
    buffer_store_dwordx4 v[148:151], v7, s[24:27], s17 offen offset:0 sc1
    buffer_store_dwordx4 v[152:155], v7, s[24:27], s17 offen offset:1024 sc1
    buffer_store_dwordx4 v[156:159], v7, s[24:27], s17 offen offset:2048 sc1
    buffer_store_dwordx4 v[160:163], v7, s[24:27], s17 offen offset:3072 sc1
    s_waitcnt vmcnt(17)
    ds_read_b64_tr_b16 v[164:165], v48 offset:16384
    ds_read_b64_tr_b16 v[166:167], v48 offset:20480
    ds_read_b64_tr_b16 v[168:169], v49 offset:16384
    ds_read_b64_tr_b16 v[170:171], v49 offset:20480
    ds_read_b64_tr_b16 v[172:173], v50 offset:16384
    ds_read_b64_tr_b16 v[174:175], v50 offset:20480
    ds_read_b64_tr_b16 v[176:177], v51 offset:16384
    ds_read_b64_tr_b16 v[178:179], v51 offset:20480
    ds_read_b64_tr_b16 v[180:181], v52 offset:16384
    ds_read_b64_tr_b16 v[182:183], v52 offset:20480
    ds_read_b64_tr_b16 v[184:185], v53 offset:16384
    ds_read_b64_tr_b16 v[186:187], v53 offset:20480
    ds_read_b64_tr_b16 v[188:189], v54 offset:16384
    ds_read_b64_tr_b16 v[190:191], v54 offset:20480
    ds_read_b64_tr_b16 v[192:193], v55 offset:16384
    ds_read_b64_tr_b16 v[194:195], v55 offset:20480
    s_waitcnt lgkmcnt(8)
    s_mov_b32 s17, 901120
    buffer_store_dwordx4 v[164:167], v7, s[24:27], s17 offen offset:0 sc1
    buffer_store_dwordx4 v[168:171], v7, s[24:27], s17 offen offset:1024 sc1
    buffer_store_dwordx4 v[172:175], v7, s[24:27], s17 offen offset:2048 sc1
    buffer_store_dwordx4 v[176:179], v7, s[24:27], s17 offen offset:3072 sc1
    s_waitcnt lgkmcnt(0)
    s_mov_b32 s17, 905216
    buffer_store_dwordx4 v[180:183], v7, s[24:27], s17 offen offset:0 sc1
    buffer_store_dwordx4 v[184:187], v7, s[24:27], s17 offen offset:1024 sc1
    buffer_store_dwordx4 v[188:191], v7, s[24:27], s17 offen offset:2048 sc1
    buffer_store_dwordx4 v[192:195], v7, s[24:27], s17 offen offset:3072 sc1
aux_tg_26:
    s_waitcnt vmcnt(8)
    v_readfirstlane_b32 s70, v212
    v_readfirstlane_b32 s71, v213
    s_cmp_lg_u64 s[70:71], 0
    s_cbranch_scc1 tagok_35
    s_mov_b32 s74, 0x100000
    v_mov_b32 v214, 0
tag_36:
    s_mov_b64 exec, 1
    global_load_dwordx2 v[212:213], v214, s[72:73] sc1
    s_mov_b64 exec, -1
    s_waitcnt vmcnt(0)
    v_readfirstlane_b32 s70, v212
    v_readfirstlane_b32 s71, v213
    s_sub_u32 s74, s74, 1
    s_cbranch_scc1 tagd_37
    s_cmp_eq_u64 s[70:71], 0
    s_cbranch_scc1 tag_36
tagd_37:
tagok_35:
    s_waitcnt vmcnt(0)
    s_barrier
    s_cmp_lg_u32 s3, 0
    s_cbranch_scc1 pub_38
    s_lshl_b32 s74, s2, 7
    s_add_u32 s74, s74, 0
    v_lshl_add_u32 v18, v0, 3, s74
    v_mov_b32 v16, s70
    v_mov_b32 v17, s71
    s_mov_b64 exec, 0xffff
    global_store_dwordx2 v18, v[16:17], s[12:13] sc1
    s_mov_b64 exec, -1
pub_38:
    s_cmp_lt_u32 s8, 82
    s_cbranch_scc1 aux_now3_20
    s_sub_u32 s44, s8, 32
    s_cmp_lt_u32 s8, 92
    s_cbranch_scc1 aux_mod_23
    s_cmp_lg_u32 s8, 95
    s_cbranch_scc1 aux_now3_20
    s_cmp_lg_u32 s3, 0
    s_cbranch_scc1 aux_now3_20
    v_add_u32 v22, 216, v0
    v_lshlrev_b32 v22, 7, v22
    v_add_u32 v22, 0, v22
    s_mov_b32 s74, 0x100000
    s_mov_b32 exec_hi, 0xff
poll_39:
    global_load_dwordx2 v[20:21], v22, s[12:13] sc1
    s_waitcnt vmcnt(0)
    v_cmp_ne_u64 vcc, s[70:71], v[20:21]
    s_and_b64 exec, exec, vcc
    s_cbranch_execz polld_40
    s_sleep 1
    s_sub_u32 s74, s74, 1
    s_cbranch_scc0 poll_39
polld_40:
    s_mov_b64 exec, -1
    v_mov_b32 v16, s70
    v_mov_b32 v17, s71
    v_mov_b32 v18, s70
    v_mov_b32 v19, s71
    s_add_u32 s14, s12, 167936
    s_addc_u32 s15, s13, 0
    global_store_dwordx4 v9, v[16:19], s[14:15] offset:-4096 sc1
    global_store_dwordx4 v9, v[16:19], s[14:15] offset:-3072 sc1
    global_store_dwordx4 v9, v[16:19], s[14:15] offset:-2048 sc1
    global_store_dwordx4 v9, v[16:19], s[14:15] offset:-1024 sc1
    global_store_dwordx4 v9, v[16:19], s[14:15] offset:0 sc1
    global_store_dwordx4 v9, v[16:19], s[14:15] offset:1024 sc1
    global_store_dwordx4 v9, v[16:19], s[14:15] offset:2048 sc1
    global_store_dwordx4 v9, v[16:19], s[14:15] offset:3072 sc1
    s_branch aux_now3_20
aux_gbd_24:
    s_waitcnt vmcnt(0)
    s_barrier
    s_cmp_lg_u32 s3, 0
    s_cbranch_scc1 pub_41
    s_lshl_b32 s74, s2, 7
    s_add_u32 s74, s74, 32768
    v_lshl_add_u32 v18, v0, 3, s74
    v_mov_b32 v16, s70
    v_mov_b32 v17, s71
    s_mov_b64 exec, 0xffff
    global_store_dwordx2 v18, v[16:17], s[12:13] sc1
    s_mov_b64 exec, -1
pub_41:
aux_now3_20:
    s_and_b32 s74, s2, 63
    s_lshl_b32 s74, s74, 7
    s_add_u32 s74, s74, 163840
    v_mov_b32 v240, s74
    v_mov_b32 v236, s70
    v_mov_b32 v237, s71
    v_writelane_b32 v236, 0, 0
    s_branch g1_idle
g1_3:
    s_lshr_b32 s4, s2, 3
    s_bfe_u32 s44, s2, 0x20001
    s_lshl_b32 s44, s44, 3
    s_lshr_b32 s45, s4, 2
    s_add_u32 s44, s44, s45
    s_and_b32 s45, s2, 1
    s_lshl_b32 s45, s45, 2
    s_and_b32 s9, s4, 3
    s_add_u32 s45, s45, s9
    s_mul_i32 s9, s45, 5120
    s_add_u32 s10, s9, 11550720
    v_lshlrev_b32 v9, 4, v0
    v_add_u32 v8, 4096, v9
    s_add_u32 s14, s12, s10
    s_addc_u32 s15, s13, 0
    s_mov_b32 s40, s14
    s_and_b32 s41, s15, 0xffff
    s_mov_b32 s42, 0
    s_mov_b32 s43, 0x20000
    s_sub_u32 s42, 2211840, s9
    s_mul_i32 s46, s3, 40960
    s_waitcnt vmcnt(4)
    s_barrier
    s_cmp_lg_u32 s3, 0
    s_cbranch_scc1 pubr_43
    s_lshl_b32 s74, s2, 10
    s_add_u32 s74, s74, 458752
    v_lshl_add_u32 v56, v0, 4, s74
    v_mov_b32 v52, s70
    v_mov_b32 v53, s71
    v_mov_b32 v54, s70
    v_mov_b32 v55, s71
    global_store_dwordx4 v56, v[52:55], s[12:13] sc1
    s_nop 1
pubr_43:
    s_cmp_lg_u32 s3, 0
    s_cbranch_scc1 pub_44
    s_lshl_b32 s74, s2, 7
    s_add_u32 s74, s74, 65536
    v_lshl_add_u32 v60, v0, 3, s74
    v_mov_b32 v58, s70
    v_mov_b32 v59, s71
    s_mov_b64 exec, 0xffff
    global_store_dwordx2 v60, v[58:59], s[12:13] sc1
    s_mov_b64 exec, -1
pub_44:
    s_mov_b32 s74, 0x100000
f2_slow_46:
    v_cmp_ne_u64 vcc, s[70:71], v[236:237]
    s_cbranch_vccz f2_ok_45
    s_sleep 4
f2_ld_47:
    s_mov_b64 exec, 1
    global_load_dwordx2 v[236:237], v240, s[12:13] sc1
    s_mov_b64 exec, -1
    s_waitcnt vmcnt(0)
    s_sub_u32 s74, s74, 1
    s_cbranch_scc0 f2_slow_46
f2_ok_45:
    s_add_u32 s47, s46, 0
    buffer_load_dwordx4 a[0:3], v9, s[40:43], s47 offen offset:0 sc1
    s_add_u32 s47, s46, 0
    buffer_load_dwordx4 a[4:7], v9, s[40:43], s47 offen offset:1024 sc1
    s_add_u32 s47, s46, 0
    buffer_load_dwordx4 a[8:11], v9, s[40:43], s47 offen offset:2048 sc1
    s_add_u32 s47, s46, 0
    buffer_load_dwordx4 a[12:15], v9, s[40:43], s47 offen offset:3072 sc1
    s_add_u32 s47, s46, 0
    buffer_load_dwordx4 a[16:19], v8, s[40:43], s47 offen offset:0 sc1
    s_add_u32 s47, s46, 163840
    buffer_load_dwordx4 a[20:23], v9, s[40:43], s47 offen offset:0 sc1
    s_add_u32 s47, s46, 163840
    buffer_load_dwordx4 a[24:27], v9, s[40:43], s47 offen offset:1024 sc1
    s_add_u32 s47, s46, 163840
    buffer_load_dwordx4 a[28:31], v9, s[40:43], s47 offen offset:2048 sc1
    s_add_u32 s47, s46, 163840
    buffer_load_dwordx4 a[32:35], v9, s[40:43], s47 offen offset:3072 sc1
    s_add_u32 s47, s46, 163840
    buffer_load_dwordx4 a[36:39], v8, s[40:43], s47 offen offset:0 sc1
    s_add_u32 s47, s46, 327680
    buffer_load_dwordx4 a[40:43], v9, s[40:43], s47 offen offset:0 sc1
    s_add_u32 s47, s46, 327680
    buffer_load_dwordx4 a[44:47], v9, s[40:43], s47 offen offset:1024 sc1
    s_and_b32 s8, s3, 1
    s_lshl_b32 s7, s6, 1
    s_add_u32 s7, s7, s8
    s_lshr_b32 s4, s3, 1
    v_lshrrev_b32 v2, 4, v0
    v_and_b32 v3, 15, v0
    v_lshlrev_b32 v4, 1, v2
    v_xor_b32 v4, v4, v3
    v_lshlrev_b32 v2, 12, v2
    s_lshl_b32 s9, s3, 15
    s_lshl_b32 s10, s5, 9
    s_add_u32 s9, s9, s10
    v_add_u32 v2, s9, v2
    v_lshl_add_u32 v5, v4, 4, v2
    v_xor_b32 v4, 8, v4
    v_lshl_add_u32 v6, v4, 4, v2
    v_add_u32 v6, 16384, v6
    s_lshl_b32 s26, s3, 11
    s_lshl_b32 s9, s4, 13
    v_lshrrev_b32 v2, 2, v0
    v_and_b32 v3, 7, v2
    v_lshlrev_b32 v3, 1, v3
    v_bfe_u32 v4, v0, 1, 1
    v_or_b32 v3, v3, v4
    v_lshlrev_b32 v2, 8, v2
    v_and_b32 v4, 1, v0
    v_lshl_add_u32 v2, v4, 3, v2
    v_add_u32 v2, s9, v2
    v_xor_b32 v4, 0, v3
    v_lshl_add_u32 v10, v4, 4, v2
    v_xor_b32 v4, 2, v3
    v_lshl_add_u32 v11, v4, 4, v2
    v_xor_b32 v4, 4, v3
    v_lshl_add_u32 v12, v4, 4, v2
    v_xor_b32 v4, 6, v3
    v_lshl_add_u32 v13, v4, 4, v2
    v_xor_b32 v4, 8, v3
    v_lshl_add_u32 v14, v4, 4, v2
    v_xor_b32 v4, 10, v3
    v_lshl_add_u32 v15, v4, 4, v2
    v_xor_b32 v4, 12, v3
    v_lshl_add_u32 v16, v4, 4, v2
    v_xor_b32 v4, 14, v3
    v_lshl_add_u32 v17, v4, 4, v2
    v_lshrrev_b32 v2, 2, v0
    v_bfe_u32 v3, v0, 3, 2
    v_and_b32 v4, 3, v0
    v_lshlrev_b32 v2, 7, v2
    v_lshl_add_u32 v2, v4, 3, v2
    v_add_u32 v2, 69632, v2
    s_lshl_b32 s9, s8, 1
    v_xor_b32 v3, s9, v3
    v_lshl_add_u32 v18, v3, 5, v2
    v_xor_b32 v3, 1, v3
    v_lshl_add_u32 v19, v3, 5, v2
    v_add_u32 v28, 0x10000, v18
    v_add_u32 v29, 0x10000, v19
    s_add_u32 s14, s12, 8884224
    s_addc_u32 s15, s13, 0
    s_mov_b32 s16, s14
    s_and_b32 s17, s15, 0xffff
    s_mov_b32 s18, 2621440
    s_mov_b32 s19, 0x20000
    s_lshl_b32 s9, s5, 2
    s_lshl_b32 s10, s4, 1
    s_add_u32 s9, s9, s10
    v_add_u32 v20, s9, v0
    s_mul_i32 s10, s6, 37
    s_lshr_b32 s10, s10, 8
    s_mul_i32 s10, s10, 55
    s_lshl_b32 s11, s6, 3
    s_sub_u32 s10, s11, s10
    s_add_u32 s10, s10, 4294966720
    v_lshl_add_u32 v21, v0, 2, s10
    v_cmp_gt_u32 vcc, 2, v0
    s_lshl_b32 s9, s9, 9
    s_add_u32 s9, s9, 11505664
    v_cndmask_b32 v20, v21, v20, vcc
    v_lshlrev_b32 v20, 7, v20
    v_add_u32 v20, 158720, v20
    v_add_u32 v21, s9, v9
    v_bfe_u32 v22, v0, 3, 2
    v_mul_u32_u24 v22, 6912, v22
    v_and_b32 v23, 7, v0
    v_lshl_add_u32 v22, v23, 4, v22
    s_lshl_b32 s9, s7, 7
    s_add_u32 s9, s9, 11522048
    v_add_u32 v22, s9, v22
    v_mov_b32 v24, s70
    v_mov_b32 v25, s71
    s_lshl_b32 s30, s3, 10
    s_add_u32 s30, s30, 65536
    s_lshl_b32 s31, s3, 9
    s_add_u32 s31, s31, 159744
    v_and_b32 v26, 15, v0
    v_lshl_add_u32 v26, v26, 3, s30
    v_lshrrev_b32 v27, 4, v0
    v_lshl_add_u32 v27, v27, 4, s31
    s_mul_i32 s9, s3, 40
    s_add_u32 s47, s46, 327680
    buffer_load_dwordx4 a[48:51], v9, s[40:43], s47 offen offset:2048 sc1
    s_add_u32 s47, s46, 327680
    buffer_load_dwordx4 a[52:55], v9, s[40:43], s47 offen offset:3072 sc1
    s_add_u32 s47, s46, 327680
    buffer_load_dwordx4 a[56:59], v8, s[40:43], s47 offen offset:0 sc1
    s_add_u32 s47, s46, 491520
    buffer_load_dwordx4 a[60:63], v9, s[40:43], s47 offen offset:0 sc1
    s_add_u32 s47, s46, 491520
    buffer_load_dwordx4 a[64:67], v9, s[40:43], s47 offen offset:1024 sc1
    s_add_u32 s47, s46, 491520
    buffer_load_dwordx4 a[68:71], v9, s[40:43], s47 offen offset:2048 sc1
    s_add_u32 s47, s46, 491520
    buffer_load_dwordx4 a[72:75], v9, s[40:43], s47 offen offset:3072 sc1
    s_add_u32 s47, s46, 491520
    buffer_load_dwordx4 a[76:79], v8, s[40:43], s47 offen offset:0 sc1
    s_add_u32 s47, s46, 655360
    buffer_load_dwordx4 a[80:83], v9, s[40:43], s47 offen offset:0 sc1
    s_add_u32 s47, s46, 655360
    buffer_load_dwordx4 a[84:87], v9, s[40:43], s47 offen offset:1024 sc1
    v_add_u32 v54, s9, v0
    s_and_b32 s74, s2, 7
    s_lshl_b32 s74, s74, 7
    s_add_u32 s74, s74, 458752
    v_lshl_add_u32 v54, v54, 10, s74
    s_mov_b32 s74, 0x100000
    s_mov_b32 exec_hi, 0xff
poll_48:
    global_load_dwordx2 v[52:53], v54, s[12:13] sc1
    s_waitcnt vmcnt(0)
    v_cmp_ne_u64 vcc, s[70:71], v[52:53]
    s_and_b64 exec, exec, vcc
    s_cbranch_execz polld_49
    s_sleep 1
    s_sub_u32 s74, s74, 1
    s_cbranch_scc0 poll_48
polld_49:
    s_mov_b64 exec, -1
    s_barrier
    s_add_u32 m0, s26, 0
    s_mov_b32 s25, 0
    s_nop 0
    buffer_load_dwordx4 v5, s[16:19], s25 offen offset:0 sc1 lds
    s_add_u32 m0, s26, 1024
    s_nop 0
    buffer_load_dwordx4 v6, s[16:19], s25 offen offset:0 sc1 lds
    s_add_u32 m0, s26, 7936
    s_nop 0
    buffer_load_dwordx4 v5, s[16:19], s25 offen offset:256 sc1 lds
    s_add_u32 m0, s26, 8960
    s_nop 0
    buffer_load_dwordx4 v6, s[16:19], s25 offen offset:256 sc1 lds
    s_add_u32 m0, s26, 16384
    s_mov_b32 s25, 131072
    s_nop 0
    buffer_load_dwordx4 v5, s[16:19], s25 offen offset:0 sc1 lds
    s_add_u32 m0, s26, 17408
    s_nop 0
    buffer_load_dwordx4 v6, s[16:19], s25 offen offset:0 sc1 lds
    s_add_u32 m0, s26, 24320
    s_nop 0
    buffer_load_dwordx4 v5, s[16:19], s25 offen offset:256 sc1 lds
    s_add_u32 m0, s26, 25344
    s_nop 0
    buffer_load_dwordx4 v6, s[16:19], s25 offen offset:256 sc1 lds
    s_add_u32 m0, s26, 32768
    s_mov_b32 s25, 262144
    s_nop 0
    buffer_load_dwordx4 v5, s[16:19], s25 offen offset:0 sc1 lds
    s_add_u32 m0, s26, 33792
    s_nop 0
    buffer_load_dwordx4 v6, s[16:19], s25 offen offset:0 sc1 lds
    s_add_u32 m0, s26, 40704
    s_nop 0
    buffer_load_dwordx4 v5, s[16:19], s25 offen offset:256 sc1 lds
    s_add_u32 m0, s26, 41728
    s_nop 0
    buffer_load_dwordx4 v6, s[16:19], s25 offen offset:256 sc1 lds
    ds_read_b64_tr_b16 v[32:33], v18 offset:0
    ds_read_b64_tr_b16 v[34:35], v18 offset:2048
    ds_read_b64_tr_b16 v[36:37], v18 offset:4096
    ds_read_b64_tr_b16 v[38:39], v18 offset:6144
    ds_read_b64_tr_b16 v[40:41], v19 offset:0
    ds_read_b64_tr_b16 v[42:43], v19 offset:2048
    ds_read_b64_tr_b16 v[44:45], v19 offset:4096
    ds_read_b64_tr_b16 v[46:47], v19 offset:6144
    s_cmp_lg_u32 s3, 0
    s_cbranch_scc1 pub_50
    s_lshl_b32 s74, s2, 7
    s_add_u32 s74, s74, 131072
    v_lshl_add_u32 v4, v0, 3, s74
    v_mov_b32 v2, s70
    v_mov_b32 v3, s71
    s_mov_b64 exec, 0xffff
    global_store_dwordx2 v4, v[2:3], s[12:13] sc1
    s_mov_b64 exec, -1
pub_50:
    s_waitcnt vmcnt(8)
    s_barrier
    ds_read_b64_tr_b16 v[64:65], v10 offset:0
    ds_read_b64_tr_b16 v[66:67], v10 offset:4096
    ds_read_b64_tr_b16 v[68:69], v11 offset:0
    ds_read_b64_tr_b16 v[70:71], v11 offset:4096
    ds_read_b64_tr_b16 v[72:73], v12 offset:0
    ds_read_b64_tr_b16 v[74:75], v12 offset:4096
    ds_read_b64_tr_b16 v[76:77], v13 offset:0
    ds_read_b64_tr_b16 v[78:79], v13 offset:4096
    ds_read_b64_tr_b16 v[80:81], v14 offset:0
    ds_read_b64_tr_b16 v[82:83], v14 offset:4096
    ds_read_b64_tr_b16 v[84:85], v15 offset:0
    ds_read_b64_tr_b16 v[86:87], v15 offset:4096
    ds_read_b64_tr_b16 v[88:89], v16 offset:0
    ds_read_b64_tr_b16 v[90:91], v16 offset:4096
    ds_read_b64_tr_b16 v[92:93], v17 offset:0
    ds_read_b64_tr_b16 v[94:95], v17 offset:4096
    s_add_u32 m0, s26, 49152
    s_mov_b32 s25, 393216
    s_nop 0
    buffer_load_dwordx4 v5, s[16:19], s25 offen offset:0 sc1 lds
    s_add_u32 m0, s26, 50176
    s_nop 0
    buffer_load_dwordx4 v6, s[16:19], s25 offen offset:0 sc1 lds
    s_add_u32 m0, s26, 57088
    s_nop 0
    buffer_load_dwordx4 v5, s[16:19], s25 offen offset:256 sc1 lds
    s_add_u32 m0, s26, 58112
    s_nop 0
    buffer_load_dwordx4 v6, s[16:19], s25 offen offset:256 sc1 lds
    s_waitcnt lgkmcnt(0)
    s_waitcnt vmcnt(8)
    s_barrier
    v_mfma_f32_16x16x32_bf16 v[128:131], v[32:35], v[64:67], 0
    ds_read_b64_tr_b16 v[48:49], v18 offset:8192
    s_add_u32 m0, s26, 0
    s_mov_b32 s25, 524288
    v_mfma_f32_16x16x32_bf16 v[160:163], v[36:39], v[64:67], 0
    buffer_load_dwordx4 v5, s[16:19], s25 offen offset:0 sc1 lds
    v_mfma_f32_16x16x32_bf16 v[192:195], v[40:43], v[64:67], 0
    ds_read_b64_tr_b16 v[50:51], v18 offset:10240
    v_mfma_f32_16x16x32_bf16 v[224:227], v[44:47], v[64:67], 0
    ds_read_b64_tr_b16 v[52:53], v18 offset:12288
    v_mfma_f32_16x16x32_bf16 v[132:135], v[32:35], v[68:71], 0
    ds_read_b64_tr_b16 v[54:55], v18 offset:14336
    v_mfma_f32_16x16x32_bf16 v[164:167], v[36:39], v[68:71], 0
    ds_read_b64_tr_b16 v[56:57], v19 offset:8192
    v_mfma_f32_16x16x32_bf16 v[196:199], v[40:43], v[68:71], 0
    ds_read_b64_tr_b16 v[58:59], v19 offset:10240
    v_mfma_f32_16x16x32_bf16 v[228:231], v[44:47], v[68:71], 0
    ds_read_b64_tr_b16 v[60:61], v19 offset:12288
    s_add_u32 m0, s26, 1024
    v_mfma_f32_16x16x32_bf16 v[136:139], v[32:35], v[72:75], 0
    buffer_load_dwordx4 v6, s[16:19], s25 offen offset:0 sc1 lds
    v_mfma_f32_16x16x32_bf16 v[168:171], v[36:39], v[72:75], 0
    ds_read_b64_tr_b16 v[62:63], v19 offset:14336
    v_mfma_f32_16x16x32_bf16 v[200:203], v[40:43], v[72:75], 0
    ds_read_b64_tr_b16 v[96:97], v10 offset:16384
    v_mfma_f32_16x16x32_bf16 v[232:235], v[44:47], v[72:75], 0
    ds_read_b64_tr_b16 v[98:99], v10 offset:20480
    v_mfma_f32_16x16x32_bf16 v[140:143], v[32:35], v[76:79], 0
    ds_read_b64_tr_b16 v[100:101], v11 offset:16384
    v_mfma_f32_16x16x32_bf16 v[172:175], v[36:39], v[76:79], 0
    ds_read_b64_tr_b16 v[102:103], v11 offset:20480
    v_mfma_f32_16x16x32_bf16 v[204:207], v[40:43], v[76:79], 0
    ds_read_b64_tr_b16 v[104:105], v12 offset:16384
    v_mfma_f32_16x16x32_bf16 v[236:239], v[44:47], v[76:79], 0
    ds_read_b64_tr_b16 v[106:107], v12 offset:20480
    s_add_u32 m0, s26, 7936
    v_mfma_f32_16x16x32_bf16 v[144:147], v[32:35], v[80:83], 0
    buffer_load_dwordx4 v5, s[16:19], s25 offen offset:256 sc1 lds
    v_mfma_f32_16x16x32_bf16 v[176:179], v[36:39], v[80:83], 0
    ds_read_b64_tr_b16 v[108:109], v13 offset:16384
    v_mfma_f32_16x16x32_bf16 v[208:211], v[40:43], v[80:83], 0
    ds_read_b64_tr_b16 v[110:111], v13 offset:20480
    v_mfma_f32_16x16x32_bf16 v[240:243], v[44:47], v[80:83], 0
    ds_read_b64_tr_b16 v[112:113], v14 offset:16384
    v_mfma_f32_16x16x32_bf16 v[148:151], v[32:35], v[84:87], 0
    ds_read_b64_tr_b16 v[114:115], v14 offset:20480
    v_mfma_f32_16x16x32_bf16 v[180:183], v[36:39], v[84:87], 0
    ds_read_b64_tr_b16 v[116:117], v15 offset:16384
    v_mfma_f32_16x16x32_bf16 v[212:215], v[40:43], v[84:87], 0
    ds_read_b64_tr_b16 v[118:119], v15 offset:20480
    v_mfma_f32_16x16x32_bf16 v[244:247], v[44:47], v[84:87], 0
    ds_read_b64_tr_b16 v[120:121], v16 offset:16384
    s_add_u32 m0, s26, 8960
    v_mfma_f32_16x16x32_bf16 v[152:155], v[32:35], v[88:91], 0
    buffer_load_dwordx4 v6, s[16:19], s25 offen offset:256 sc1 lds
    v_mfma_f32_16x16x32_bf16 v[184:187], v[36:39], v[88:91], 0
    ds_read_b64_tr_b16 v[122:123], v16 offset:20480
    v_mfma_f32_16x16x32_bf16 v[216:219], v[40:43], v[88:91], 0
    ds_read_b64_tr_b16 v[124:125], v17 offset:16384
    v_mfma_f32_16x16x32_bf16 v[248:251], v[44:47], v[88:91], 0
    ds_read_b64_tr_b16 v[126:127], v17 offset:20480
    v_mfma_f32_16x16x32_bf16 v[156:159], v[32:35], v[92:95], 0
    v_mfma_f32_16x16x32_bf16 v[188:191], v[36:39], v[92:95], 0
    v_mfma_f32_16x16x32_bf16 v[220:223], v[40:43], v[92:95], 0
    v_mfma_f32_16x16x32_bf16 v[252:255], v[44:47], v[92:95], 0
    s_waitcnt lgkmcnt(0)
    s_waitcnt vmcnt(8)
    s_barrier
    v_mfma_f32_16x16x32_bf16 v[128:131], v[48:51], v[96:99], v[128:131]
    ds_read_b64_tr_b16 v[32:33], v18 offset:16384
    s_add_u32 m0, s26, 16384
    s_mov_b32 s25, 655360
    v_mfma_f32_16x16x32_bf16 v[160:163], v[52:55], v[96:99], v[160:163]
    buffer_load_dwordx4 v5, s[16:19], s25 offen offset:0 sc1 lds
    v_mfma_f32_16x16x32_bf16 v[192:195], v[56:59], v[96:99], v[192:195]
    ds_read_b64_tr_b16 v[34:35], v18 offset:18432
    v_mfma_f32_16x16x32_bf16 v[224:227], v[60:63], v[96:99], v[224:227]
    ds_read_b64_tr_b16 v[36:37], v18 offset:20480
    v_mfma_f32_16x16x32_bf16 v[132:135], v[48:51], v[100:103], v[132:135]
    ds_read_b64_tr_b16 v[38:39], v18 offset:22528
    v_mfma_f32_16x16x32_bf16 v[164:167], v[52:55], v[100:103], v[164:167]
    ds_read_b64_tr_b16 v[40:41], v19 offset:16384
    v_mfma_f32_16x16x32_bf16 v[196:199], v[56:59], v[100:103], v[196:199]
    ds_read_b64_tr_b16 v[42:43], v19 offset:18432
    v_mfma_f32_16x16x32_bf16 v[228:231], v[60:63], v[100:103], v[228:231]
    ds_read_b64_tr_b16 v[44:45], v19 offset:20480
    s_add_u32 m0, s26, 17408
    v_mfma_f32_16x16x32_bf16 v[136:139], v[48:51], v[104:107], v[136:139]
    buffer_load_dwordx4 v6, s[16:19], s25 offen offset:0 sc1 lds
    v_mfma_f32_16x16x32_bf16 v[168:171], v[52:55], v[104:107], v[168:171]
    ds_read_b64_tr_b16 v[46:47], v19 offset:22528
    v_mfma_f32_16x16x32_bf16 v[200:203], v[56:59], v[104:107], v[200:203]
    ds_read_b64_tr_b16 v[64:65], v10 offset:32768
    v_mfma_f32_16x16x32_bf16 v[232:235], v[60:63], v[104:107], v[232:235]
    ds_read_b64_tr_b16 v[66:67], v10 offset:36864
    v_mfma_f32_16x16x32_bf16 v[140:143], v[48:51], v[108:111], v[140:143]
    ds_read_b64_tr_b16 v[68:69], v11 offset:32768
    v_mfma_f32_16x16x32_bf16 v[172:175], v[52:55], v[108:111], v[172:175]
    ds_read_b64_tr_b16 v[70:71], v11 offset:36864
    v_mfma_f32_16x16x32_bf16 v[204:207], v[56:59], v[108:111], v[204:207]
    ds_read_b64_tr_b16 v[72:73], v12 offset:32768
    v_mfma_f32_16x16x32_bf16 v[236:239], v[60:63], v[108:111], v[236:239]
    ds_read_b64_tr_b16 v[74:75], v12 offset:36864
    s_add_u32 m0, s26, 24320
    v_mfma_f32_16x16x32_bf16 v[144:147], v[48:51], v[112:115], v[144:147]
    buffer_load_dwordx4 v5, s[16:19], s25 offen offset:256 sc1 lds
    v_mfma_f32_16x16x32_bf16 v[176:179], v[52:55], v[112:115], v[176:179]
    ds_read_b64_tr_b16 v[76:77], v13 offset:32768
    v_mfma_f32_16x16x32_bf16 v[208:211], v[56:59], v[112:115], v[208:211]
    ds_read_b64_tr_b16 v[78:79], v13 offset:36864
    v_mfma_f32_16x16x32_bf16 v[240:243], v[60:63], v[112:115], v[240:243]
    ds_read_b64_tr_b16 v[80:81], v14 offset:32768
    v_mfma_f32_16x16x32_bf16 v[148:151], v[48:51], v[116:119], v[148:151]
    ds_read_b64_tr_b16 v[82:83], v14 offset:36864
    v_mfma_f32_16x16x32_bf16 v[180:183], v[52:55], v[116:119], v[180:183]
    ds_read_b64_tr_b16 v[84:85], v15 offset:32768
    v_mfma_f32_16x16x32_bf16 v[212:215], v[56:59], v[116:119], v[212:215]
    ds_read_b64_tr_b16 v[86:87], v15 offset:36864
    v_mfma_f32_16x16x32_bf16 v[244:247], v[60:63], v[116:119], v[244:247]
    ds_read_b64_tr_b16 v[88:89], v16 offset:32768
    s_add_u32 m0, s26, 25344
    v_mfma_f32_16x16x32_bf16 v[152:155], v[48:51], v[120:123], v[152:155]
    buffer_load_dwordx4 v6, s[16:19], s25 offen offset:256 sc1 lds
    v_mfma_f32_16x16x32_bf16 v[184:187], v[52:55], v[120:123], v[184:187]
    ds_read_b64_tr_b16 v[90:91], v16 offset:36864
    v_mfma_f32_16x16x32_bf16 v[216:219], v[56:59], v[120:123], v[216:219]
    ds_read_b64_tr_b16 v[92:93], v17 offset:32768
    v_mfma_f32_16x16x32_bf16 v[248:251], v[60:63], v[120:123], v[248:251]
    ds_read_b64_tr_b16 v[94:95], v17 offset:36864
    v_mfma_f32_16x16x32_bf16 v[156:159], v[48:51], v[124:127], v[156:159]
    v_mfma_f32_16x16x32_bf16 v[188:191], v[52:55], v[124:127], v[188:191]
    v_mfma_f32_16x16x32_bf16 v[220:223], v[56:59], v[124:127], v[220:223]
    v_mfma_f32_16x16x32_bf16 v[252:255], v[60:63], v[124:127], v[252:255]
    s_waitcnt lgkmcnt(0)
    s_waitcnt vmcnt(8)
    s_barrier
    v_mfma_f32_16x16x32_bf16 v[128:131], v[32:35], v[64:67], v[128:131]
    ds_read_b64_tr_b16 v[48:49], v18 offset:24576
    s_add_u32 m0, s26, 32768
    s_mov_b32 s25, 786432
    v_mfma_f32_16x16x32_bf16 v[160:163], v[36:39], v[64:67], v[160:163]
    buffer_load_dwordx4 v5, s[16:19], s25 offen offset:0 sc1 lds
    v_mfma_f32_16x16x32_bf16 v[192:195], v[40:43], v[64:67], v[192:195]
    ds_read_b64_tr_b16 v[50:51], v18 offset:26624
    v_mfma_f32_16x16x32_bf16 v[224:227], v[44:47], v[64:67], v[224:227]
    ds_read_b64_tr_b16 v[52:53], v18 offset:28672
    v_mfma_f32_16x16x32_bf16 v[132:135], v[32:35], v[68:71], v[132:135]
    ds_read_b64_tr_b16 v[54:55], v18 offset:30720
    v_mfma_f32_16x16x32_bf16 v[164:167], v[36:39], v[68:71], v[164:167]
    ds_read_b64_tr_b16 v[56:57], v19 offset:24576
    v_mfma_f32_16x16x32_bf16 v[196:199], v[40:43], v[68:71], v[196:199]
    ds_read_b64_tr_b16 v[58:59], v19 offset:26624
    v_mfma_f32_16x16x32_bf16 v[228:231], v[44:47], v[68:71], v[228:231]
    ds_read_b64_tr_b16 v[60:61], v19 offset:28672
    s_add_u32 m0, s26, 33792
    v_mfma_f32_16x16x32_bf16 v[136:139], v[32:35], v[72:75], v[136:139]
    buffer_load_dwordx4 v6, s[16:19], s25 offen offset:0 sc1 lds
    v_mfma_f32_16x16x32_bf16 v[168:171], v[36:39], v[72:75], v[168:171]
    ds_read_b64_tr_b16 v[62:63], v19 offset:30720
    v_mfma_f32_16x16x32_bf16 v[200:203], v[40:43], v[72:75], v[200:203]
    ds_read_b64_tr_b16 v[96:97], v10 offset:49152
    v_mfma_f32_16x16x32_bf16 v[232:235], v[44:47], v[72:75], v[232:235]
    ds_read_b64_tr_b16 v[98:99], v10 offset:53248
    v_mfma_f32_16x16x32_bf16 v[140:143], v[32:35], v[76:79], v[140:143]
    ds_read_b64_tr_b16 v[100:101], v11 offset:49152
    v_mfma_f32_16x16x32_bf16 v[172:175], v[36:39], v[76:79], v[172:175]
    ds_read_b64_tr_b16 v[102:103], v11 offset:53248
    v_mfma_f32_16x16x32_bf16 v[204:207], v[40:43], v[76:79], v[204:207]
    ds_read_b64_tr_b16 v[104:105], v12 offset:49152
    v_mfma_f32_16x16x32_bf16 v[236:239], v[44:47], v[76:79], v[236:239]
    ds_read_b64_tr_b16 v[106:107], v12 offset:53248
    s_add_u32 m0, s26, 40704
    v_mfma_f32_16x16x32_bf16 v[144:147], v[32:35], v[80:83], v[144:147]
    buffer_load_dwordx4 v5, s[16:19], s25 offen offset:256 sc1 lds
    v_mfma_f32_16x16x32_bf16 v[176:179], v[36:39], v[80:83], v[176:179]
    ds_read_b64_tr_b16 v[108:109], v13 offset:49152
    v_mfma_f32_16x16x32_bf16 v[208:211], v[40:43], v[80:83], v[208:211]
    ds_read_b64_tr_b16 v[110:111], v13 offset:53248
    v_mfma_f32_16x16x32_bf16 v[240:243], v[44:47], v[80:83], v[240:243]
    ds_read_b64_tr_b16 v[112:113], v14 offset:49152
    v_mfma_f32_16x16x32_bf16 v[148:151], v[32:35], v[84:87], v[148:151]
    ds_read_b64_tr_b16 v[114:115], v14 offset:53248
    v_mfma_f32_16x16x32_bf16 v[180:183], v[36:39], v[84:87], v[180:183]
    ds_read_b64_tr_b16 v[116:117], v15 offset:49152
    v_mfma_f32_16x16x32_bf16 v[212:215], v[40:43], v[84:87], v[212:215]
    ds_read_b64_tr_b16 v[118:119], v15 offset:53248
    v_mfma_f32_16x16x32_bf16 v[244:247], v[44:47], v[84:87], v[244:247]
    ds_read_b64_tr_b16 v[120:121], v16 offset:49152
    s_add_u32 m0, s26, 41728
    v_mfma_f32_16x16x32_bf16 v[152:155], v[32:35], v[88:91], v[152:155]
    buffer_load_dwordx4 v6, s[16:19], s25 offen offset:256 sc1 lds
    v_mfma_f32_16x16x32_bf16 v[184:187], v[36:39], v[88:91], v[184:187]
    ds_read_b64_tr_b16 v[122:123], v16 offset:53248
    v_mfma_f32_16x16x32_bf16 v[216:219], v[40:43], v[88:91], v[216:219]
    ds_read_b64_tr_b16 v[124:125], v17 offset:49152
    v_mfma_f32_16x16x32_bf16 v[248:251], v[44:47], v[88:91], v[248:251]
    ds_read_b64_tr_b16 v[126:127], v17 offset:53248
    v_mfma_f32_16x16x32_bf16 v[156:159], v[32:35], v[92:95], v[156:159]
    v_mfma_f32_16x16x32_bf16 v[188:191], v[36:39], v[92:95], v[188:191]
    v_mfma_f32_16x16x32_bf16 v[220:223], v[40:43], v[92:95], v[220:223]
    v_mfma_f32_16x16x32_bf16 v[252:255], v[44:47], v[92:95], v[252:255]
    s_waitcnt lgkmcnt(0)
    s_waitcnt vmcnt(8)
    s_barrier
    v_mfma_f32_16x16x32_bf16 v[128:131], v[48:51], v[96:99], v[128:131]
    ds_read_b64_tr_b16 v[32:33], v18 offset:32768
    s_add_u32 m0, s26, 49152
    s_mov_b32 s25, 917504
    v_mfma_f32_16x16x32_bf16 v[160:163], v[52:55], v[96:99], v[160:163]
    buffer_load_dwordx4 v5, s[16:19], s25 offen offset:0 sc1 lds
    v_mfma_f32_16x16x32_bf16 v[192:195], v[56:59], v[96:99], v[192:195]
    ds_read_b64_tr_b16 v[34:35], v18 offset:34816
    v_mfma_f32_16x16x32_bf16 v[224:227], v[60:63], v[96:99], v[224:227]
    ds_read_b64_tr_b16 v[36:37], v18 offset:36864
    v_mfma_f32_16x16x32_bf16 v[132:135], v[48:51], v[100:103], v[132:135]
    ds_read_b64_tr_b16 v[38:39], v18 offset:38912
    v_mfma_f32_16x16x32_bf16 v[164:167], v[52:55], v[100:103], v[164:167]
    ds_read_b64_tr_b16 v[40:41], v19 offset:32768
    v_mfma_f32_16x16x32_bf16 v[196:199], v[56:59], v[100:103], v[196:199]
    ds_read_b64_tr_b16 v[42:43], v19 offset:34816
    v_mfma_f32_16x16x32_bf16 v[228:231], v[60:63], v[100:103], v[228:231]
    ds_read_b64_tr_b16 v[44:45], v19 offset:36864
    s_add_u32 m0, s26, 50176
    v_mfma_f32_16x16x32_bf16 v[136:139], v[48:51], v[104:107], v[136:139]
    buffer_load_dwordx4 v6, s[16:19], s25 offen offset:0 sc1 lds
    v_mfma_f32_16x16x32_bf16 v[168:171], v[52:55], v[104:107], v[168:171]
    ds_read_b64_tr_b16 v[46:47], v19 offset:38912
    v_mfma_f32_16x16x32_bf16 v[200:203], v[56:59], v[104:107], v[200:203]
    ds_read_b64_tr_b16 v[64:65], v10 offset:0
    v_mfma_f32_16x16x32_bf16 v[232:235], v[60:63], v[104:107], v[232:235]
    ds_read_b64_tr_b16 v[66:67], v10 offset:4096
    v_mfma_f32_16x16x32_bf16 v[140:143], v[48:51], v[108:111], v[140:143]
    ds_read_b64_tr_b16 v[68:69], v11 offset:0
    v_mfma_f32_16x16x32_bf16 v[172:175], v[52:55], v[108:111], v[172:175]
    ds_read_b64_tr_b16 v[70:71], v11 offset:4096
    v_mfma_f32_16x16x32_bf16 v[204:207], v[56:59], v[108:111], v[204:207]
    ds_read_b64_tr_b16 v[72:73], v12 offset:0
    v_mfma_f32_16x16x32_bf16 v[236:239], v[60:63], v[108:111], v[236:239]
    ds_read_b64_tr_b16 v[74:75], v12 offset:4096
    s_add_u32 m0, s26, 57088
    v_mfma_f32_16x16x32_bf16 v[144:147], v[48:51], v[112:115], v[144:147]
    buffer_load_dwordx4 v5, s[16:19], s25 offen offset:256 sc1 lds
    v_mfma_f32_16x16x32_bf16 v[176:179], v[52:55], v[112:115], v[176:179]
    ds_read_b64_tr_b16 v[76:77], v13 offset:0
    v_mfma_f32_16x16x32_bf16 v[208:211], v[56:59], v[112:115], v[208:211]
    ds_read_b64_tr_b16 v[78:79], v13 offset:4096
    v_mfma_f32_16x16x32_bf16 v[240:243], v[60:63], v[112:115], v[240:243]
    ds_read_b64_tr_b16 v[80:81], v14 offset:0
    v_mfma_f32_16x16x32_bf16 v[148:151], v[48:51], v[116:119], v[148:151]
    ds_read_b64_tr_b16 v[82:83], v14 offset:4096
    v_mfma_f32_16x16x32_bf16 v[180:183], v[52:55], v[116:119], v[180:183]
    ds_read_b64_tr_b16 v[84:85], v15 offset:0
    v_mfma_f32_16x16x32_bf16 v[212:215], v[56:59], v[116:119], v[212:215]
    ds_read_b64_tr_b16 v[86:87], v15 offset:4096
    v_mfma_f32_16x16x32_bf16 v[244:247], v[60:63], v[116:119], v[244:247]
    ds_read_b64_tr_b16 v[88:89], v16 offset:0
    s_add_u32 m0, s26, 58112
    v_mfma_f32_16x16x32_bf16 v[152:155], v[48:51], v[120:123], v[152:155]
    buffer_load_dwordx4 v6, s[16:19], s25 offen offset:256 sc1 lds
    v_mfma_f32_16x16x32_bf16 v[184:187], v[52:55], v[120:123], v[184:187]
    ds_read_b64_tr_b16 v[90:91], v16 offset:4096
    v_mfma_f32_16x16x32_bf16 v[216:219], v[56:59], v[120:123], v[216:219]
    ds_read_b64_tr_b16 v[92:93], v17 offset:0
    v_mfma_f32_16x16x32_bf16 v[248:251], v[60:63], v[120:123], v[248:251]
    ds_read_b64_tr_b16 v[94:95], v17 offset:4096
    v_mfma_f32_16x16x32_bf16 v[156:159], v[48:51], v[124:127], v[156:159]
    v_mfma_f32_16x16x32_bf16 v[188:191], v[52:55], v[124:127], v[188:191]
    v_mfma_f32_16x16x32_bf16 v[220:223], v[56:59], v[124:127], v[220:223]
    v_mfma_f32_16x16x32_bf16 v[252:255], v[60:63], v[124:127], v[252:255]
    s_waitcnt lgkmcnt(0)
    s_waitcnt vmcnt(8)
    s_barrier
    v_mfma_f32_16x16x32_bf16 v[128:131], v[32:35], v[64:67], v[128:131]
    ds_read_b64_tr_b16 v[48:49], v18 offset:40960
    s_add_u32 m0, s26, 0
    s_mov_b32 s25, 1048576
    v_mfma_f32_16x16x32_bf16 v[160:163], v[36:39], v[64:67], v[160:163]
    buffer_load_dwordx4 v5, s[16:19], s25 offen offset:0 sc1 lds
    ds_read_b64_tr_b16 v[50:51], v18 offset:43008
    v_mfma_f32_16x16x32_bf16 v[192:195], v[40:43], v[64:67], v[192:195]
    ds_read_b64_tr_b16 v[52:53], v18 offset:45056
    v_mfma_f32_16x16x32_bf16 v[224:227], v[44:47], v[64:67], v[224:227]
    ds_read_b64_tr_b16 v[54:55], v18 offset:47104
    v_mfma_f32_16x16x32_bf16 v[132:135], v[32:35], v[68:71], v[132:135]
    ds_read_b64_tr_b16 v[56:57], v19 offset:40960
    s_add_u32 m0, s26, 1024
    v_mfma_f32_16x16x32_bf16 v[164:167], v[36:39], v[68:71], v[164:167]
    buffer_load_dwordx4 v6, s[16:19], s25 offen offset:0 sc1 lds
    ds_read_b64_tr_b16 v[58:59], v19 offset:43008
    v_mfma_f32_16x16x32_bf16 v[196:199], v[40:43], v[68:71], v[196:199]
    ds_read_b64_tr_b16 v[60:61], v19 offset:45056
    v_mfma_f32_16x16x32_bf16 v[228:231], v[44:47], v[68:71], v[228:231]
    ds_read_b64_tr_b16 v[62:63], v19 offset:47104
    v_mfma_f32_16x16x32_bf16 v[136:139], v[32:35], v[72:75], v[136:139]
    ds_read_b64_tr_b16 v[96:97], v10 offset:16384
    s_add_u32 m0, s26, 7936
    v_mfma_f32_16x16x32_bf16 v[168:171], v[36:39], v[72:75], v[168:171]
    buffer_load_dwordx4 v5, s[16:19], s25 offen offset:256 sc1 lds
    ds_read_b64_tr_b16 v[98:99], v10 offset:20480
    v_mfma_f32_16x16x32_bf16 v[200:203], v[40:43], v[72:75], v[200:203]
    ds_read_b64_tr_b16 v[100:101], v11 offset:16384
    v_mfma_f32_16x16x32_bf16 v[232:235], v[44:47], v[72:75], v[232:235]
    ds_read_b64_tr_b16 v[102:103], v11 offset:20480
    v_mfma_f32_16x16x32_bf16 v[140:143], v[32:35], v[76:79], v[140:143]
    ds_read_b64_tr_b16 v[104:105], v12 offset:16384
    v_mfma_f32_16x16x32_bf16 v[172:175], v[36:39], v[76:79], v[172:175]
    ds_read_b64_tr_b16 v[106:107], v12 offset:20480
    s_add_u32 m0, s26, 8960
    v_mfma_f32_16x16x32_bf16 v[204:207], v[40:43], v[76:79], v[204:207]
    buffer_load_dwordx4 v6, s[16:19], s25 offen offset:256 sc1 lds
    v_mfma_f32_16x16x32_bf16 v[236:239], v[44:47], v[76:79], v[236:239]
    ds_read_b64_tr_b16 v[108:109], v13 offset:16384
    v_mfma_f32_16x16x32_bf16 v[144:147], v[32:35], v[80:83], v[144:147]
    ds_read_b64_tr_b16 v[110:111], v13 offset:20480
    v_mfma_f32_16x16x32_bf16 v[176:179], v[36:39], v[80:83], v[176:179]
    ds_read_b64_tr_b16 v[112:113], v14 offset:16384
    s_add_u32 m0, s88, 0
    s_mov_b32 s89, 1216512
    v_mfma_f32_16x16x32_bf16 v[208:211], v[40:43], v[80:83], v[208:211]
    buffer_load_dwordx4 v7, s[80:83], s89 offen lds
    v_mfma_f32_16x16x32_bf16 v[240:243], v[44:47], v[80:83], v[240:243]
    ds_read_b64_tr_b16 v[114:115], v14 offset:20480
    v_mfma_f32_16x16x32_bf16 v[148:151], v[32:35], v[84:87], v[148:151]
    ds_read_b64_tr_b16 v[116:117], v15 offset:16384
    v_mfma_f32_16x16x32_bf16 v[180:183], v[36:39], v[84:87], v[180:183]
    ds_read_b64_tr_b16 v[118:119], v15 offset:20480
    v_mfma_f32_16x16x32_bf16 v[212:215], v[40:43], v[84:87], v[212:215]
    ds_read_b64_tr_b16 v[120:121], v16 offset:16384
    s_add_u32 m0, s88, 4096
    v_mfma_f32_16x16x32_bf16 v[244:247], v[44:47], v[84:87], v[244:247]
    buffer_load_dwordx4 v7, s[84:87], s89 offen lds
    v_mfma_f32_16x16x32_bf16 v[152:155], v[32:35], v[88:91], v[152:155]
    ds_read_b64_tr_b16 v[122:123], v16 offset:20480
    v_mfma_f32_16x16x32_bf16 v[184:187], v[36:39], v[88:91], v[184:187]
    ds_read_b64_tr_b16 v[124:125], v17 offset:16384
    v_mfma_f32_16x16x32_bf16 v[216:219], v[40:43], v[88:91], v[216:219]
    ds_read_b64_tr_b16 v[126:127], v17 offset:20480
    v_mfma_f32_16x16x32_bf16 v[248:251], v[44:47], v[88:91], v[248:251]
    s_add_u32 s47, s46, 655360
    buffer_load_dwordx4 a[88:91], v9, s[40:43], s47 offen offset:2048 sc1
    v_mfma_f32_16x16x32_bf16 v[156:159], v[32:35], v[92:95], v[156:159]
    v_mfma_f32_16x16x32_bf16 v[188:191], v[36:39], v[92:95], v[188:191]
    v_mfma_f32_16x16x32_bf16 v[220:223], v[40:43], v[92:95], v[220:223]
    v_mfma_f32_16x16x32_bf16 v[252:255], v[44:47], v[92:95], v[252:255]
    s_waitcnt lgkmcnt(0)
    s_waitcnt vmcnt(11)
    s_barrier
    v_mfma_f32_16x16x32_bf16 v[128:131], v[48:51], v[96:99], v[128:131]
    ds_read_b64_tr_b16 v[32:33], v18 offset:49152
    s_add_u32 m0, s26, 16384
    s_mov_b32 s25, 1179648
    v_mfma_f32_16x16x32_bf16 v[160:163], v[52:55], v[96:99], v[160:163]
    buffer_load_dwordx4 v5, s[16:19], s25 offen offset:0 sc1 lds
    ds_read_b64_tr_b16 v[34:35], v18 offset:51200
    v_mfma_f32_16x16x32_bf16 v[192:195], v[56:59], v[96:99], v[192:195]
    ds_read_b64_tr_b16 v[36:37], v18 offset:53248
    v_mfma_f32_16x16x32_bf16 v[224:227], v[60:63], v[96:99], v[224:227]
    ds_read_b64_tr_b16 v[38:39], v18 offset:55296
    v_mfma_f32_16x16x32_bf16 v[132:135], v[48:51], v[100:103], v[132:135]
    ds_read_b64_tr_b16 v[40:41], v19 offset:49152
    s_add_u32 m0, s26, 17408
    v_mfma_f32_16x16x32_bf16 v[164:167], v[52:55], v[100:103], v[164:167]
    buffer_load_dwordx4 v6, s[16:19], s25 offen offset:0 sc1 lds
    ds_read_b64_tr_b16 v[42:43], v19 offset:51200
    v_mfma_f32_16x16x32_bf16 v[196:199], v[56:59], v[100:103], v[196:199]
    ds_read_b64_tr_b16 v[44:45], v19 offset:53248
    v_mfma_f32_16x16x32_bf16 v[228:231], v[60:63], v[100:103], v[228:231]
    ds_read_b64_tr_b16 v[46:47], v19 offset:55296
    v_mfma_f32_16x16x32_bf16 v[136:139], v[48:51], v[104:107], v[136:139]
    ds_read_b64_tr_b16 v[64:65], v10 offset:32768
    s_add_u32 m0, s26, 24320
    v_mfma_f32_16x16x32_bf16 v[168:171], v[52:55], v[104:107], v[168:171]
    buffer_load_dwordx4 v5, s[16:19], s25 offen offset:256 sc1 lds
    ds_read_b64_tr_b16 v[66:67], v10 offset:36864
    v_mfma_f32_16x16x32_bf16 v[200:203], v[56:59], v[104:107], v[200:203]
    ds_read_b64_tr_b16 v[68:69], v11 offset:32768
    v_mfma_f32_16x16x32_bf16 v[232:235], v[60:63], v[104:107], v[232:235]
    ds_read_b64_tr_b16 v[70:71], v11 offset:36864
    v_mfma_f32_16x16x32_bf16 v[140:143], v[48:51], v[108:111], v[140:143]
    ds_read_b64_tr_b16 v[72:73], v12 offset:32768
    v_mfma_f32_16x16x32_bf16 v[172:175], v[52:55], v[108:111], v[172:175]
    ds_read_b64_tr_b16 v[74:75], v12 offset:36864
    s_add_u32 m0, s26, 25344
    v_mfma_f32_16x16x32_bf16 v[204:207], v[56:59], v[108:111], v[204:207]
    buffer_load_dwordx4 v6, s[16:19], s25 offen offset:256 sc1 lds
    v_mfma_f32_16x16x32_bf16 v[236:239], v[60:63], v[108:111], v[236:239]
    ds_read_b64_tr_b16 v[76:77], v13 offset:32768
    v_mfma_f32_16x16x32_bf16 v[144:147], v[48:51], v[112:115], v[144:147]
    ds_read_b64_tr_b16 v[78:79], v13 offset:36864
    v_mfma_f32_16x16x32_bf16 v[176:179], v[52:55], v[112:115], v[176:179]
    ds_read_b64_tr_b16 v[80:81], v14 offset:32768
    s_add_u32 m0, s88, 8192
    s_mov_b32 s89, 1327104
    v_mfma_f32_16x16x32_bf16 v[208:211], v[56:59], v[112:115], v[208:211]
    buffer_load_dwordx4 v7, s[80:83], s89 offen lds
    v_mfma_f32_16x16x32_bf16 v[240:243], v[60:63], v[112:115], v[240:243]
    ds_read_b64_tr_b16 v[82:83], v14 offset:36864
    v_mfma_f32_16x16x32_bf16 v[148:151], v[48:51], v[116:119], v[148:151]
    ds_read_b64_tr_b16 v[84:85], v15 offset:32768
    v_mfma_f32_16x16x32_bf16 v[180:183], v[52:55], v[116:119], v[180:183]
    ds_read_b64_tr_b16 v[86:87], v15 offset:36864
    v_mfma_f32_16x16x32_bf16 v[212:215], v[56:59], v[116:119], v[212:215]
    ds_read_b64_tr_b16 v[88:89], v16 offset:32768
    s_add_u32 m0, s88, 12288
    v_mfma_f32_16x16x32_bf16 v[244:247], v[60:63], v[116:119], v[244:247]
    buffer_load_dwordx4 v7, s[84:87], s89 offen lds
    v_mfma_f32_16x16x32_bf16 v[152:155], v[48:51], v[120:123], v[152:155]
    ds_read_b64_tr_b16 v[90:91], v16 offset:36864
    v_mfma_f32_16x16x32_bf16 v[184:187], v[52:55], v[120:123], v[184:187]
    ds_read_b64_tr_b16 v[92:93], v17 offset:32768
    v_mfma_f32_16x16x32_bf16 v[216:219], v[56:59], v[120:123], v[216:219]
    ds_read_b64_tr_b16 v[94:95], v17 offset:36864
    v_mfma_f32_16x16x32_bf16 v[248:251], v[60:63], v[120:123], v[248:251]
    s_add_u32 s47, s46, 655360
    buffer_load_dwordx4 a[92:95], v9, s[40:43], s47 offen offset:3072 sc1
    v_mfma_f32_16x16x32_bf16 v[156:159], v[48:51], v[124:127], v[156:159]
    v_mfma_f32_16x16x32_bf16 v[188:191], v[52:55], v[124:127], v[188:191]
    v_mfma_f32_16x16x32_bf16 v[220:223], v[56:59], v[124:127], v[220:223]
    v_mfma_f32_16x16x32_bf16 v[252:255], v[60:63], v[124:127], v[252:255]
    s_waitcnt lgkmcnt(0)
    s_waitcnt vmcnt(14)
    s_barrier
    v_mfma_f32_16x16x32_bf16 v[128:131], v[32:35], v[64:67], v[128:131]
    ds_read_b64_tr_b16 v[48:49], v18 offset:57344
    s_add_u32 m0, s26, 32768
    s_mov_b32 s25, 1310720
    v_mfma_f32_16x16x32_bf16 v[160:163], v[36:39], v[64:67], v[160:163]
    buffer_load_dwordx4 v5, s[16:19], s25 offen offset:0 sc1 lds
    ds_read_b64_tr_b16 v[50:51], v18 offset:59392
    v_mfma_f32_16x16x32_bf16 v[192:195], v[40:43], v[64:67], v[192:195]
    ds_read_b64_tr_b16 v[52:53], v18 offset:61440
    v_mfma_f32_16x16x32_bf16 v[224:227], v[44:47], v[64:67], v[224:227]
    ds_read_b64_tr_b16 v[54:55], v18 offset:63488
    v_mfma_f32_16x16x32_bf16 v[132:135], v[32:35], v[68:71], v[132:135]
    ds_read_b64_tr_b16 v[56:57], v19 offset:57344
    s_add_u32 m0, s26, 33792
    v_mfma_f32_16x16x32_bf16 v[164:167], v[36:39], v[68:71], v[164:167]
    buffer_load_dwordx4 v6, s[16:19], s25 offen offset:0 sc1 lds
    ds_read_b64_tr_b16 v[58:59], v19 offset:59392
    v_mfma_f32_16x16x32_bf16 v[196:199], v[40:43], v[68:71], v[196:199]
    ds_read_b64_tr_b16 v[60:61], v19 offset:61440
    v_mfma_f32_16x16x32_bf16 v[228:231], v[44:47], v[68:71], v[228:231]
    ds_read_b64_tr_b16 v[62:63], v19 offset:63488
    v_mfma_f32_16x16x32_bf16 v[136:139], v[32:35], v[72:75], v[136:139]
    ds_read_b64_tr_b16 v[96:97], v10 offset:49152
    s_add_u32 m0, s26, 40704
    v_mfma_f32_16x16x32_bf16 v[168:171], v[36:39], v[72:75], v[168:171]
    buffer_load_dwordx4 v5, s[16:19], s25 offen offset:256 sc1 lds
    ds_read_b64_tr_b16 v[98:99], v10 offset:53248
    v_mfma_f32_16x16x32_bf16 v[200:203], v[40:43], v[72:75], v[200:203]
    ds_read_b64_tr_b16 v[100:101], v11 offset:49152
    v_mfma_f32_16x16x32_bf16 v[232:235], v[44:47], v[72:75], v[232:235]
    ds_read_b64_tr_b16 v[102:103], v11 offset:53248
    v_mfma_f32_16x16x32_bf16 v[140:143], v[32:35], v[76:79], v[140:143]
    ds_read_b64_tr_b16 v[104:105], v12 offset:49152
    v_mfma_f32_16x16x32_bf16 v[172:175], v[36:39], v[76:79], v[172:175]
    ds_read_b64_tr_b16 v[106:107], v12 offset:53248
    s_add_u32 m0, s26, 41728
    v_mfma_f32_16x16x32_bf16 v[204:207], v[40:43], v[76:79], v[204:207]
    buffer_load_dwordx4 v6, s[16:19], s25 offen offset:256 sc1 lds
    v_mfma_f32_16x16x32_bf16 v[236:239], v[44:47], v[76:79], v[236:239]
    ds_read_b64_tr_b16 v[108:109], v13 offset:49152
    v_mfma_f32_16x16x32_bf16 v[144:147], v[32:35], v[80:83], v[144:147]
    ds_read_b64_tr_b16 v[110:111], v13 offset:53248
    v_mfma_f32_16x16x32_bf16 v[176:179], v[36:39], v[80:83], v[176:179]
    ds_read_b64_tr_b16 v[112:113], v14 offset:49152
    s_add_u32 m0, s88, 16384
    s_mov_b32 s89, 1437696
    v_mfma_f32_16x16x32_bf16 v[208:211], v[40:43], v[80:83], v[208:211]
    buffer_load_dwordx4 v7, s[80:83], s89 offen lds
    v_mfma_f32_16x16x32_bf16 v[240:243], v[44:47], v[80:83], v[240:243]
    ds_read_b64_tr_b16 v[114:115], v14 offset:53248
    v_mfma_f32_16x16x32_bf16 v[148:151], v[32:35], v[84:87], v[148:151]
    ds_read_b64_tr_b16 v[116:117], v15 offset:49152
    v_mfma_f32_16x16x32_bf16 v[180:183], v[36:39], v[84:87], v[180:183]
    ds_read_b64_tr_b16 v[118:119], v15 offset:53248
    v_mfma_f32_16x16x32_bf16 v[212:215], v[40:43], v[84:87], v[212:215]
    ds_read_b64_tr_b16 v[120:121], v16 offset:49152
    s_add_u32 m0, s88, 20480
    v_mfma_f32_16x16x32_bf16 v[244:247], v[44:47], v[84:87], v[244:247]
    buffer_load_dwordx4 v7, s[84:87], s89 offen lds
    v_mfma_f32_16x16x32_bf16 v[152:155], v[32:35], v[88:91], v[152:155]
    ds_read_b64_tr_b16 v[122:123], v16 offset:53248
    v_mfma_f32_16x16x32_bf16 v[184:187], v[36:39], v[88:91], v[184:187]
    ds_read_b64_tr_b16 v[124:125], v17 offset:49152
    v_mfma_f32_16x16x32_bf16 v[216:219], v[40:43], v[88:91], v[216:219]
    ds_read_b64_tr_b16 v[126:127], v17 offset:53248
    v_mfma_f32_16x16x32_bf16 v[248:251], v[44:47], v[88:91], v[248:251]
    s_add_u32 s47, s46, 655360
    buffer_load_dwordx4 a[96:99], v8, s[40:43], s47 offen offset:0 sc1
    v_mfma_f32_16x16x32_bf16 v[156:159], v[32:35], v[92:95], v[156:159]
    v_mfma_f32_16x16x32_bf16 v[188:191], v[36:39], v[92:95], v[188:191]
    v_mfma_f32_16x16x32_bf16 v[220:223], v[40:43], v[92:95], v[220:223]
    v_mfma_f32_16x16x32_bf16 v[252:255], v[44:47], v[92:95], v[252:255]
    s_waitcnt lgkmcnt(0)
    s_waitcnt vmcnt(17)
    s_barrier
    v_mfma_f32_16x16x32_bf16 v[128:131], v[48:51], v[96:99], v[128:131]
    ds_read_b64_tr_b16 v[32:33], v28 offset:0
    s_add_u32 m0, s26, 49152
    s_mov_b32 s25, 1441792
    v_mfma_f32_16x16x32_bf16 v[160:163], v[52:55], v[96:99], v[160:163]
    buffer_load_dwordx4 v5, s[16:19], s25 offen offset:0 sc1 lds
    ds_read_b64_tr_b16 v[34:35], v28 offset:2048
    v_mfma_f32_16x16x32_bf16 v[192:195], v[56:59], v[96:99], v[192:195]
    ds_read_b64_tr_b16 v[36:37], v28 offset:4096
    v_mfma_f32_16x16x32_bf16 v[224:227], v[60:63], v[96:99], v[224:227]
    ds_read_b64_tr_b16 v[38:39], v28 offset:6144
    v_mfma_f32_16x16x32_bf16 v[132:135], v[48:51], v[100:103], v[132:135]
    ds_read_b64_tr_b16 v[40:41], v29 offset:0
    s_add_u32 m0, s26, 50176
    v_mfma_f32_16x16x32_bf16 v[164:167], v[52:55], v[100:103], v[164:167]
    buffer_load_dwordx4 v6, s[16:19], s25 offen offset:0 sc1 lds
    ds_read_b64_tr_b16 v[42:43], v29 offset:2048
    v_mfma_f32_16x16x32_bf16 v[196:199], v[56:59], v[100:103], v[196:199]
    ds_read_b64_tr_b16 v[44:45], v29 offset:4096
    v_mfma_f32_16x16x32_bf16 v[228:231], v[60:63], v[100:103], v[228:231]
    ds_read_b64_tr_b16 v[46:47], v29 offset:6144
    v_mfma_f32_16x16x32_bf16 v[136:139], v[48:51], v[104:107], v[136:139]
    ds_read_b64_tr_b16 v[64:65], v10 offset:0
    s_add_u32 m0, s26, 57088
    v_mfma_f32_16x16x32_bf16 v[168:171], v[52:55], v[104:107], v[168:171]
    buffer_load_dwordx4 v5, s[16:19], s25 offen offset:256 sc1 lds
    ds_read_b64_tr_b16 v[66:67], v10 offset:4096
    v_mfma_f32_16x16x32_bf16 v[200:203], v[56:59], v[104:107], v[200:203]
    ds_read_b64_tr_b16 v[68:69], v11 offset:0
    v_mfma_f32_16x16x32_bf16 v[232:235], v[60:63], v[104:107], v[232:235]
    ds_read_b64_tr_b16 v[70:71], v11 offset:4096
    v_mfma_f32_16x16x32_bf16 v[140:143], v[48:51], v[108:111], v[140:143]
    ds_read_b64_tr_b16 v[72:73], v12 offset:0
    v_mfma_f32_16x16x32_bf16 v[172:175], v[52:55], v[108:111], v[172:175]
    ds_read_b64_tr_b16 v[74:75], v12 offset:4096
    s_add_u32 m0, s26, 58112
    v_mfma_f32_16x16x32_bf16 v[204:207], v[56:59], v[108:111], v[204:207]
    buffer_load_dwordx4 v6, s[16:19], s25 offen offset:256 sc1 lds
    v_mfma_f32_16x16x32_bf16 v[236:239], v[60:63], v[108:111], v[236:239]
    ds_read_b64_tr_b16 v[76:77], v13 offset:0
    v_mfma_f32_16x16x32_bf16 v[144:147], v[48:51], v[112:115], v[144:147]
    ds_read_b64_tr_b16 v[78:79], v13 offset:4096
    v_mfma_f32_16x16x32_bf16 v[176:179], v[52:55], v[112:115], v[176:179]
    ds_read_b64_tr_b16 v[80:81], v14 offset:0
    s_add_u32 m0, s88, 24576
    s_mov_b32 s89, 1548288
    v_mfma_f32_16x16x32_bf16 v[208:211], v[56:59], v[112:115], v[208:211]
    buffer_load_dwordx4 v7, s[80:83], s89 offen lds
    v_mfma_f32_16x16x32_bf16 v[240:243], v[60:63], v[112:115], v[240:243]
    ds_read_b64_tr_b16 v[82:83], v14 offset:4096
    v_mfma_f32_16x16x32_bf16 v[148:151], v[48:51], v[116:119], v[148:151]
    ds_read_b64_tr_b16 v[84:85], v15 offset:0
    v_mfma_f32_16x16x32_bf16 v[180:183], v[52:55], v[116:119], v[180:183]
    ds_read_b64_tr_b16 v[86:87], v15 offset:4096
    v_mfma_f32_16x16x32_bf16 v[212:215], v[56:59], v[116:119], v[212:215]
    ds_read_b64_tr_b16 v[88:89], v16 offset:0
    s_add_u32 m0, s88, 28672
    v_mfma_f32_16x16x32_bf16 v[244:247], v[60:63], v[116:119], v[244:247]
    buffer_load_dwordx4 v7, s[84:87], s89 offen lds
    v_mfma_f32_16x16x32_bf16 v[152:155], v[48:51], v[120:123], v[152:155]
    ds_read_b64_tr_b16 v[90:91], v16 offset:4096
    v_mfma_f32_16x16x32_bf16 v[184:187], v[52:55], v[120:123], v[184:187]
    ds_read_b64_tr_b16 v[92:93], v17 offset:0
    v_mfma_f32_16x16x32_bf16 v[216:219], v[56:59], v[120:123], v[216:219]
    ds_read_b64_tr_b16 v[94:95], v17 offset:4096
    v_mfma_f32_16x16x32_bf16 v[248:251], v[60:63], v[120:123], v[248:251]
    s_add_u32 s47, s46, 819200
    buffer_load_dwordx4 a[100:103], v9, s[40:43], s47 offen offset:0 sc1
    v_mfma_f32_16x16x32_bf16 v[156:159], v[48:51], v[124:127], v[156:159]
    v_mfma_f32_16x16x32_bf16 v[188:191], v[52:55], v[124:127], v[188:191]
    v_mfma_f32_16x16x32_bf16 v[220:223], v[56:59], v[124:127], v[220:223]
    v_mfma_f32_16x16x32_bf16 v[252:255], v[60:63], v[124:127], v[252:255]
    s_waitcnt lgkmcnt(0)
    s_waitcnt vmcnt(17)
    s_barrier
    v_mfma_f32_16x16x32_bf16 v[128:131], v[32:35], v[64:67], v[128:131]
    ds_read_b64_tr_b16 v[48:49], v28 offset:8192
    s_add_u32 m0, s26, 0
    s_mov_b32 s25, 1572864
    v_mfma_f32_16x16x32_bf16 v[160:163], v[36:39], v[64:67], v[160:163]
    buffer_load_dwordx4 v5, s[16:19], s25 offen offset:0 sc1 lds
    ds_read_b64_tr_b16 v[50:51], v28 offset:10240
    v_mfma_f32_16x16x32_bf16 v[192:195], v[40:43], v[64:67], v[192:195]
    ds_read_b64_tr_b16 v[52:53], v28 offset:12288
    v_mfma_f32_16x16x32_bf16 v[224:227], v[44:47], v[64:67], v[224:227]
    ds_read_b64_tr_b16 v[54:55], v28 offset:14336
    v_mfma_f32_16x16x32_bf16 v[132:135], v[32:35], v[68:71], v[132:135]
    ds_read_b64_tr_b16 v[56:57], v29 offset:8192
    s_add_u32 m0, s26, 1024
    v_mfma_f32_16x16x32_bf16 v[164:167], v[36:39], v[68:71], v[164:167]
    buffer_load_dwordx4 v6, s[16:19], s25 offen offset:0 sc1 lds
    ds_read_b64_tr_b16 v[58:59], v29 offset:10240
    v_mfma_f32_16x16x32_bf16 v[196:199], v[40:43], v[68:71], v[196:199]
    ds_read_b64_tr_b16 v[60:61], v29 offset:12288
    v_mfma_f32_16x16x32_bf16 v[228:231], v[44:47], v[68:71], v[228:231]
    ds_read_b64_tr_b16 v[62:63], v29 offset:14336
    v_mfma_f32_16x16x32_bf16 v[136:139], v[32:35], v[72:75], v[136:139]
    ds_read_b64_tr_b16 v[96:97], v10 offset:16384
    s_add_u32 m0, s26, 7936
    v_mfma_f32_16x16x32_bf16 v[168:171], v[36:39], v[72:75], v[168:171]
    buffer_load_dwordx4 v5, s[16:19], s25 offen offset:256 sc1 lds
    ds_read_b64_tr_b16 v[98:99], v10 offset:20480
    v_mfma_f32_16x16x32_bf16 v[200:203], v[40:43], v[72:75], v[200:203]
    ds_read_b64_tr_b16 v[100:101], v11 offset:16384
    v_mfma_f32_16x16x32_bf16 v[232:235], v[44:47], v[72:75], v[232:235]
    ds_read_b64_tr_b16 v[102:103], v11 offset:20480
    v_mfma_f32_16x16x32_bf16 v[140:143], v[32:35], v[76:79], v[140:143]
    ds_read_b64_tr_b16 v[104:105], v12 offset:16384
    v_mfma_f32_16x16x32_bf16 v[172:175], v[36:39], v[76:79], v[172:175]
    ds_read_b64_tr_b16 v[106:107], v12 offset:20480
    s_add_u32 m0, s26, 8960
    v_mfma_f32_16x16x32_bf16 v[204:207], v[40:43], v[76:79], v[204:207]
    buffer_load_dwordx4 v6, s[16:19], s25 offen offset:256 sc1 lds
    v_mfma_f32_16x16x32_bf16 v[236:239], v[44:47], v[76:79], v[236:239]
    ds_read_b64_tr_b16 v[108:109], v13 offset:16384
    v_mfma_f32_16x16x32_bf16 v[144:147], v[32:35], v[80:83], v[144:147]
    ds_read_b64_tr_b16 v[110:111], v13 offset:20480
    v_mfma_f32_16x16x32_bf16 v[176:179], v[36:39], v[80:83], v[176:179]
    ds_read_b64_tr_b16 v[112:113], v14 offset:16384
    s_add_u32 m0, s88, 32768
    s_mov_b32 s89, 1658880
    v_mfma_f32_16x16x32_bf16 v[208:211], v[40:43], v[80:83], v[208:211]
    buffer_load_dwordx4 v7, s[80:83], s89 offen lds
    v_mfma_f32_16x16x32_bf16 v[240:243], v[44:47], v[80:83], v[240:243]
    ds_read_b64_tr_b16 v[114:115], v14 offset:20480
    v_mfma_f32_16x16x32_bf16 v[148:151], v[32:35], v[84:87], v[148:151]
    ds_read_b64_tr_b16 v[116:117], v15 offset:16384
    v_mfma_f32_16x16x32_bf16 v[180:183], v[36:39], v[84:87], v[180:183]
    ds_read_b64_tr_b16 v[118:119], v15 offset:20480
    v_mfma_f32_16x16x32_bf16 v[212:215], v[40:43], v[84:87], v[212:215]
    ds_read_b64_tr_b16 v[120:121], v16 offset:16384
    s_add_u32 m0, s88, 36864
    v_mfma_f32_16x16x32_bf16 v[244:247], v[44:47], v[84:87], v[244:247]
    buffer_load_dwordx4 v7, s[84:87], s89 offen lds
    v_mfma_f32_16x16x32_bf16 v[152:155], v[32:35], v[88:91], v[152:155]
    ds_read_b64_tr_b16 v[122:123], v16 offset:20480
    v_mfma_f32_16x16x32_bf16 v[184:187], v[36:39], v[88:91], v[184:187]
    ds_read_b64_tr_b16 v[124:125], v17 offset:16384
    v_mfma_f32_16x16x32_bf16 v[216:219], v[40:43], v[88:91], v[216:219]
    ds_read_b64_tr_b16 v[126:127], v17 offset:20480
    v_mfma_f32_16x16x32_bf16 v[248:251], v[44:47], v[88:91], v[248:251]
    s_add_u32 s47, s46, 819200
    buffer_load_dwordx4 a[104:107], v9, s[40:43], s47 offen offset:1024 sc1
    v_mfma_f32_16x16x32_bf16 v[156:159], v[32:35], v[92:95], v[156:159]
    v_mfma_f32_16x16x32_bf16 v[188:191], v[36:39], v[92:95], v[188:191]
    v_mfma_f32_16x16x32_bf16 v[220:223], v[40:43], v[92:95], v[220:223]
    v_mfma_f32_16x16x32_bf16 v[252:255], v[44:47], v[92:95], v[252:255]
    s_waitcnt lgkmcnt(0)
    s_waitcnt vmcnt(17)
    s_barrier
    v_mfma_f32_16x16x32_bf16 v[128:131], v[48:51], v[96:99], v[128:131]
    ds_read_b64_tr_b16 v[32:33], v28 offset:16384
    s_add_u32 m0, s26, 16384
    s_mov_b32 s25, 1703936
    v_mfma_f32_16x16x32_bf16 v[160:163], v[52:55], v[96:99], v[160:163]
    buffer_load_dwordx4 v5, s[16:19], s25 offen offset:0 sc1 lds
    ds_read_b64_tr_b16 v[34:35], v28 offset:18432
    v_mfma_f32_16x16x32_bf16 v[192:195], v[56:59], v[96:99], v[192:195]
    ds_read_b64_tr_b16 v[36:37], v28 offset:20480
    v_mfma_f32_16x16x32_bf16 v[224:227], v[60:63], v[96:99], v[224:227]
    ds_read_b64_tr_b16 v[38:39], v28 offset:22528
    v_mfma_f32_16x16x32_bf16 v[132:135], v[48:51], v[100:103], v[132:135]
    ds_read_b64_tr_b16 v[40:41], v29 offset:16384
    s_add_u32 m0, s26, 17408
    v_mfma_f32_16x16x32_bf16 v[164:167], v[52:55], v[100:103], v[164:167]
    buffer_load_dwordx4 v6, s[16:19], s25 offen offset:0 sc1 lds
    ds_read_b64_tr_b16 v[42:43], v29 offset:18432
    v_mfma_f32_16x16x32_bf16 v[196:199], v[56:59], v[100:103], v[196:199]
    ds_read_b64_tr_b16 v[44:45], v29 offset:20480
    v_mfma_f32_16x16x32_bf16 v[228:231], v[60:63], v[100:103], v[228:231]
    ds_read_b64_tr_b16 v[46:47], v29 offset:22528
    v_mfma_f32_16x16x32_bf16 v[136:139], v[48:51], v[104:107], v[136:139]
    ds_read_b64_tr_b16 v[64:65], v10 offset:32768
    s_add_u32 m0, s26, 24320
    v_mfma_f32_16x16x32_bf16 v[168:171], v[52:55], v[104:107], v[168:171]
    buffer_load_dwordx4 v5, s[16:19], s25 offen offset:256 sc1 lds
    ds_read_b64_tr_b16 v[66:67], v10 offset:36864
    v_mfma_f32_16x16x32_bf16 v[200:203], v[56:59], v[104:107], v[200:203]
    ds_read_b64_tr_b16 v[68:69], v11 offset:32768
    v_mfma_f32_16x16x32_bf16 v[232:235], v[60:63], v[104:107], v[232:235]
    ds_read_b64_tr_b16 v[70:71], v11 offset:36864
    v_mfma_f32_16x16x32_bf16 v[140:143], v[48:51], v[108:111], v[140:143]
    ds_read_b64_tr_b16 v[72:73], v12 offset:32768
    v_mfma_f32_16x16x32_bf16 v[172:175], v[52:55], v[108:111], v[172:175]
    ds_read_b64_tr_b16 v[74:75], v12 offset:36864
    s_add_u32 m0, s26, 25344
    v_mfma_f32_16x16x32_bf16 v[204:207], v[56:59], v[108:111], v[204:207]
    buffer_load_dwordx4 v6, s[16:19], s25 offen offset:256 sc1 lds
    v_mfma_f32_16x16x32_bf16 v[236:239], v[60:63], v[108:111], v[236:239]
    ds_read_b64_tr_b16 v[76:77], v13 offset:32768
    v_mfma_f32_16x16x32_bf16 v[144:147], v[48:51], v[112:115], v[144:147]
    ds_read_b64_tr_b16 v[78:79], v13 offset:36864
    v_mfma_f32_16x16x32_bf16 v[176:179], v[52:55], v[112:115], v[176:179]
    ds_read_b64_tr_b16 v[80:81], v14 offset:32768
    s_add_u32 m0, s88, 40960
    s_mov_b32 s89, 1769472
    v_mfma_f32_16x16x32_bf16 v[208:211], v[56:59], v[112:115], v[208:211]
    buffer_load_dwordx4 v7, s[80:83], s89 offen lds
    v_mfma_f32_16x16x32_bf16 v[240:243], v[60:63], v[112:115], v[240:243]
    ds_read_b64_tr_b16 v[82:83], v14 offset:36864
    v_mfma_f32_16x16x32_bf16 v[148:151], v[48:51], v[116:119], v[148:151]
    ds_read_b64_tr_b16 v[84:85], v15 offset:32768
    v_mfma_f32_16x16x32_bf16 v[180:183], v[52:55], v[116:119], v[180:183]
    ds_read_b64_tr_b16 v[86:87], v15 offset:36864
    v_mfma_f32_16x16x32_bf16 v[212:215], v[56:59], v[116:119], v[212:215]
    ds_read_b64_tr_b16 v[88:89], v16 offset:32768
    s_add_u32 m0, s88, 45056
    v_mfma_f32_16x16x32_bf16 v[244:247], v[60:63], v[116:119], v[244:247]
    buffer_load_dwordx4 v7, s[84:87], s89 offen lds
    v_mfma_f32_16x16x32_bf16 v[152:155], v[48:51], v[120:123], v[152:155]
    ds_read_b64_tr_b16 v[90:91], v16 offset:36864
    v_mfma_f32_16x16x32_bf16 v[184:187], v[52:55], v[120:123], v[184:187]
    ds_read_b64_tr_b16 v[92:93], v17 offset:32768
    v_mfma_f32_16x16x32_bf16 v[216:219], v[56:59], v[120:123], v[216:219]
    ds_read_b64_tr_b16 v[94:95], v17 offset:36864
    v_mfma_f32_16x16x32_bf16 v[248:251], v[60:63], v[120:123], v[248:251]
    s_add_u32 s47, s46, 819200
    buffer_load_dwordx4 a[108:111], v9, s[40:43], s47 offen offset:2048 sc1
    v_mfma_f32_16x16x32_bf16 v[156:159], v[48:51], v[124:127], v[156:159]
    v_mfma_f32_16x16x32_bf16 v[188:191], v[52:55], v[124:127], v[188:191]
    v_mfma_f32_16x16x32_bf16 v[220:223], v[56:59], v[124:127], v[220:223]
    v_mfma_f32_16x16x32_bf16 v[252:255], v[60:63], v[124:127], v[252:255]
    s_waitcnt lgkmcnt(0)
    s_waitcnt vmcnt(17)
    s_barrier
    v_mfma_f32_16x16x32_bf16 v[128:131], v[32:35], v[64:67], v[128:131]
    ds_read_b64_tr_b16 v[48:49], v18 offset:0
    s_add_u32 m0, s26, 32768
    s_mov_b32 s25, 1835008
    v_mfma_f32_16x16x32_bf16 v[160:163], v[36:39], v[64:67], v[160:163]
    buffer_load_dwordx4 v5, s[16:19], s25 offen offset:0 sc1 lds
    ds_read_b64_tr_b16 v[50:51], v18 offset:2048
    v_mfma_f32_16x16x32_bf16 v[192:195], v[40:43], v[64:67], v[192:195]
    ds_read_b64_tr_b16 v[52:53], v18 offset:4096
    v_mfma_f32_16x16x32_bf16 v[224:227], v[44:47], v[64:67], v[224:227]
    ds_read_b64_tr_b16 v[54:55], v18 offset:6144
    v_mfma_f32_16x16x32_bf16 v[132:135], v[32:35], v[68:71], v[132:135]
    ds_read_b64_tr_b16 v[56:57], v19 offset:0
    s_add_u32 m0, s26, 33792
    v_mfma_f32_16x16x32_bf16 v[164:167], v[36:39], v[68:71], v[164:167]
    buffer_load_dwordx4 v6, s[16:19], s25 offen offset:0 sc1 lds
    ds_read_b64_tr_b16 v[58:59], v19 offset:2048
    v_mfma_f32_16x16x32_bf16 v[196:199], v[40:43], v[68:71], v[196:199]
    ds_read_b64_tr_b16 v[60:61], v19 offset:4096
    v_mfma_f32_16x16x32_bf16 v[228:231], v[44:47], v[68:71], v[228:231]
    ds_read_b64_tr_b16 v[62:63], v19 offset:6144
    v_mfma_f32_16x16x32_bf16 v[136:139], v[32:35], v[72:75], v[136:139]
    ds_read_b64_tr_b16 v[96:97], v10 offset:49152
    s_add_u32 m0, s26, 40704
    v_mfma_f32_16x16x32_bf16 v[168:171], v[36:39], v[72:75], v[168:171]
    buffer_load_dwordx4 v5, s[16:19], s25 offen offset:256 sc1 lds
    ds_read_b64_tr_b16 v[98:99], v10 offset:53248
    v_mfma_f32_16x16x32_bf16 v[200:203], v[40:43], v[72:75], v[200:203]
    ds_read_b64_tr_b16 v[100:101], v11 offset:49152
    v_mfma_f32_16x16x32_bf16 v[232:235], v[44:47], v[72:75], v[232:235]
    ds_read_b64_tr_b16 v[102:103], v11 offset:53248
    v_mfma_f32_16x16x32_bf16 v[140:143], v[32:35], v[76:79], v[140:143]
    ds_read_b64_tr_b16 v[104:105], v12 offset:49152
    v_mfma_f32_16x16x32_bf16 v[172:175], v[36:39], v[76:79], v[172:175]
    ds_read_b64_tr_b16 v[106:107], v12 offset:53248
    s_add_u32 m0, s26, 41728
    v_mfma_f32_16x16x32_bf16 v[204:207], v[40:43], v[76:79], v[204:207]
    buffer_load_dwordx4 v6, s[16:19], s25 offen offset:256 sc1 lds
    v_mfma_f32_16x16x32_bf16 v[236:239], v[44:47], v[76:79], v[236:239]
    ds_read_b64_tr_b16 v[108:109], v13 offset:49152
    v_mfma_f32_16x16x32_bf16 v[144:147], v[32:35], v[80:83], v[144:147]
    ds_read_b64_tr_b16 v[110:111], v13 offset:53248
    v_mfma_f32_16x16x32_bf16 v[176:179], v[36:39], v[80:83], v[176:179]
    ds_read_b64_tr_b16 v[112:113], v14 offset:49152
    s_add_u32 m0, s88, 49152
    s_mov_b32 s89, 1880064
    v_mfma_f32_16x16x32_bf16 v[208:211], v[40:43], v[80:83], v[208:211]
    buffer_load_dwordx4 v7, s[80:83], s89 offen lds
    v_mfma_f32_16x16x32_bf16 v[240:243], v[44:47], v[80:83], v[240:243]
    ds_read_b64_tr_b16 v[114:115], v14 offset:53248
    v_mfma_f32_16x16x32_bf16 v[148:151], v[32:35], v[84:87], v[148:151]
    ds_read_b64_tr_b16 v[116:117], v15 offset:49152
    v_mfma_f32_16x16x32_bf16 v[180:183], v[36:39], v[84:87], v[180:183]
    ds_read_b64_tr_b16 v[118:119], v15 offset:53248
    v_mfma_f32_16x16x32_bf16 v[212:215], v[40:43], v[84:87], v[212:215]
    ds_read_b64_tr_b16 v[120:121], v16 offset:49152
    s_add_u32 m0, s88, 53248
    v_mfma_f32_16x16x32_bf16 v[244:247], v[44:47], v[84:87], v[244:247]
    buffer_load_dwordx4 v7, s[84:87], s89 offen lds
    v_mfma_f32_16x16x32_bf16 v[152:155], v[32:35], v[88:91], v[152:155]
    ds_read_b64_tr_b16 v[122:123], v16 offset:53248
    v_mfma_f32_16x16x32_bf16 v[184:187], v[36:39], v[88:91], v[184:187]
    ds_read_b64_tr_b16 v[124:125], v17 offset:49152
    v_mfma_f32_16x16x32_bf16 v[216:219], v[40:43], v[88:91], v[216:219]
    ds_read_b64_tr_b16 v[126:127], v17 offset:53248
    v_mfma_f32_16x16x32_bf16 v[248:251], v[44:47], v[88:91], v[248:251]
    s_add_u32 s47, s46, 819200
    buffer_load_dwordx4 a[112:115], v9, s[40:43], s47 offen offset:3072 sc1
    v_mfma_f32_16x16x32_bf16 v[156:159], v[32:35], v[92:95], v[156:159]
    v_mfma_f32_16x16x32_bf16 v[188:191], v[36:39], v[92:95], v[188:191]
    v_mfma_f32_16x16x32_bf16 v[220:223], v[40:43], v[92:95], v[220:223]
    v_mfma_f32_16x16x32_bf16 v[252:255], v[44:47], v[92:95], v[252:255]
    s_waitcnt lgkmcnt(0)
    s_waitcnt vmcnt(17)
    s_barrier
    v_mfma_f32_16x16x32_bf16 v[128:131], v[48:51], v[96:99], v[128:131]
    ds_read_b64_tr_b16 v[32:33], v18 offset:8192
    s_add_u32 m0, s26, 49152
    s_mov_b32 s25, 1966080
    v_mfma_f32_16x16x32_bf16 v[160:163], v[52:55], v[96:99], v[160:163]
    buffer_load_dwordx4 v5, s[16:19], s25 offen offset:0 sc1 lds
    ds_read_b64_tr_b16 v[34:35], v18 offset:10240
    v_mfma_f32_16x16x32_bf16 v[192:195], v[56:59], v[96:99], v[192:195]
    ds_read_b64_tr_b16 v[36:37], v18 offset:12288
    v_mfma_f32_16x16x32_bf16 v[224:227], v[60:63], v[96:99], v[224:227]
    ds_read_b64_tr_b16 v[38:39], v18 offset:14336
    v_mfma_f32_16x16x32_bf16 v[132:135], v[48:51], v[100:103], v[132:135]
    ds_read_b64_tr_b16 v[40:41], v19 offset:8192
    s_add_u32 m0, s26, 50176
    v_mfma_f32_16x16x32_bf16 v[164:167], v[52:55], v[100:103], v[164:167]
    buffer_load_dwordx4 v6, s[16:19], s25 offen offset:0 sc1 lds
    ds_read_b64_tr_b16 v[42:43], v19 offset:10240
    v_mfma_f32_16x16x32_bf16 v[196:199], v[56:59], v[100:103], v[196:199]
    ds_read_b64_tr_b16 v[44:45], v19 offset:12288
    v_mfma_f32_16x16x32_bf16 v[228:231], v[60:63], v[100:103], v[228:231]
    ds_read_b64_tr_b16 v[46:47], v19 offset:14336
    v_mfma_f32_16x16x32_bf16 v[136:139], v[48:51], v[104:107], v[136:139]
    ds_read_b64_tr_b16 v[64:65], v10 offset:0
    s_add_u32 m0, s26, 57088
    v_mfma_f32_16x16x32_bf16 v[168:171], v[52:55], v[104:107], v[168:171]
    buffer_load_dwordx4 v5, s[16:19], s25 offen offset:256 sc1 lds
    ds_read_b64_tr_b16 v[66:67], v10 offset:4096
    v_mfma_f32_16x16x32_bf16 v[200:203], v[56:59], v[104:107], v[200:203]
    ds_read_b64_tr_b16 v[68:69], v11 offset:0
    v_mfma_f32_16x16x32_bf16 v[232:235], v[60:63], v[104:107], v[232:235]
    ds_read_b64_tr_b16 v[70:71], v11 offset:4096
    v_mfma_f32_16x16x32_bf16 v[140:143], v[48:51], v[108:111], v[140:143]
    ds_read_b64_tr_b16 v[72:73], v12 offset:0
    v_mfma_f32_16x16x32_bf16 v[172:175], v[52:55], v[108:111], v[172:175]
    ds_read_b64_tr_b16 v[74:75], v12 offset:4096
    s_add_u32 m0, s26, 58112
    v_mfma_f32_16x16x32_bf16 v[204:207], v[56:59], v[108:111], v[204:207]
    buffer_load_dwordx4 v6, s[16:19], s25 offen offset:256 sc1 lds
    v_mfma_f32_16x16x32_bf16 v[236:239], v[60:63], v[108:111], v[236:239]
    ds_read_b64_tr_b16 v[76:77], v13 offset:0
    v_mfma_f32_16x16x32_bf16 v[144:147], v[48:51], v[112:115], v[144:147]
    ds_read_b64_tr_b16 v[78:79], v13 offset:4096
    v_mfma_f32_16x16x32_bf16 v[176:179], v[52:55], v[112:115], v[176:179]
    ds_read_b64_tr_b16 v[80:81], v14 offset:0
    s_add_u32 m0, s88, 57344
    s_mov_b32 s89, 1990656
    v_mfma_f32_16x16x32_bf16 v[208:211], v[56:59], v[112:115], v[208:211]
    buffer_load_dwordx4 v7, s[80:83], s89 offen lds
    v_mfma_f32_16x16x32_bf16 v[240:243], v[60:63], v[112:115], v[240:243]
    ds_read_b64_tr_b16 v[82:83], v14 offset:4096
    v_mfma_f32_16x16x32_bf16 v[148:151], v[48:51], v[116:119], v[148:151]
    ds_read_b64_tr_b16 v[84:85], v15 offset:0
    v_mfma_f32_16x16x32_bf16 v[180:183], v[52:55], v[116:119], v[180:183]
    ds_read_b64_tr_b16 v[86:87], v15 offset:4096
    v_mfma_f32_16x16x32_bf16 v[212:215], v[56:59], v[116:119], v[212:215]
    ds_read_b64_tr_b16 v[88:89], v16 offset:0
    s_add_u32 m0, s88, 61440
    v_mfma_f32_16x16x32_bf16 v[244:247], v[60:63], v[116:119], v[244:247]
    buffer_load_dwordx4 v7, s[84:87], s89 offen lds
    v_mfma_f32_16x16x32_bf16 v[152:155], v[48:51], v[120:123], v[152:155]
    ds_read_b64_tr_b16 v[90:91], v16 offset:4096
    v_mfma_f32_16x16x32_bf16 v[184:187], v[52:55], v[120:123], v[184:187]
    ds_read_b64_tr_b16 v[92:93], v17 offset:0
    v_mfma_f32_16x16x32_bf16 v[216:219], v[56:59], v[120:123], v[216:219]
    ds_read_b64_tr_b16 v[94:95], v17 offset:4096
    v_mfma_f32_16x16x32_bf16 v[248:251], v[60:63], v[120:123], v[248:251]
    s_add_u32 s47, s46, 819200
    buffer_load_dwordx4 a[116:119], v8, s[40:43], s47 offen offset:0 sc1
    v_mfma_f32_16x16x32_bf16 v[156:159], v[48:51], v[124:127], v[156:159]
    v_mfma_f32_16x16x32_bf16 v[188:191], v[52:55], v[124:127], v[188:191]
    v_mfma_f32_16x16x32_bf16 v[220:223], v[56:59], v[124:127], v[220:223]
    v_mfma_f32_16x16x32_bf16 v[252:255], v[60:63], v[124:127], v[252:255]
    s_waitcnt lgkmcnt(0)
    s_waitcnt vmcnt(17)
    s_barrier
    v_mfma_f32_16x16x32_bf16 v[128:131], v[32:35], v[64:67], v[128:131]
    ds_read_b64_tr_b16 v[48:49], v18 offset:16384
    s_add_u32 m0, s26, 0
    s_mov_b32 s25, 2097152
    v_mfma_f32_16x16x32_bf16 v[160:163], v[36:39], v[64:67], v[160:163]
    buffer_load_dwordx4 v5, s[16:19], s25 offen offset:0 sc1 lds
    ds_read_b64_tr_b16 v[50:51], v18 offset:18432
    v_mfma_f32_16x16x32_bf16 v[192:195], v[40:43], v[64:67], v[192:195]
    ds_read_b64_tr_b16 v[52:53], v18 offset:20480
    v_mfma_f32_16x16x32_bf16 v[224:227], v[44:47], v[64:67], v[224:227]
    ds_read_b64_tr_b16 v[54:55], v18 offset:22528
    v_mfma_f32_16x16x32_bf16 v[132:135], v[32:35], v[68:71], v[132:135]
    ds_read_b64_tr_b16 v[56:57], v19 offset:16384
    s_add_u32 m0, s26, 1024
    v_mfma_f32_16x16x32_bf16 v[164:167], v[36:39], v[68:71], v[164:167]
    buffer_load_dwordx4 v6, s[16:19], s25 offen offset:0 sc1 lds
    ds_read_b64_tr_b16 v[58:59], v19 offset:18432
    v_mfma_f32_16x16x32_bf16 v[196:199], v[40:43], v[68:71], v[196:199]
    ds_read_b64_tr_b16 v[60:61], v19 offset:20480
    v_mfma_f32_16x16x32_bf16 v[228:231], v[44:47], v[68:71], v[228:231]
    ds_read_b64_tr_b16 v[62:63], v19 offset:22528
    v_mfma_f32_16x16x32_bf16 v[136:139], v[32:35], v[72:75], v[136:139]
    ds_read_b64_tr_b16 v[96:97], v10 offset:16384
    s_add_u32 m0, s26, 7936
    v_mfma_f32_16x16x32_bf16 v[168:171], v[36:39], v[72:75], v[168:171]
    buffer_load_dwordx4 v5, s[16:19], s25 offen offset:256 sc1 lds
    ds_read_b64_tr_b16 v[98:99], v10 offset:20480
    v_mfma_f32_16x16x32_bf16 v[200:203], v[40:43], v[72:75], v[200:203]
    ds_read_b64_tr_b16 v[100:101], v11 offset:16384
    v_mfma_f32_16x16x32_bf16 v[232:235], v[44:47], v[72:75], v[232:235]
    ds_read_b64_tr_b16 v[102:103], v11 offset:20480
    v_mfma_f32_16x16x32_bf16 v[140:143], v[32:35], v[76:79], v[140:143]
    ds_read_b64_tr_b16 v[104:105], v12 offset:16384
    v_mfma_f32_16x16x32_bf16 v[172:175], v[36:39], v[76:79], v[172:175]
    ds_read_b64_tr_b16 v[106:107], v12 offset:20480
    s_add_u32 m0, s26, 8960
    v_mfma_f32_16x16x32_bf16 v[204:207], v[40:43], v[76:79], v[204:207]
    buffer_load_dwordx4 v6, s[16:19], s25 offen offset:256 sc1 lds
    v_mfma_f32_16x16x32_bf16 v[236:239], v[44:47], v[76:79], v[236:239]
    ds_read_b64_tr_b16 v[108:109], v13 offset:16384
    v_mfma_f32_16x16x32_bf16 v[144:147], v[32:35], v[80:83], v[144:147]
    ds_read_b64_tr_b16 v[110:111], v13 offset:20480
    v_mfma_f32_16x16x32_bf16 v[176:179], v[36:39], v[80:83], v[176:179]
    ds_read_b64_tr_b16 v[112:113], v14 offset:16384
    s_add_u32 m0, s88, 65536
    s_mov_b32 s89, 2101248
    v_mfma_f32_16x16x32_bf16 v[208:211], v[40:43], v[80:83], v[208:211]
    buffer_load_dwordx4 v7, s[80:83], s89 offen lds
    v_mfma_f32_16x16x32_bf16 v[240:243], v[44:47], v[80:83], v[240:243]
    ds_read_b64_tr_b16 v[114:115], v14 offset:20480
    v_mfma_f32_16x16x32_bf16 v[148:151], v[32:35], v[84:87], v[148:151]
    ds_read_b64_tr_b16 v[116:117], v15 offset:16384
    v_mfma_f32_16x16x32_bf16 v[180:183], v[36:39], v[84:87], v[180:183]
    ds_read_b64_tr_b16 v[118:119], v15 offset:20480
    v_mfma_f32_16x16x32_bf16 v[212:215], v[40:43], v[84:87], v[212:215]
    ds_read_b64_tr_b16 v[120:121], v16 offset:16384
    s_add_u32 m0, s88, 69632
    v_mfma_f32_16x16x32_bf16 v[244:247], v[44:47], v[84:87], v[244:247]
    buffer_load_dwordx4 v7, s[84:87], s89 offen lds
    v_mfma_f32_16x16x32_bf16 v[152:155], v[32:35], v[88:91], v[152:155]
    ds_read_b64_tr_b16 v[122:123], v16 offset:20480
    v_mfma_f32_16x16x32_bf16 v[184:187], v[36:39], v[88:91], v[184:187]
    ds_read_b64_tr_b16 v[124:125], v17 offset:16384
    v_mfma_f32_16x16x32_bf16 v[216:219], v[40:43], v[88:91], v[216:219]
    ds_read_b64_tr_b16 v[126:127], v17 offset:20480
    v_mfma_f32_16x16x32_bf16 v[248:251], v[44:47], v[88:91], v[248:251]
    s_add_u32 s47, s46, 983040
    buffer_load_dwordx4 a[120:123], v9, s[40:43], s47 offen offset:0 sc1
    v_mfma_f32_16x16x32_bf16 v[156:159], v[32:35], v[92:95], v[156:159]
    v_mfma_f32_16x16x32_bf16 v[188:191], v[36:39], v[92:95], v[188:191]
    v_mfma_f32_16x16x32_bf16 v[220:223], v[40:43], v[92:95], v[220:223]
    v_mfma_f32_16x16x32_bf16 v[252:255], v[44:47], v[92:95], v[252:255]
    s_waitcnt lgkmcnt(0)
    s_waitcnt vmcnt(17)
    s_barrier
    v_mfma_f32_16x16x32_bf16 v[128:131], v[48:51], v[96:99], v[128:131]
    ds_read_b64_tr_b16 v[32:33], v18 offset:24576
    s_add_u32 m0, s26, 16384
    s_mov_b32 s25, 2228224
    v_mfma_f32_16x16x32_bf16 v[160:163], v[52:55], v[96:99], v[160:163]
    buffer_load_dwordx4 v5, s[16:19], s25 offen offset:0 sc1 lds
    ds_read_b64_tr_b16 v[34:35], v18 offset:26624
    v_mfma_f32_16x16x32_bf16 v[192:195], v[56:59], v[96:99], v[192:195]
    ds_read_b64_tr_b16 v[36:37], v18 offset:28672
    v_mfma_f32_16x16x32_bf16 v[224:227], v[60:63], v[96:99], v[224:227]
    ds_read_b64_tr_b16 v[38:39], v18 offset:30720
    v_mfma_f32_16x16x32_bf16 v[132:135], v[48:51], v[100:103], v[132:135]
    ds_read_b64_tr_b16 v[40:41], v19 offset:24576
    s_add_u32 m0, s26, 17408
    v_mfma_f32_16x16x32_bf16 v[164:167], v[52:55], v[100:103], v[164:167]
    buffer_load_dwordx4 v6, s[16:19], s25 offen offset:0 sc1 lds
    ds_read_b64_tr_b16 v[42:43], v19 offset:26624
    v_mfma_f32_16x16x32_bf16 v[196:199], v[56:59], v[100:103], v[196:199]
    ds_read_b64_tr_b16 v[44:45], v19 offset:28672
    v_mfma_f32_16x16x32_bf16 v[228:231], v[60:63], v[100:103], v[228:231]
    ds_read_b64_tr_b16 v[46:47], v19 offset:30720
    v_mfma_f32_16x16x32_bf16 v[136:139], v[48:51], v[104:107], v[136:139]
    ds_read_b64_tr_b16 v[64:65], v10 offset:32768
    s_add_u32 m0, s26, 24320
    v_mfma_f32_16x16x32_bf16 v[168:171], v[52:55], v[104:107], v[168:171]
    buffer_load_dwordx4 v5, s[16:19], s25 offen offset:256 sc1 lds
    ds_read_b64_tr_b16 v[66:67], v10 offset:36864
    v_mfma_f32_16x16x32_bf16 v[200:203], v[56:59], v[104:107], v[200:203]
    ds_read_b64_tr_b16 v[68:69], v11 offset:32768
    v_mfma_f32_16x16x32_bf16 v[232:235], v[60:63], v[104:107], v[232:235]
    ds_read_b64_tr_b16 v[70:71], v11 offset:36864
    v_mfma_f32_16x16x32_bf16 v[140:143], v[48:51], v[108:111], v[140:143]
    ds_read_b64_tr_b16 v[72:73], v12 offset:32768
    v_mfma_f32_16x16x32_bf16 v[172:175], v[52:55], v[108:111], v[172:175]
    ds_read_b64_tr_b16 v[74:75], v12 offset:36864
    s_add_u32 m0, s26, 25344
    v_mfma_f32_16x16x32_bf16 v[204:207], v[56:59], v[108:111], v[204:207]
    buffer_load_dwordx4 v6, s[16:19], s25 offen offset:256 sc1 lds
    v_mfma_f32_16x16x32_bf16 v[236:239], v[60:63], v[108:111], v[236:239]
    ds_read_b64_tr_b16 v[76:77], v13 offset:32768
    v_mfma_f32_16x16x32_bf16 v[144:147], v[48:51], v[112:115], v[144:147]
    ds_read_b64_tr_b16 v[78:79], v13 offset:36864
    v_mfma_f32_16x16x32_bf16 v[176:179], v[52:55], v[112:115], v[176:179]
    ds_read_b64_tr_b16 v[80:81], v14 offset:32768
    v_mfma_f32_16x16x32_bf16 v[208:211], v[56:59], v[112:115], v[208:211]
    s_add_u32 s47, s46, 983040
    buffer_load_dwordx4 a[124:127], v9, s[40:43], s47 offen offset:1024 sc1
    v_mfma_f32_16x16x32_bf16 v[240:243], v[60:63], v[112:115], v[240:243]
    ds_read_b64_tr_b16 v[82:83], v14 offset:36864
    v_mfma_f32_16x16x32_bf16 v[148:151], v[48:51], v[116:119], v[148:151]
    ds_read_b64_tr_b16 v[84:85], v15 offset:32768
    v_mfma_f32_16x16x32_bf16 v[180:183], v[52:55], v[116:119], v[180:183]
    ds_read_b64_tr_b16 v[86:87], v15 offset:36864
    v_mfma_f32_16x16x32_bf16 v[212:215], v[56:59], v[116:119], v[212:215]
    ds_read_b64_tr_b16 v[88:89], v16 offset:32768
    v_mfma_f32_16x16x32_bf16 v[244:247], v[60:63], v[116:119], v[244:247]
    s_add_u32 s47, s46, 983040
    buffer_load_dwordx4 a[128:131], v9, s[40:43], s47 offen offset:2048 sc1
    v_mfma_f32_16x16x32_bf16 v[152:155], v[48:51], v[120:123], v[152:155]
    ds_read_b64_tr_b16 v[90:91], v16 offset:36864
    v_mfma_f32_16x16x32_bf16 v[184:187], v[52:55], v[120:123], v[184:187]
    ds_read_b64_tr_b16 v[92:93], v17 offset:32768
    v_mfma_f32_16x16x32_bf16 v[216:219], v[56:59], v[120:123], v[216:219]
    ds_read_b64_tr_b16 v[94:95], v17 offset:36864
    v_mfma_f32_16x16x32_bf16 v[248:251], v[60:63], v[120:123], v[248:251]
    s_add_u32 s47, s46, 983040
    buffer_load_dwordx4 a[132:135], v9, s[40:43], s47 offen offset:3072 sc1
    v_mfma_f32_16x16x32_bf16 v[156:159], v[48:51], v[124:127], v[156:159]
    v_mfma_f32_16x16x32_bf16 v[188:191], v[52:55], v[124:127], v[188:191]
    v_mfma_f32_16x16x32_bf16 v[220:223], v[56:59], v[124:127], v[220:223]
    v_mfma_f32_16x16x32_bf16 v[252:255], v[60:63], v[124:127], v[252:255]
    s_waitcnt lgkmcnt(0)
    s_waitcnt vmcnt(17)
    s_barrier
    v_mfma_f32_16x16x32_bf16 v[128:131], v[32:35], v[64:67], v[128:131]
    ds_read_b64_tr_b16 v[48:49], v18 offset:32768
    v_mfma_f32_16x16x32_bf16 v[160:163], v[36:39], v[64:67], v[160:163]
    s_mov_b64 exec, 0xf
    global_load_dwordx2 v[24:25], v20, s[12:13] sc1
    s_mov_b64 exec, -1
    ds_read_b64_tr_b16 v[50:51], v18 offset:34816
    v_mfma_f32_16x16x32_bf16 v[192:195], v[40:43], v[64:67], v[192:195]
    ds_read_b64_tr_b16 v[52:53], v18 offset:36864
    v_mfma_f32_16x16x32_bf16 v[224:227], v[44:47], v[64:67], v[224:227]
    ds_read_b64_tr_b16 v[54:55], v18 offset:38912
    v_mfma_f32_16x16x32_bf16 v[132:135], v[32:35], v[68:71], v[132:135]
    ds_read_b64_tr_b16 v[56:57], v19 offset:32768
    s_add_u32 m0, s26, 32768
    s_mov_b32 s25, 2359296
    v_mfma_f32_16x16x32_bf16 v[164:167], v[36:39], v[68:71], v[164:167]
    buffer_load_dwordx4 v5, s[16:19], s25 offen offset:0 sc1 lds
    ds_read_b64_tr_b16 v[58:59], v19 offset:34816
    v_mfma_f32_16x16x32_bf16 v[196:199], v[40:43], v[68:71], v[196:199]
    ds_read_b64_tr_b16 v[60:61], v19 offset:36864
    v_mfma_f32_16x16x32_bf16 v[228:231], v[44:47], v[68:71], v[228:231]
    ds_read_b64_tr_b16 v[62:63], v19 offset:38912
    v_mfma_f32_16x16x32_bf16 v[136:139], v[32:35], v[72:75], v[136:139]
    ds_read_b64_tr_b16 v[96:97], v10 offset:49152
    s_add_u32 m0, s26, 33792
    v_mfma_f32_16x16x32_bf16 v[168:171], v[36:39], v[72:75], v[168:171]
    buffer_load_dwordx4 v6, s[16:19], s25 offen offset:0 sc1 lds
    ds_read_b64_tr_b16 v[98:99], v10 offset:53248
    v_mfma_f32_16x16x32_bf16 v[200:203], v[40:43], v[72:75], v[200:203]
    ds_read_b64_tr_b16 v[100:101], v11 offset:49152
    v_mfma_f32_16x16x32_bf16 v[232:235], v[44:47], v[72:75], v[232:235]
    ds_read_b64_tr_b16 v[102:103], v11 offset:53248
    v_mfma_f32_16x16x32_bf16 v[140:143], v[32:35], v[76:79], v[140:143]
    ds_read_b64_tr_b16 v[104:105], v12 offset:49152
    v_mfma_f32_16x16x32_bf16 v[172:175], v[36:39], v[76:79], v[172:175]
    ds_read_b64_tr_b16 v[106:107], v12 offset:53248
    s_add_u32 m0, s26, 40704
    v_mfma_f32_16x16x32_bf16 v[204:207], v[40:43], v[76:79], v[204:207]
    buffer_load_dwordx4 v5, s[16:19], s25 offen offset:256 sc1 lds
    v_mfma_f32_16x16x32_bf16 v[236:239], v[44:47], v[76:79], v[236:239]
    ds_read_b64_tr_b16 v[108:109], v13 offset:49152
    v_mfma_f32_16x16x32_bf16 v[144:147], v[32:35], v[80:83], v[144:147]
    ds_read_b64_tr_b16 v[110:111], v13 offset:53248
    v_mfma_f32_16x16x32_bf16 v[176:179], v[36:39], v[80:83], v[176:179]
    ds_read_b64_tr_b16 v[112:113], v14 offset:49152
    s_add_u32 m0, s26, 41728
    v_mfma_f32_16x16x32_bf16 v[208:211], v[40:43], v[80:83], v[208:211]
    buffer_load_dwordx4 v6, s[16:19], s25 offen offset:256 sc1 lds
    v_mfma_f32_16x16x32_bf16 v[240:243], v[44:47], v[80:83], v[240:243]
    ds_read_b64_tr_b16 v[114:115], v14 offset:53248
    v_mfma_f32_16x16x32_bf16 v[148:151], v[32:35], v[84:87], v[148:151]
    ds_read_b64_tr_b16 v[116:117], v15 offset:49152
    v_mfma_f32_16x16x32_bf16 v[180:183], v[36:39], v[84:87], v[180:183]
    ds_read_b64_tr_b16 v[118:119], v15 offset:53248
    v_mfma_f32_16x16x32_bf16 v[212:215], v[40:43], v[84:87], v[212:215]
    ds_read_b64_tr_b16 v[120:121], v16 offset:49152
    v_mfma_f32_16x16x32_bf16 v[244:247], v[44:47], v[84:87], v[244:247]
    s_add_u32 s47, s46, 983040
    buffer_load_dwordx4 a[136:139], v8, s[40:43], s47 offen offset:0 sc1
    v_mfma_f32_16x16x32_bf16 v[152:155], v[32:35], v[88:91], v[152:155]
    ds_read_b64_tr_b16 v[122:123], v16 offset:53248
    v_mfma_f32_16x16x32_bf16 v[184:187], v[36:39], v[88:91], v[184:187]
    ds_read_b64_tr_b16 v[124:125], v17 offset:49152
    v_mfma_f32_16x16x32_bf16 v[216:219], v[40:43], v[88:91], v[216:219]
    ds_read_b64_tr_b16 v[126:127], v17 offset:53248
    v_mfma_f32_16x16x32_bf16 v[248:251], v[44:47], v[88:91], v[248:251]
    s_add_u32 s47, s46, 1146880
    buffer_load_dwordx4 a[140:143], v9, s[40:43], s47 offen offset:0 sc1
    v_mfma_f32_16x16x32_bf16 v[156:159], v[32:35], v[92:95], v[156:159]
    v_mfma_f32_16x16x32_bf16 v[188:191], v[36:39], v[92:95], v[188:191]
    v_mfma_f32_16x16x32_bf16 v[220:223], v[40:43], v[92:95], v[220:223]
    v_mfma_f32_16x16x32_bf16 v[252:255], v[44:47], v[92:95], v[252:255]
    s_waitcnt lgkmcnt(0)
    s_waitcnt vmcnt(17)
    s_barrier
    v_mfma_f32_16x16x32_bf16 v[128:131], v[48:51], v[96:99], v[128:131]
    ds_read_b64_tr_b16 v[32:33], v18 offset:40960
    s_add_u32 m0, s26, 49152
    s_mov_b32 s25, 2490368
    v_mfma_f32_16x16x32_bf16 v[160:163], v[52:55], v[96:99], v[160:163]
    buffer_load_dwordx4 v5, s[16:19], s25 offen offset:0 sc1 lds
    ds_read_b64_tr_b16 v[34:35], v18 offset:43008
    v_mfma_f32_16x16x32_bf16 v[192:195], v[56:59], v[96:99], v[192:195]
    ds_read_b64_tr_b16 v[36:37], v18 offset:45056
    v_mfma_f32_16x16x32_bf16 v[224:227], v[60:63], v[96:99], v[224:227]
    ds_read_b64_tr_b16 v[38:39], v18 offset:47104
    v_mfma_f32_16x16x32_bf16 v[132:135], v[48:51], v[100:103], v[132:135]
    ds_read_b64_tr_b16 v[40:41], v19 offset:40960
    s_add_u32 m0, s26, 50176
    v_mfma_f32_16x16x32_bf16 v[164:167], v[52:55], v[100:103], v[164:167]
    buffer_load_dwordx4 v6, s[16:19], s25 offen offset:0 sc1 lds
    ds_read_b64_tr_b16 v[42:43], v19 offset:43008
    v_mfma_f32_16x16x32_bf16 v[196:199], v[56:59], v[100:103], v[196:199]
    ds_read_b64_tr_b16 v[44:45], v19 offset:45056
    v_mfma_f32_16x16x32_bf16 v[228:231], v[60:63], v[100:103], v[228:231]
    ds_read_b64_tr_b16 v[46:47], v19 offset:47104
    v_mfma_f32_16x16x32_bf16 v[136:139], v[48:51], v[104:107], v[136:139]
    ds_read_b64_tr_b16 v[64:65], v10 offset:0
    s_add_u32 m0, s26, 57088
    v_mfma_f32_16x16x32_bf16 v[168:171], v[52:55], v[104:107], v[168:171]
    buffer_load_dwordx4 v5, s[16:19], s25 offen offset:256 sc1 lds
    ds_read_b64_tr_b16 v[66:67], v10 offset:4096
    v_mfma_f32_16x16x32_bf16 v[200:203], v[56:59], v[104:107], v[200:203]
    ds_read_b64_tr_b16 v[68:69], v11 offset:0
    v_mfma_f32_16x16x32_bf16 v[232:235], v[60:63], v[104:107], v[232:235]
    ds_read_b64_tr_b16 v[70:71], v11 offset:4096
    v_mfma_f32_16x16x32_bf16 v[140:143], v[48:51], v[108:111], v[140:143]
    ds_read_b64_tr_b16 v[72:73], v12 offset:0
    v_mfma_f32_16x16x32_bf16 v[172:175], v[52:55], v[108:111], v[172:175]
    ds_read_b64_tr_b16 v[74:75], v12 offset:4096
    s_add_u32 m0, s26, 58112
    v_mfma_f32_16x16x32_bf16 v[204:207], v[56:59], v[108:111], v[204:207]
    buffer_load_dwordx4 v6, s[16:19], s25 offen offset:256 sc1 lds
    v_mfma_f32_16x16x32_bf16 v[236:239], v[60:63], v[108:111], v[236:239]
    ds_read_b64_tr_b16 v[76:77], v13 offset:0
    v_mfma_f32_16x16x32_bf16 v[144:147], v[48:51], v[112:115], v[144:147]
    ds_read_b64_tr_b16 v[78:79], v13 offset:4096
    v_mfma_f32_16x16x32_bf16 v[176:179], v[52:55], v[112:115], v[176:179]
    ds_read_b64_tr_b16 v[80:81], v14 offset:0
    v_mfma_f32_16x16x32_bf16 v[208:211], v[56:59], v[112:115], v[208:211]
    s_add_u32 s47, s46, 1146880
    buffer_load_dwordx4 a[144:147], v9, s[40:43], s47 offen offset:1024 sc1
    v_mfma_f32_16x16x32_bf16 v[240:243], v[60:63], v[112:115], v[240:243]
    ds_read_b64_tr_b16 v[82:83], v14 offset:4096
    v_mfma_f32_16x16x32_bf16 v[148:151], v[48:51], v[116:119], v[148:151]
    ds_read_b64_tr_b16 v[84:85], v15 offset:0
    v_mfma_f32_16x16x32_bf16 v[180:183], v[52:55], v[116:119], v[180:183]
    ds_read_b64_tr_b16 v[86:87], v15 offset:4096
    v_mfma_f32_16x16x32_bf16 v[212:215], v[56:59], v[116:119], v[212:215]
    ds_read_b64_tr_b16 v[88:89], v16 offset:0
    v_mfma_f32_16x16x32_bf16 v[244:247], v[60:63], v[116:119], v[244:247]
    s_add_u32 s47, s46, 1146880
    buffer_load_dwordx4 a[148:151], v9, s[40:43], s47 offen offset:2048 sc1
    v_mfma_f32_16x16x32_bf16 v[152:155], v[48:51], v[120:123], v[152:155]
    ds_read_b64_tr_b16 v[90:91], v16 offset:4096
    v_mfma_f32_16x16x32_bf16 v[184:187], v[52:55], v[120:123], v[184:187]
    ds_read_b64_tr_b16 v[92:93], v17 offset:0
    v_mfma_f32_16x16x32_bf16 v[216:219], v[56:59], v[120:123], v[216:219]
    ds_read_b64_tr_b16 v[94:95], v17 offset:4096
    v_mfma_f32_16x16x32_bf16 v[248:251], v[60:63], v[120:123], v[248:251]
    s_add_u32 s47, s46, 1146880
    buffer_load_dwordx4 a[152:155], v9, s[40:43], s47 offen offset:3072 sc1
    v_mfma_f32_16x16x32_bf16 v[156:159], v[48:51], v[124:127], v[156:159]
    v_mfma_f32_16x16x32_bf16 v[188:191], v[52:55], v[124:127], v[188:191]
    v_mfma_f32_16x16x32_bf16 v[220:223], v[56:59], v[124:127], v[220:223]
    v_mfma_f32_16x16x32_bf16 v[252:255], v[60:63], v[124:127], v[252:255]
    s_waitcnt lgkmcnt(0)
    s_waitcnt vmcnt(13)
    s_barrier
    s_mov_b32 s74, 0x100000
h3_slow_52:
    v_cmp_ne_u64 vcc, s[70:71], v[24:25]
    s_cbranch_vccz h3_ok_51
    s_mov_b64 exec, 0xf
    global_load_dwordx2 v[24:25], v20, s[12:13] sc1
    s_mov_b64 exec, -1
    s_waitcnt vmcnt(0)
    s_sub_u32 s74, s74, 1
    s_cbranch_scc0 h3_slow_52
h3_ok_51:
    v_mfma_f32_16x16x32_bf16 v[128:131], v[32:35], v[64:67], v[128:131]
    ds_read_b64_tr_b16 v[48:49], v18 offset:49152
    s_mov_b32 m0, s30
    v_mfma_f32_16x16x32_bf16 v[160:163], v[36:39], v[64:67], v[160:163]
    global_load_lds_dwordx4 v21, s[12:13] sc1
    ds_read_b64_tr_b16 v[50:51], v18 offset:51200
    v_mfma_f32_16x16x32_bf16 v[192:195], v[40:43], v[64:67], v[192:195]
    ds_read_b64_tr_b16 v[52:53], v18 offset:53248
    v_mfma_f32_16x16x32_bf16 v[224:227], v[44:47], v[64:67], v[224:227]
    ds_read_b64_tr_b16 v[54:55], v18 offset:55296
    v_mfma_f32_16x16x32_bf16 v[132:135], v[32:35], v[68:71], v[132:135]
    ds_read_b64_tr_b16 v[56:57], v19 offset:49152
    s_mov_b32 m0, s31
    v_mfma_f32_16x16x32_bf16 v[164:167], v[36:39], v[68:71], v[164:167]
    s_mov_b32 exec_hi, 0
    global_load_lds_dwordx4 v22, s[12:13] sc1
    s_mov_b64 exec, -1
    ds_read_b64_tr_b16 v[58:59], v19 offset:51200
    v_mfma_f32_16x16x32_bf16 v[196:199], v[40:43], v[68:71], v[196:199]
    ds_read_b64_tr_b16 v[60:61], v19 offset:53248
    v_mfma_f32_16x16x32_bf16 v[228:231], v[44:47], v[68:71], v[228:231]
    ds_read_b64_tr_b16 v[62:63], v19 offset:55296
    v_mfma_f32_16x16x32_bf16 v[136:139], v[32:35], v[72:75], v[136:139]
    ds_read_b64_tr_b16 v[96:97], v10 offset:16384
    v_mfma_f32_16x16x32_bf16 v[168:171], v[36:39], v[72:75], v[168:171]
    s_add_u32 s47, s46, 1146880
    buffer_load_dwordx4 a[156:159], v8, s[40:43], s47 offen offset:0 sc1
    ds_read_b64_tr_b16 v[98:99], v10 offset:20480
    v_mfma_f32_16x16x32_bf16 v[200:203], v[40:43], v[72:75], v[200:203]
    ds_read_b64_tr_b16 v[100:101], v11 offset:16384
    v_mfma_f32_16x16x32_bf16 v[232:235], v[44:47], v[72:75], v[232:235]
    ds_read_b64_tr_b16 v[102:103], v11 offset:20480
    v_mfma_f32_16x16x32_bf16 v[140:143], v[32:35], v[76:79], v[140:143]
    ds_read_b64_tr_b16 v[104:105], v12 offset:16384
    v_mfma_f32_16x16x32_bf16 v[172:175], v[36:39], v[76:79], v[172:175]
    ds_read_b64_tr_b16 v[106:107], v12 offset:20480
    v_mfma_f32_16x16x32_bf16 v[204:207], v[40:43], v[76:79], v[204:207]
    s_add_u32 s47, s46, 1310720
    buffer_load_dwordx4 a[160:163], v9, s[40:43], s47 offen offset:0 sc1
    v_mfma_f32_16x16x32_bf16 v[236:239], v[44:47], v[76:79], v[236:239]
    ds_read_b64_tr_b16 v[108:109], v13 offset:16384
    v_mfma_f32_16x16x32_bf16 v[144:147], v[32:35], v[80:83], v[144:147]
    ds_read_b64_tr_b16 v[110:111], v13 offset:20480
    v_mfma_f32_16x16x32_bf16 v[176:179], v[36:39], v[80:83], v[176:179]
    ds_read_b64_tr_b16 v[112:113], v14 offset:16384
    v_mfma_f32_16x16x32_bf16 v[208:211], v[40:43], v[80:83], v[208:211]
    s_add_u32 s47, s46, 1310720
    buffer_load_dwordx4 a[164:167], v9, s[40:43], s47 offen offset:1024 sc1
    v_mfma_f32_16x16x32_bf16 v[240:243], v[44:47], v[80:83], v[240:243]
    ds_read_b64_tr_b16 v[114:115], v14 offset:20480
    v_mfma_f32_16x16x32_bf16 v[148:151], v[32:35], v[84:87], v[148:151]
    ds_read_b64_tr_b16 v[116:117], v15 offset:16384
    v_mfma_f32_16x16x32_bf16 v[180:183], v[36:39], v[84:87], v[180:183]
    ds_read_b64_tr_b16 v[118:119], v15 offset:20480
    v_mfma_f32_16x16x32_bf16 v[212:215], v[40:43], v[84:87], v[212:215]
    ds_read_b64_tr_b16 v[120:121], v16 offset:16384
    v_mfma_f32_16x16x32_bf16 v[244:247], v[44:47], v[84:87], v[244:247]
    s_add_u32 s47, s46, 1310720
    buffer_load_dwordx4 a[168:171], v9, s[40:43], s47 offen offset:2048 sc1
    v_mfma_f32_16x16x32_bf16 v[152:155], v[32:35], v[88:91], v[152:155]
    ds_read_b64_tr_b16 v[122:123], v16 offset:20480
    v_mfma_f32_16x16x32_bf16 v[184:187], v[36:39], v[88:91], v[184:187]
    ds_read_b64_tr_b16 v[124:125], v17 offset:16384
    v_mfma_f32_16x16x32_bf16 v[216:219], v[40:43], v[88:91], v[216:219]
    ds_read_b64_tr_b16 v[126:127], v17 offset:20480
    v_mfma_f32_16x16x32_bf16 v[248:251], v[44:47], v[88:91], v[248:251]
    s_add_u32 s47, s46, 1310720
    buffer_load_dwordx4 a[172:175], v9, s[40:43], s47 offen offset:3072 sc1
    v_mfma_f32_16x16x32_bf16 v[156:159], v[32:35], v[92:95], v[156:159]
    v_mfma_f32_16x16x32_bf16 v[188:191], v[36:39], v[92:95], v[188:191]
    v_mfma_f32_16x16x32_bf16 v[220:223], v[40:43], v[92:95], v[220:223]
    v_mfma_f32_16x16x32_bf16 v[252:255], v[44:47], v[92:95], v[252:255]
    s_waitcnt lgkmcnt(0)
    s_waitcnt vmcnt(16)
    s_barrier
    v_mfma_f32_16x16x32_bf16 v[128:131], v[48:51], v[96:99], v[128:131]
    ds_read_b64_tr_b16 v[32:33], v18 offset:57344
    v_mfma_f32_16x16x32_bf16 v[160:163], v[52:55], v[96:99], v[160:163]
    s_add_u32 s47, s46, 1310720
    buffer_load_dwordx4 a[176:179], v8, s[40:43], s47 offen offset:0 sc1
    ds_read_b64_tr_b16 v[34:35], v18 offset:59392
    v_mfma_f32_16x16x32_bf16 v[192:195], v[56:59], v[96:99], v[192:195]
    ds_read_b64_tr_b16 v[36:37], v18 offset:61440
    v_mfma_f32_16x16x32_bf16 v[224:227], v[60:63], v[96:99], v[224:227]
    ds_read_b64_tr_b16 v[38:39], v18 offset:63488
    v_mfma_f32_16x16x32_bf16 v[132:135], v[48:51], v[100:103], v[132:135]
    ds_read_b64_tr_b16 v[40:41], v19 offset:57344
    v_mfma_f32_16x16x32_bf16 v[164:167], v[52:55], v[100:103], v[164:167]
    s_add_u32 s47, s46, 1474560
    buffer_load_dwordx4 a[180:183], v9, s[40:43], s47 offen offset:0 sc1
    ds_read_b64_tr_b16 v[42:43], v19 offset:59392
    v_mfma_f32_16x16x32_bf16 v[196:199], v[56:59], v[100:103], v[196:199]
    ds_read_b64_tr_b16 v[44:45], v19 offset:61440
    v_mfma_f32_16x16x32_bf16 v[228:231], v[60:63], v[100:103], v[228:231]
    ds_read_b64_tr_b16 v[46:47], v19 offset:63488
    v_mfma_f32_16x16x32_bf16 v[136:139], v[48:51], v[104:107], v[136:139]
    ds_read_b64_tr_b16 v[64:65], v10 offset:32768
    v_mfma_f32_16x16x32_bf16 v[168:171], v[52:55], v[104:107], v[168:171]
    s_add_u32 s47, s46, 1474560
    buffer_load_dwordx4 a[184:187], v9, s[40:43], s47 offen offset:1024 sc1
    ds_read_b64_tr_b16 v[66:67], v10 offset:36864
    v_mfma_f32_16x16x32_bf16 v[200:203], v[56:59], v[104:107], v[200:203]
    ds_read_b64_tr_b16 v[68:69], v11 offset:32768
    v_mfma_f32_16x16x32_bf16 v[232:235], v[60:63], v[104:107], v[232:235]
    ds_read_b64_tr_b16 v[70:71], v11 offset:36864
    v_mfma_f32_16x16x32_bf16 v[140:143], v[48:51], v[108:111], v[140:143]
    ds_read_b64_tr_b16 v[72:73], v12 offset:32768
    v_mfma_f32_16x16x32_bf16 v[172:175], v[52:55], v[108:111], v[172:175]
    ds_read_b64_tr_b16 v[74:75], v12 offset:36864
    v_mfma_f32_16x16x32_bf16 v[204:207], v[56:59], v[108:111], v[204:207]
    s_add_u32 s47, s46, 1474560
    buffer_load_dwordx4 a[188:191], v9, s[40:43], s47 offen offset:2048 sc1
    v_mfma_f32_16x16x32_bf16 v[236:239], v[60:63], v[108:111], v[236:239]
    ds_read_b64_tr_b16 v[76:77], v13 offset:32768
    v_mfma_f32_16x16x32_bf16 v[144:147], v[48:51], v[112:115], v[144:147]
    ds_read_b64_tr_b16 v[78:79], v13 offset:36864
    v_mfma_f32_16x16x32_bf16 v[176:179], v[52:55], v[112:115], v[176:179]
    ds_read_b64_tr_b16 v[80:81], v14 offset:32768
    v_mfma_f32_16x16x32_bf16 v[208:211], v[56:59], v[112:115], v[208:211]
    s_add_u32 s47, s46, 1474560
    buffer_load_dwordx4 a[192:195], v9, s[40:43], s47 offen offset:3072 sc1
    v_mfma_f32_16x16x32_bf16 v[240:243], v[60:63], v[112:115], v[240:243]
    ds_read_b64_tr_b16 v[82:83], v14 offset:36864
    v_mfma_f32_16x16x32_bf16 v[148:151], v[48:51], v[116:119], v[148:151]
    ds_read_b64_tr_b16 v[84:85], v15 offset:32768
    v_mfma_f32_16x16x32_bf16 v[180:183], v[52:55], v[116:119], v[180:183]
    ds_read_b64_tr_b16 v[86:87], v15 offset:36864
    v_mfma_f32_16x16x32_bf16 v[212:215], v[56:59], v[116:119], v[212:215]
    ds_read_b64_tr_b16 v[88:89], v16 offset:32768
    v_mfma_f32_16x16x32_bf16 v[244:247], v[60:63], v[116:119], v[244:247]
    s_add_u32 s47, s46, 1474560
    buffer_load_dwordx4 a[196:199], v8, s[40:43], s47 offen offset:0 sc1
    v_mfma_f32_16x16x32_bf16 v[152:155], v[48:51], v[120:123], v[152:155]
    ds_read_b64_tr_b16 v[90:91], v16 offset:36864
    v_mfma_f32_16x16x32_bf16 v[184:187], v[52:55], v[120:123], v[184:187]
    ds_read_b64_tr_b16 v[92:93], v17 offset:32768
    v_mfma_f32_16x16x32_bf16 v[216:219], v[56:59], v[120:123], v[216:219]
    ds_read_b64_tr_b16 v[94:95], v17 offset:36864
    v_mfma_f32_16x16x32_bf16 v[248:251], v[60:63], v[120:123], v[248:251]
    s_add_u32 s47, s46, 1638400
    buffer_load_dwordx4 a[200:203], v9, s[40:43], s47 offen offset:0 sc1
    v_mfma_f32_16x16x32_bf16 v[156:159], v[48:51], v[124:127], v[156:159]
    v_mfma_f32_16x16x32_bf16 v[188:191], v[52:55], v[124:127], v[188:191]
    v_mfma_f32_16x16x32_bf16 v[220:223], v[56:59], v[124:127], v[220:223]
    v_mfma_f32_16x16x32_bf16 v[252:255], v[60:63], v[124:127], v[252:255]
    s_waitcnt lgkmcnt(0)
    s_waitcnt vmcnt(17)
    s_barrier
g1_tail:
    v_mfma_f32_16x16x32_bf16 v[128:131], v[32:35], v[64:67], v[128:131]
    ds_read_b64_tr_b16 v[48:49], v28 offset:0
    v_mfma_f32_16x16x32_bf16 v[160:163], v[36:39], v[64:67], v[160:163]
    s_add_u32 s47, s46, 1638400
    buffer_load_dwordx4 a[204:207], v9, s[40:43], s47 offen offset:1024 sc1
    ds_read_b64_tr_b16 v[50:51], v28 offset:2048
    v_mfma_f32_16x16x32_bf16 v[192:195], v[40:43], v[64:67], v[192:195]
    ds_read_b64_tr_b16 v[52:53], v28 offset:4096
    v_mfma_f32_16x16x32_bf16 v[224:227], v[44:47], v[64:67], v[224:227]
    ds_read_b64_tr_b16 v[54:55], v28 offset:6144
    v_mfma_f32_16x16x32_bf16 v[132:135], v[32:35], v[68:71], v[132:135]
    ds_read_b64_tr_b16 v[56:57], v29 offset:0
    v_mfma_f32_16x16x32_bf16 v[164:167], v[36:39], v[68:71], v[164:167]
    s_add_u32 s47, s46, 1638400
    buffer_load_dwordx4 a[208:211], v9, s[40:43], s47 offen offset:2048 sc1
    ds_read_b64_tr_b16 v[58:59], v29 offset:2048
    v_mfma_f32_16x16x32_bf16 v[196:199], v[40:43], v[68:71], v[196:199]
    ds_read_b64_tr_b16 v[60:61], v29 offset:4096
    v_mfma_f32_16x16x32_bf16 v[228:231], v[44:47], v[68:71], v[228:231]
    ds_read_b64_tr_b16 v[62:63], v29 offset:6144
    v_mfma_f32_16x16x32_bf16 v[136:139], v[32:35], v[72:75], v[136:139]
    ds_read_b64_tr_b16 v[96:97], v10 offset:49152
    v_mfma_f32_16x16x32_bf16 v[168:171], v[36:39], v[72:75], v[168:171]
    s_add_u32 s47, s46, 1638400
    buffer_load_dwordx4 a[212:215], v9, s[40:43], s47 offen offset:3072 sc1
    ds_read_b64_tr_b16 v[98:99], v10 offset:53248
    v_mfma_f32_16x16x32_bf16 v[200:203], v[40:43], v[72:75], v[200:203]
    ds_read_b64_tr_b16 v[100:101], v11 offset:49152
    v_mfma_f32_16x16x32_bf16 v[232:235], v[44:47], v[72:75], v[232:235]
    ds_read_b64_tr_b16 v[102:103], v11 offset:53248
    v_mfma_f32_16x16x32_bf16 v[140:143], v[32:35], v[76:79], v[140:143]
    ds_read_b64_tr_b16 v[104:105], v12 offset:49152
    v_mfma_f32_16x16x32_bf16 v[172:175], v[36:39], v[76:79], v[172:175]
    ds_read_b64_tr_b16 v[106:107], v12 offset:53248
    v_mfma_f32_16x16x32_bf16 v[204:207], v[40:43], v[76:79], v[204:207]
    s_add_u32 s47, s46, 1638400
    buffer_load_dwordx4 a[216:219], v8, s[40:43], s47 offen offset:0 sc1
    v_mfma_f32_16x16x32_bf16 v[236:239], v[44:47], v[76:79], v[236:239]
    ds_read_b64_tr_b16 v[108:109], v13 offset:49152
    v_mfma_f32_16x16x32_bf16 v[144:147], v[32:35], v[80:83], v[144:147]
    ds_read_b64_tr_b16 v[110:111], v13 offset:53248
    v_mfma_f32_16x16x32_bf16 v[176:179], v[36:39], v[80:83], v[176:179]
    ds_read_b64_tr_b16 v[112:113], v14 offset:49152
    v_mfma_f32_16x16x32_bf16 v[208:211], v[40:43], v[80:83], v[208:211]
    s_add_u32 s47, s46, 1802240
    buffer_load_dwordx4 a[220:223], v9, s[40:43], s47 offen offset:0 sc1
    v_mfma_f32_16x16x32_bf16 v[240:243], v[44:47], v[80:83], v[240:243]
    ds_read_b64_tr_b16 v[114:115], v14 offset:53248
    v_mfma_f32_16x16x32_bf16 v[148:151], v[32:35], v[84:87], v[148:151]
    ds_read_b64_tr_b16 v[116:117], v15 offset:49152
    v_mfma_f32_16x16x32_bf16 v[180:183], v[36:39], v[84:87], v[180:183]
    ds_read_b64_tr_b16 v[118:119], v15 offset:53248
    v_mfma_f32_16x16x32_bf16 v[212:215], v[40:43], v[84:87], v[212:215]
    ds_read_b64_tr_b16 v[120:121], v16 offset:49152
    v_mfma_f32_16x16x32_bf16 v[244:247], v[44:47], v[84:87], v[244:247]
    s_add_u32 s47, s46, 1802240
    buffer_load_dwordx4 a[224:227], v9, s[40:43], s47 offen offset:1024 sc1
    v_mfma_f32_16x16x32_bf16 v[152:155], v[32:35], v[88:91], v[152:155]
    ds_read_b64_tr_b16 v[122:123], v16 offset:53248
    v_mfma_f32_16x16x32_bf16 v[184:187], v[36:39], v[88:91], v[184:187]
    ds_read_b64_tr_b16 v[124:125], v17 offset:49152
    v_mfma_f32_16x16x32_bf16 v[216:219], v[40:43], v[88:91], v[216:219]
    ds_read_b64_tr_b16 v[126:127], v17 offset:53248
    v_mfma_f32_16x16x32_bf16 v[248:251], v[44:47], v[88:91], v[248:251]
    s_add_u32 s47, s46, 1802240
    buffer_load_dwordx4 a[228:231], v9, s[40:43], s47 offen offset:2048 sc1
    v_mfma_f32_16x16x32_bf16 v[156:159], v[32:35], v[92:95], v[156:159]
    v_mfma_f32_16x16x32_bf16 v[188:191], v[36:39], v[92:95], v[188:191]
    v_mfma_f32_16x16x32_bf16 v[220:223], v[40:43], v[92:95], v[220:223]
    v_mfma_f32_16x16x32_bf16 v[252:255], v[44:47], v[92:95], v[252:255]
    s_waitcnt lgkmcnt(0)
    s_waitcnt vmcnt(19)
    v_mfma_f32_16x16x32_bf16 v[128:131], v[48:51], v[96:99], v[128:131]
    ds_read_b64 v[32:33], v26 offset:0
    v_mfma_f32_16x16x32_bf16 v[160:163], v[52:55], v[96:99], v[160:163]
    s_add_u32 s47, s46, 1802240
    buffer_load_dwordx4 a[232:235], v9, s[40:43], s47 offen offset:3072 sc1
    v_mfma_f32_16x16x32_bf16 v[192:195], v[56:59], v[96:99], v[192:195]
    ds_read_b64 v[34:35], v26 offset:128
    v_mfma_f32_16x16x32_bf16 v[224:227], v[60:63], v[96:99], v[224:227]
    ds_read_b64 v[36:37], v26 offset:256
    v_mfma_f32_16x16x32_bf16 v[132:135], v[48:51], v[100:103], v[132:135]
    ds_read_b64 v[38:39], v26 offset:384
    v_mfma_f32_16x16x32_bf16 v[164:167], v[52:55], v[100:103], v[164:167]
    ds_read_b64 v[40:41], v26 offset:512
    v_mfma_f32_16x16x32_bf16 v[196:199], v[56:59], v[100:103], v[196:199]
    ds_read_b64 v[42:43], v26 offset:640
    v_mfma_f32_16x16x32_bf16 v[228:231], v[60:63], v[100:103], v[228:231]
    ds_read_b64 v[44:45], v26 offset:768
    v_mfma_f32_16x16x32_bf16 v[136:139], v[48:51], v[104:107], v[136:139]
    s_add_u32 s47, s46, 1802240
    buffer_load_dwordx4 a[236:239], v8, s[40:43], s47 offen offset:0 sc1
    v_mfma_f32_16x16x32_bf16 v[168:171], v[52:55], v[104:107], v[168:171]
    ds_read_b64 v[46:47], v26 offset:896
    v_mfma_f32_16x16x32_bf16 v[200:203], v[56:59], v[104:107], v[200:203]
    ds_read_b128 v[64:67], v27 offset:0
    v_mfma_f32_16x16x32_bf16 v[232:235], v[60:63], v[104:107], v[232:235]
    ds_read_b128 v[68:71], v27 offset:128
    v_mfma_f32_16x16x32_bf16 v[140:143], v[48:51], v[108:111], v[140:143]
    ds_read_b128 v[72:75], v27 offset:256
    v_mfma_f32_16x16x32_bf16 v[172:175], v[52:55], v[108:111], v[172:175]
    ds_read_b128 v[76:79], v27 offset:384
    v_mfma_f32_16x16x32_bf16 v[204:207], v[56:59], v[108:111], v[204:207]
    ds_read_b128 v[80:83], v27 offset:64
    v_mfma_f32_16x16x32_bf16 v[236:239], v[60:63], v[108:111], v[236:239]
    ds_read_b128 v[84:87], v27 offset:192
    v_mfma_f32_16x16x32_bf16 v[144:147], v[48:51], v[112:115], v[144:147]
    s_add_u32 s47, s46, 1966080
    buffer_load_dwordx4 a[240:243], v9, s[40:43], s47 offen offset:0 sc1
    v_mfma_f32_16x16x32_bf16 v[176:179], v[52:55], v[112:115], v[176:179]
    ds_read_b128 v[88:91], v27 offset:320
    v_mfma_f32_16x16x32_bf16 v[208:211], v[56:59], v[112:115], v[208:211]
    ds_read_b128 v[92:95], v27 offset:448
    v_mfma_f32_16x16x32_bf16 v[240:243], v[60:63], v[112:115], v[240:243]
    v_mfma_f32_16x16x32_bf16 v[148:151], v[48:51], v[116:119], v[148:151]
    v_mfma_f32_16x16x32_bf16 v[180:183], v[52:55], v[116:119], v[180:183]
    v_mfma_f32_16x16x32_bf16 v[212:215], v[56:59], v[116:119], v[212:215]
    v_mfma_f32_16x16x32_bf16 v[244:247], v[60:63], v[116:119], v[244:247]
    v_mfma_f32_16x16x32_bf16 v[152:155], v[48:51], v[120:123], v[152:155]
    s_add_u32 s47, s46, 1966080
    buffer_load_dwordx4 a[244:247], v9, s[40:43], s47 offen offset:1024 sc1
    v_mfma_f32_16x16x32_bf16 v[184:187], v[52:55], v[120:123], v[184:187]
    v_mfma_f32_16x16x32_bf16 v[216:219], v[56:59], v[120:123], v[216:219]
    v_mfma_f32_16x16x32_bf16 v[248:251], v[60:63], v[120:123], v[248:251]
    v_mfma_f32_16x16x32_bf16 v[156:159], v[48:51], v[124:127], v[156:159]
    v_mfma_f32_16x16x32_bf16 v[188:191], v[52:55], v[124:127], v[188:191]
    v_mfma_f32_16x16x32_bf16 v[220:223], v[56:59], v[124:127], v[220:223]
    v_mfma_f32_16x16x32_bf16 v[252:255], v[60:63], v[124:127], v[252:255]
    s_lshl_b32 s9, s5, 1
    s_add_u32 s9, s9, s4
    s_mul_i32 s9, s9, 108
    s_add_u32 s9, s9, s7
    s_lshl_b32 s9, s9, 12
    s_add_u32 s9, s9, 13762560
    s_add_u32 s14, s12, s9
    s_addc_u32 s15, s13, 0
    s_add_u32 s28, s14, 221184
    s_addc_u32 s29, s15, 0
    s_waitcnt lgkmcnt(0)
    v_pk_fma_f32 v[112:113], v[64:65], v[32:33], v[68:69] op_sel:[0,1,0] op_sel_hi:[1,1,1]
    v_pk_fma_f32 v[116:117], v[72:73], v[32:33], v[76:77] op_sel:[0,1,0] op_sel_hi:[1,1,1]
    v_pk_fma_f32 v[114:115], v[66:67], v[32:33], v[70:71] op_sel:[0,1,0] op_sel_hi:[1,1,1]
    v_pk_fma_f32 v[118:119], v[74:75], v[32:33], v[78:79] op_sel:[0,1,0] op_sel_hi:[1,1,1]
    v_pk_fma_f32 v[128:129], v[128:129], v[32:33], v[112:113] op_sel_hi:[1,0,1]
    v_pk_fma_f32 v[160:161], v[160:161], v[32:33], v[116:117] op_sel_hi:[1,0,1]
    v_pk_fma_f32 v[130:131], v[130:131], v[32:33], v[114:115] op_sel_hi:[1,0,1]
    v_pk_fma_f32 v[162:163], v[162:163], v[32:33], v[118:119] op_sel_hi:[1,0,1]
    v_max_f32 v128, 0, v128
    v_max_f32 v129, 0, v129
    v_max_f32 v130, 0, v130
    v_max_f32 v131, 0, v131
    v_pk_mul_f32 v[128:129], v[128:129], v[160:161]
    v_pk_mul_f32 v[130:131], v[130:131], v[162:163]
    v_cvt_pk_bf16_f32 v96, v128, v129
    v_cvt_pk_bf16_f32 v97, v130, v131
    v_pk_fma_f32 v[120:121], v[80:81], v[32:33], v[84:85] op_sel:[0,1,0] op_sel_hi:[1,1,1]
    v_pk_fma_f32 v[124:125], v[88:89], v[32:33], v[92:93] op_sel:[0,1,0] op_sel_hi:[1,1,1]
    v_pk_fma_f32 v[122:123], v[82:83], v[32:33], v[86:87] op_sel:[0,1,0] op_sel_hi:[1,1,1]
    v_pk_fma_f32 v[126:127], v[90:91], v[32:33], v[94:95] op_sel:[0,1,0] op_sel_hi:[1,1,1]
    v_pk_fma_f32 v[192:193], v[192:193], v[32:33], v[120:121] op_sel_hi:[1,0,1]
    v_pk_fma_f32 v[224:225], v[224:225], v[32:33], v[124:125] op_sel_hi:[1,0,1]
    v_pk_fma_f32 v[194:195], v[194:195], v[32:33], v[122:123] op_sel_hi:[1,0,1]
    v_pk_fma_f32 v[226:227], v[226:227], v[32:33], v[126:127] op_sel_hi:[1,0,1]
    v_max_f32 v192, 0, v192
    v_max_f32 v193, 0, v193
    v_max_f32 v194, 0, v194
    v_max_f32 v195, 0, v195
    v_pk_mul_f32 v[192:193], v[192:193], v[224:225]
    v_pk_mul_f32 v[194:195], v[194:195], v[226:227]
    v_cvt_pk_bf16_f32 v98, v192, v193
    v_cvt_pk_bf16_f32 v99, v194, v195
    global_store_dwordx4 v9, v[96:99], s[14:15] offset:0 sc1
    v_pk_fma_f32 v[112:113], v[64:65], v[34:35], v[68:69] op_sel:[0,1,0] op_sel_hi:[1,1,1]
    v_pk_fma_f32 v[116:117], v[72:73], v[34:35], v[76:77] op_sel:[0,1,0] op_sel_hi:[1,1,1]
    v_pk_fma_f32 v[114:115], v[66:67], v[34:35], v[70:71] op_sel:[0,1,0] op_sel_hi:[1,1,1]
    v_pk_fma_f32 v[118:119], v[74:75], v[34:35], v[78:79] op_sel:[0,1,0] op_sel_hi:[1,1,1]
    v_pk_fma_f32 v[132:133], v[132:133], v[34:35], v[112:113] op_sel_hi:[1,0,1]
    v_pk_fma_f32 v[164:165], v[164:165], v[34:35], v[116:117] op_sel_hi:[1,0,1]
    v_pk_fma_f32 v[134:135], v[134:135], v[34:35], v[114:115] op_sel_hi:[1,0,1]
    v_pk_fma_f32 v[166:167], v[166:167], v[34:35], v[118:119] op_sel_hi:[1,0,1]
    v_max_f32 v132, 0, v132
    v_max_f32 v133, 0, v133
    v_max_f32 v134, 0, v134
    v_max_f32 v135, 0, v135
    v_pk_mul_f32 v[132:133], v[132:133], v[164:165]
    v_pk_mul_f32 v[134:135], v[134:135], v[166:167]
    v_cvt_pk_bf16_f32 v100, v132, v133
    v_cvt_pk_bf16_f32 v101, v134, v135
    v_pk_fma_f32 v[120:121], v[80:81], v[34:35], v[84:85] op_sel:[0,1,0] op_sel_hi:[1,1,1]
    v_pk_fma_f32 v[124:125], v[88:89], v[34:35], v[92:93] op_sel:[0,1,0] op_sel_hi:[1,1,1]
    v_pk_fma_f32 v[122:123], v[82:83], v[34:35], v[86:87] op_sel:[0,1,0] op_sel_hi:[1,1,1]
    v_pk_fma_f32 v[126:127], v[90:91], v[34:35], v[94:95] op_sel:[0,1,0] op_sel_hi:[1,1,1]
    v_pk_fma_f32 v[196:197], v[196:197], v[34:35], v[120:121] op_sel_hi:[1,0,1]
    v_pk_fma_f32 v[228:229], v[228:229], v[34:35], v[124:125] op_sel_hi:[1,0,1]
    v_pk_fma_f32 v[198:199], v[198:199], v[34:35], v[122:123] op_sel_hi:[1,0,1]
    v_pk_fma_f32 v[230:231], v[230:231], v[34:35], v[126:127] op_sel_hi:[1,0,1]
    v_max_f32 v196, 0, v196
    v_max_f32 v197, 0, v197
    v_max_f32 v198, 0, v198
    v_max_f32 v199, 0, v199
    v_pk_mul_f32 v[196:197], v[196:197], v[228:229]
    v_pk_mul_f32 v[198:199], v[198:199], v[230:231]
    v_cvt_pk_bf16_f32 v102, v196, v197
    v_cvt_pk_bf16_f32 v103, v198, v199
    global_store_dwordx4 v9, v[100:103], s[14:15] offset:1024 sc1
    v_pk_fma_f32 v[112:113], v[64:65], v[36:37], v[68:69] op_sel:[0,1,0] op_sel_hi:[1,1,1]
    v_pk_fma_f32 v[116:117], v[72:73], v[36:37], v[76:77] op_sel:[0,1,0] op_sel_hi:[1,1,1]
    v_pk_fma_f32 v[114:115], v[66:67], v[36:37], v[70:71] op_sel:[0,1,0] op_sel_hi:[1,1,1]
    v_pk_fma_f32 v[118:119], v[74:75], v[36:37], v[78:79] op_sel:[0,1,0] op_sel_hi:[1,1,1]
    v_pk_fma_f32 v[136:137], v[136:137], v[36:37], v[112:113] op_sel_hi:[1,0,1]
    v_pk_fma_f32 v[168:169], v[168:169], v[36:37], v[116:117] op_sel_hi:[1,0,1]
    v_pk_fma_f32 v[138:139], v[138:139], v[36:37], v[114:115] op_sel_hi:[1,0,1]
    v_pk_fma_f32 v[170:171], v[170:171], v[36:37], v[118:119] op_sel_hi:[1,0,1]
    v_max_f32 v136, 0, v136
    v_max_f32 v137, 0, v137
    v_max_f32 v138, 0, v138
    v_max_f32 v139, 0, v139
    v_pk_mul_f32 v[136:137], v[136:137], v[168:169]
    v_pk_mul_f32 v[138:139], v[138:139], v[170:171]
    v_cvt_pk_bf16_f32 v104, v136, v137
    v_cvt_pk_bf16_f32 v105, v138, v139
    v_pk_fma_f32 v[120:121], v[80:81], v[36:37], v[84:85] op_sel:[0,1,0] op_sel_hi:[1,1,1]
    v_pk_fma_f32 v[124:125], v[88:89], v[36:37], v[92:93] op_sel:[0,1,0] op_sel_hi:[1,1,1]
    v_pk_fma_f32 v[122:123], v[82:83], v[36:37], v[86:87] op_sel:[0,1,0] op_sel_hi:[1,1,1]
    v_pk_fma_f32 v[126:127], v[90:91], v[36:37], v[94:95] op_sel:[0,1,0] op_sel_hi:[1,1,1]
    v_pk_fma_f32 v[200:201], v[200:201], v[36:37], v[120:121] op_sel_hi:[1,0,1]
    v_pk_fma_f32 v[232:233], v[232:233], v[36:37], v[124:125] op_sel_hi:[1,0,1]
    v_pk_fma_f32 v[202:203], v[202:203], v[36:37], v[122:123] op_sel_hi:[1,0,1]
    v_pk_fma_f32 v[234:235], v[234:235], v[36:37], v[126:127] op_sel_hi:[1,0,1]
    v_max_f32 v200, 0, v200
    v_max_f32 v201, 0, v201
    v_max_f32 v202, 0, v202
    v_max_f32 v203, 0, v203
    v_pk_mul_f32 v[200:201], v[200:201], v[232:233]
    v_pk_mul_f32 v[202:203], v[202:203], v[234:235]
    v_cvt_pk_bf16_f32 v106, v200, v201
    v_cvt_pk_bf16_f32 v107, v202, v203
    global_store_dwordx4 v9, v[104:107], s[14:15] offset:2048 sc1
    v_pk_fma_f32 v[112:113], v[64:65], v[38:39], v[68:69] op_sel:[0,1,0] op_sel_hi:[1,1,1]
    v_pk_fma_f32 v[116:117], v[72:73], v[38:39], v[76:77] op_sel:[0,1,0] op_sel_hi:[1,1,1]
    v_pk_fma_f32 v[114:115], v[66:67], v[38:39], v[70:71] op_sel:[0,1,0] op_sel_hi:[1,1,1]
    v_pk_fma_f32 v[118:119], v[74:75], v[38:39], v[78:79] op_sel:[0,1,0] op_sel_hi:[1,1,1]
    v_pk_fma_f32 v[140:141], v[140:141], v[38:39], v[112:113] op_sel_hi:[1,0,1]
    v_pk_fma_f32 v[172:173], v[172:173], v[38:39], v[116:117] op_sel_hi:[1,0,1]
    v_pk_fma_f32 v[142:143], v[142:143], v[38:39], v[114:115] op_sel_hi:[1,0,1]
    v_pk_fma_f32 v[174:175], v[174:175], v[38:39], v[118:119] op_sel_hi:[1,0,1]
    v_max_f32 v140, 0, v140
    v_max_f32 v141, 0, v141
    v_max_f32 v142, 0, v142
    v_max_f32 v143, 0, v143
    v_pk_mul_f32 v[140:141], v[140:141], v[172:173]
    v_pk_mul_f32 v[142:143], v[142:143], v[174:175]
    v_cvt_pk_bf16_f32 v108, v140, v141
    v_cvt_pk_bf16_f32 v109, v142, v143
    v_pk_fma_f32 v[120:121], v[80:81], v[38:39], v[84:85] op_sel:[0,1,0] op_sel_hi:[1,1,1]
    v_pk_fma_f32 v[124:125], v[88:89], v[38:39], v[92:93] op_sel:[0,1,0] op_sel_hi:[1,1,1]
    v_pk_fma_f32 v[122:123], v[82:83], v[38:39], v[86:87] op_sel:[0,1,0] op_sel_hi:[1,1,1]
    v_pk_fma_f32 v[126:127], v[90:91], v[38:39], v[94:95] op_sel:[0,1,0] op_sel_hi:[1,1,1]
    v_pk_fma_f32 v[204:205], v[204:205], v[38:39], v[120:121] op_sel_hi:[1,0,1]
    v_pk_fma_f32 v[236:237], v[236:237], v[38:39], v[124:125] op_sel_hi:[1,0,1]
    v_pk_fma_f32 v[206:207], v[206:207], v[38:39], v[122:123] op_sel_hi:[1,0,1]
    v_pk_fma_f32 v[238:239], v[238:239], v[38:39], v[126:127] op_sel_hi:[1,0,1]
    v_max_f32 v204, 0, v204
    v_max_f32 v205, 0, v205
    v_max_f32 v206, 0, v206
    v_max_f32 v207, 0, v207
    v_pk_mul_f32 v[204:205], v[204:205], v[236:237]
    v_pk_mul_f32 v[206:207], v[206:207], v[238:239]
    v_cvt_pk_bf16_f32 v110, v204, v205
    v_cvt_pk_bf16_f32 v111, v206, v207
    global_store_dwordx4 v9, v[108:111], s[14:15] offset:3072 sc1
    v_pk_fma_f32 v[112:113], v[64:65], v[40:41], v[68:69] op_sel:[0,1,0] op_sel_hi:[1,1,1]
    v_pk_fma_f32 v[116:117], v[72:73], v[40:41], v[76:77] op_sel:[0,1,0] op_sel_hi:[1,1,1]
    v_pk_fma_f32 v[114:115], v[66:67], v[40:41], v[70:71] op_sel:[0,1,0] op_sel_hi:[1,1,1]
    v_pk_fma_f32 v[118:119], v[74:75], v[40:41], v[78:79] op_sel:[0,1,0] op_sel_hi:[1,1,1]
    v_pk_fma_f32 v[144:145], v[144:145], v[40:41], v[112:113] op_sel_hi:[1,0,1]
    v_pk_fma_f32 v[176:177], v[176:177], v[40:41], v[116:117] op_sel_hi:[1,0,1]
    v_pk_fma_f32 v[146:147], v[146:147], v[40:41], v[114:115] op_sel_hi:[1,0,1]
    v_pk_fma_f32 v[178:179], v[178:179], v[40:41], v[118:119] op_sel_hi:[1,0,1]
    v_max_f32 v144, 0, v144
    v_max_f32 v145, 0, v145
    v_max_f32 v146, 0, v146
    v_max_f32 v147, 0, v147
    v_pk_mul_f32 v[144:145], v[144:145], v[176:177]
    v_pk_mul_f32 v[146:147], v[146:147], v[178:179]
    v_cvt_pk_bf16_f32 v96, v144, v145
    v_cvt_pk_bf16_f32 v97, v146, v147
    v_pk_fma_f32 v[120:121], v[80:81], v[40:41], v[84:85] op_sel:[0,1,0] op_sel_hi:[1,1,1]
    v_pk_fma_f32 v[124:125], v[88:89], v[40:41], v[92:93] op_sel:[0,1,0] op_sel_hi:[1,1,1]
    v_pk_fma_f32 v[122:123], v[82:83], v[40:41], v[86:87] op_sel:[0,1,0] op_sel_hi:[1,1,1]
    v_pk_fma_f32 v[126:127], v[90:91], v[40:41], v[94:95] op_sel:[0,1,0] op_sel_hi:[1,1,1]
    v_pk_fma_f32 v[208:209], v[208:209], v[40:41], v[120:121] op_sel_hi:[1,0,1]
    v_pk_fma_f32 v[240:241], v[240:241], v[40:41], v[124:125] op_sel_hi:[1,0,1]
    v_pk_fma_f32 v[210:211], v[210:211], v[40:41], v[122:123] op_sel_hi:[1,0,1]
    v_pk_fma_f32 v[242:243], v[242:243], v[40:41], v[126:127] op_sel_hi:[1,0,1]
    v_max_f32 v208, 0, v208
    v_max_f32 v209, 0, v209
    v_max_f32 v210, 0, v210
    v_max_f32 v211, 0, v211
    v_pk_mul_f32 v[208:209], v[208:209], v[240:241]
    v_pk_mul_f32 v[210:211], v[210:211], v[242:243]
    v_cvt_pk_bf16_f32 v98, v208, v209
    v_cvt_pk_bf16_f32 v99, v210, v211
    global_store_dwordx4 v9, v[96:99], s[28:29] offset:0 sc1
    v_pk_fma_f32 v[112:113], v[64:65], v[42:43], v[68:69] op_sel:[0,1,0] op_sel_hi:[1,1,1]
    v_pk_fma_f32 v[116:117], v[72:73], v[42:43], v[76:77] op_sel:[0,1,0] op_sel_hi:[1,1,1]
    v_pk_fma_f32 v[114:115], v[66:67], v[42:43], v[70:71] op_sel:[0,1,0] op_sel_hi:[1,1,1]
    v_pk_fma_f32 v[118:119], v[74:75], v[42:43], v[78:79] op_sel:[0,1,0] op_sel_hi:[1,1,1]
    v_pk_fma_f32 v[148:149], v[148:149], v[42:43], v[112:113] op_sel_hi:[1,0,1]
    v_pk_fma_f32 v[180:181], v[180:181], v[42:43], v[116:117] op_sel_hi:[1,0,1]
    v_pk_fma_f32 v[150:151], v[150:151], v[42:43], v[114:115] op_sel_hi:[1,0,1]
    v_pk_fma_f32 v[182:183], v[182:183], v[42:43], v[118:119] op_sel_hi:[1,0,1]
    v_max_f32 v148, 0, v148
    v_max_f32 v149, 0, v149
    v_max_f32 v150, 0, v150
    v_max_f32 v151, 0, v151
    v_pk_mul_f32 v[148:149], v[148:149], v[180:181]
    v_pk_mul_f32 v[150:151], v[150:151], v[182:183]
    v_cvt_pk_bf16_f32 v100, v148, v149
    v_cvt_pk_bf16_f32 v101, v150, v151
    v_pk_fma_f32 v[120:121], v[80:81], v[42:43], v[84:85] op_sel:[0,1,0] op_sel_hi:[1,1,1]
    v_pk_fma_f32 v[124:125], v[88:89], v[42:43], v[92:93] op_sel:[0,1,0] op_sel_hi:[1,1,1]
    v_pk_fma_f32 v[122:123], v[82:83], v[42:43], v[86:87] op_sel:[0,1,0] op_sel_hi:[1,1,1]
    v_pk_fma_f32 v[126:127], v[90:91], v[42:43], v[94:95] op_sel:[0,1,0] op_sel_hi:[1,1,1]
    v_pk_fma_f32 v[212:213], v[212:213], v[42:43], v[120:121] op_sel_hi:[1,0,1]
    v_pk_fma_f32 v[244:245], v[244:245], v[42:43], v[124:125] op_sel_hi:[1,0,1]
    v_pk_fma_f32 v[214:215], v[214:215], v[42:43], v[122:123] op_sel_hi:[1,0,1]
    v_pk_fma_f32 v[246:247], v[246:247], v[42:43], v[126:127] op_sel_hi:[1,0,1]
    v_max_f32 v212, 0, v212
    v_max_f32 v213, 0, v213
    v_max_f32 v214, 0, v214
    v_max_f32 v215, 0, v215
    v_pk_mul_f32 v[212:213], v[212:213], v[244:245]
    v_pk_mul_f32 v[214:215], v[214:215], v[246:247]
    v_cvt_pk_bf16_f32 v102, v212, v213
    v_cvt_pk_bf16_f32 v103, v214, v215
    global_store_dwordx4 v9, v[100:103], s[28:29] offset:1024 sc1
    v_pk_fma_f32 v[112:113], v[64:65], v[44:45], v[68:69] op_sel:[0,1,0] op_sel_hi:[1,1,1]
    v_pk_fma_f32 v[116:117], v[72:73], v[44:45], v[76:77] op_sel:[0,1,0] op_sel_hi:[1,1,1]
    v_pk_fma_f32 v[114:115], v[66:67], v[44:45], v[70:71] op_sel:[0,1,0] op_sel_hi:[1,1,1]
    v_pk_fma_f32 v[118:119], v[74:75], v[44:45], v[78:79] op_sel:[0,1,0] op_sel_hi:[1,1,1]
    v_pk_fma_f32 v[152:153], v[152:153], v[44:45], v[112:113] op_sel_hi:[1,0,1]
    v_pk_fma_f32 v[184:185], v[184:185], v[44:45], v[116:117] op_sel_hi:[1,0,1]
    v_pk_fma_f32 v[154:155], v[154:155], v[44:45], v[114:115] op_sel_hi:[1,0,1]
    v_pk_fma_f32 v[186:187], v[186:187], v[44:45], v[118:119] op_sel_hi:[1,0,1]
    v_max_f32 v152, 0, v152
    v_max_f32 v153, 0, v153
    v_max_f32 v154, 0, v154
    v_max_f32 v155, 0, v155
    v_pk_mul_f32 v[152:153], v[152:153], v[184:185]
    v_pk_mul_f32 v[154:155], v[154:155], v[186:187]
    v_cvt_pk_bf16_f32 v104, v152, v153
    v_cvt_pk_bf16_f32 v105, v154, v155
    v_pk_fma_f32 v[120:121], v[80:81], v[44:45], v[84:85] op_sel:[0,1,0] op_sel_hi:[1,1,1]
    v_pk_fma_f32 v[124:125], v[88:89], v[44:45], v[92:93] op_sel:[0,1,0] op_sel_hi:[1,1,1]
    v_pk_fma_f32 v[122:123], v[82:83], v[44:45], v[86:87] op_sel:[0,1,0] op_sel_hi:[1,1,1]
    v_pk_fma_f32 v[126:127], v[90:91], v[44:45], v[94:95] op_sel:[0,1,0] op_sel_hi:[1,1,1]
    v_pk_fma_f32 v[216:217], v[216:217], v[44:45], v[120:121] op_sel_hi:[1,0,1]
    v_pk_fma_f32 v[248:249], v[248:249], v[44:45], v[124:125] op_sel_hi:[1,0,1]
    v_pk_fma_f32 v[218:219], v[218:219], v[44:45], v[122:123] op_sel_hi:[1,0,1]
    v_pk_fma_f32 v[250:251], v[250:251], v[44:45], v[126:127] op_sel_hi:[1,0,1]
    v_max_f32 v216, 0, v216
    v_max_f32 v217, 0, v217
    v_max_f32 v218, 0, v218
    v_max_f32 v219, 0, v219
    v_pk_mul_f32 v[216:217], v[216:217], v[248:249]
    v_pk_mul_f32 v[218:219], v[218:219], v[250:251]
    v_cvt_pk_bf16_f32 v106, v216, v217
    v_cvt_pk_bf16_f32 v107, v218, v219
    global_store_dwordx4 v9, v[104:107], s[28:29] offset:2048 sc1
    v_pk_fma_f32 v[112:113], v[64:65], v[46:47], v[68:69] op_sel:[0,1,0] op_sel_hi:[1,1,1]
    v_pk_fma_f32 v[116:117], v[72:73], v[46:47], v[76:77] op_sel:[0,1,0] op_sel_hi:[1,1,1]
    v_pk_fma_f32 v[114:115], v[66:67], v[46:47], v[70:71] op_sel:[0,1,0] op_sel_hi:[1,1,1]
    v_pk_fma_f32 v[118:119], v[74:75], v[46:47], v[78:79] op_sel:[0,1,0] op_sel_hi:[1,1,1]
    v_pk_fma_f32 v[156:157], v[156:157], v[46:47], v[112:113] op_sel_hi:[1,0,1]
    v_pk_fma_f32 v[188:189], v[188:189], v[46:47], v[116:117] op_sel_hi:[1,0,1]
    v_pk_fma_f32 v[158:159], v[158:159], v[46:47], v[114:115] op_sel_hi:[1,0,1]
    v_pk_fma_f32 v[190:191], v[190:191], v[46:47], v[118:119] op_sel_hi:[1,0,1]
    v_max_f32 v156, 0, v156
    v_max_f32 v157, 0, v157
    v_max_f32 v158, 0, v158
    v_max_f32 v159, 0, v159
    v_pk_mul_f32 v[156:157], v[156:157], v[188:189]
    v_pk_mul_f32 v[158:159], v[158:159], v[190:191]
    v_cvt_pk_bf16_f32 v108, v156, v157
    v_cvt_pk_bf16_f32 v109, v158, v159
    v_pk_fma_f32 v[120:121], v[80:81], v[46:47], v[84:85] op_sel:[0,1,0] op_sel_hi:[1,1,1]
    v_pk_fma_f32 v[124:125], v[88:89], v[46:47], v[92:93] op_sel:[0,1,0] op_sel_hi:[1,1,1]
    v_pk_fma_f32 v[122:123], v[82:83], v[46:47], v[86:87] op_sel:[0,1,0] op_sel_hi:[1,1,1]
    v_pk_fma_f32 v[126:127], v[90:91], v[46:47], v[94:95] op_sel:[0,1,0] op_sel_hi:[1,1,1]
    v_pk_fma_f32 v[220:221], v[220:221], v[46:47], v[120:121] op_sel_hi:[1,0,1]
    v_pk_fma_f32 v[252:253], v[252:253], v[46:47], v[124:125] op_sel_hi:[1,0,1]
    v_pk_fma_f32 v[222:223], v[222:223], v[46:47], v[122:123] op_sel_hi:[1,0,1]
    v_pk_fma_f32 v[254:255], v[254:255], v[46:47], v[126:127] op_sel_hi:[1,0,1]
    v_max_f32 v220, 0, v220
    v_max_f32 v221, 0, v221
    v_max_f32 v222, 0, v222
    v_max_f32 v223, 0, v223
    v_pk_mul_f32 v[220:221], v[220:221], v[252:253]
    v_pk_mul_f32 v[222:223], v[222:223], v[254:255]
    v_cvt_pk_bf16_f32 v110, v220, v221
    v_cvt_pk_bf16_f32 v111, v222, v223
    global_store_dwordx4 v9, v[108:111], s[28:29] offset:3072 sc1
    s_branch g2_42
g1_idle:
    s_lshr_b32 s4, s2, 3
    s_bfe_u32 s44, s2, 0x20001
    s_lshl_b32 s44, s44, 3
    s_lshr_b32 s45, s4, 2
    s_add_u32 s44, s44, s45
    s_and_b32 s45, s2, 1
    s_lshl_b32 s45, s45, 2
    s_and_b32 s9, s4, 3
    s_add_u32 s45, s45, s9
    s_mul_i32 s9, s45, 5120
    s_add_u32 s10, s9, 11550720
    v_lshlrev_b32 v9, 4, v0
    v_add_u32 v8, 4096, v9
    s_add_u32 s14, s12, s10
    s_addc_u32 s15, s13, 0
    s_mov_b32 s40, s14
    s_and_b32 s41, s15, 0xffff
    s_mov_b32 s42, 0
    s_mov_b32 s43, 0x20000
    s_sub_u32 s42, 2211840, s9
    s_mul_i32 s46, s3, 40960
    s_mov_b32 s74, 0x100000
f2_slow_55:
    v_cmp_ne_u64 vcc, s[70:71], v[236:237]
    s_cbranch_vccz f2_ok_54
    s_sleep 4
f2_ld_56:
    s_mov_b64 exec, 1
    global_load_dwordx2 v[236:237], v240, s[12:13] sc1
    s_mov_b64 exec, -1
    s_waitcnt vmcnt(0)
    s_sub_u32 s74, s74, 1
    s_cbranch_scc0 f2_slow_55
f2_ok_54:
    s_add_u32 s47, s46, 0
    buffer_load_dwordx4 a[0:3], v9, s[40:43], s47 offen offset:0 sc1
    s_add_u32 s47, s46, 0
    buffer_load_dwordx4 a[4:7], v9, s[40:43], s47 offen offset:1024 sc1
    s_add_u32 s47, s46, 0
    buffer_load_dwordx4 a[8:11], v9, s[40:43], s47 offen offset:2048 sc1
    s_add_u32 s47, s46, 0
    buffer_load_dwordx4 a[12:15], v9, s[40:43], s47 offen offset:3072 sc1
    s_add_u32 s47, s46, 0
    buffer_load_dwordx4 a[16:19], v8, s[40:43], s47 offen offset:0 sc1
    s_add_u32 s47, s46, 163840
    buffer_load_dwordx4 a[20:23], v9, s[40:43], s47 offen offset:0 sc1
    s_add_u32 s47, s46, 163840
    buffer_load_dwordx4 a[24:27], v9, s[40:43], s47 offen offset:1024 sc1
    s_add_u32 s47, s46, 163840
    buffer_load_dwordx4 a[28:31], v9, s[40:43], s47 offen offset:2048 sc1
    s_add_u32 s47, s46, 163840
    buffer_load_dwordx4 a[32:35], v9, s[40:43], s47 offen offset:3072 sc1
    s_add_u32 s47, s46, 163840
    buffer_load_dwordx4 a[36:39], v8, s[40:43], s47 offen offset:0 sc1
    s_add_u32 s47, s46, 327680
    buffer_load_dwordx4 a[40:43], v9, s[40:43], s47 offen offset:0 sc1
    s_add_u32 s47, s46, 327680
    buffer_load_dwordx4 a[44:47], v9, s[40:43], s47 offen offset:1024 sc1
    s_add_u32 s47, s46, 327680
    buffer_load_dwordx4 a[48:51], v9, s[40:43], s47 offen offset:2048 sc1
    s_add_u32 s47, s46, 327680
    buffer_load_dwordx4 a[52:55], v9, s[40:43], s47 offen offset:3072 sc1
    s_add_u32 s47, s46, 327680
    buffer_load_dwordx4 a[56:59], v8, s[40:43], s47 offen offset:0 sc1
    s_add_u32 s47, s46, 491520
    buffer_load_dwordx4 a[60:63], v9, s[40:43], s47 offen offset:0 sc1
    s_add_u32 s47, s46, 491520
    buffer_load_dwordx4 a[64:67], v9, s[40:43], s47 offen offset:1024 sc1
    s_add_u32 s47, s46, 491520
    buffer_load_dwordx4 a[68:71], v9, s[40:43], s47 offen offset:2048 sc1
    s_add_u32 s47, s46, 491520
    buffer_load_dwordx4 a[72:75], v9, s[40:43], s47 offen offset:3072 sc1
    s_add_u32 s47, s46, 491520
    buffer_load_dwordx4 a[76:79], v8, s[40:43], s47 offen offset:0 sc1
    s_add_u32 s47, s46, 655360
    buffer_load_dwordx4 a[80:83], v9, s[40:43], s47 offen offset:0 sc1
    s_add_u32 s47, s46, 655360
    buffer_load_dwordx4 a[84:87], v9, s[40:43], s47 offen offset:1024 sc1
    s_add_u32 s47, s46, 655360
    buffer_load_dwordx4 a[88:91], v9, s[40:43], s47 offen offset:2048 sc1
    s_add_u32 s47, s46, 655360
    buffer_load_dwordx4 a[92:95], v9, s[40:43], s47 offen offset:3072 sc1
    s_add_u32 s47, s46, 655360
    buffer_load_dwordx4 a[96:99], v8, s[40:43], s47 offen offset:0 sc1
    s_add_u32 s47, s46, 819200
    buffer_load_dwordx4 a[100:103], v9, s[40:43], s47 offen offset:0 sc1
    s_add_u32 s47, s46, 819200
    buffer_load_dwordx4 a[104:107], v9, s[40:43], s47 offen offset:1024 sc1
    s_add_u32 s47, s46, 819200
    buffer_load_dwordx4 a[108:111], v9, s[40:43], s47 offen offset:2048 sc1
    s_add_u32 s47, s46, 819200
    buffer_load_dwordx4 a[112:115], v9, s[40:43], s47 offen offset:3072 sc1
    s_add_u32 s47, s46, 819200
    buffer_load_dwordx4 a[116:119], v8, s[40:43], s47 offen offset:0 sc1
    s_add_u32 s47, s46, 983040
    buffer_load_dwordx4 a[120:123], v9, s[40:43], s47 offen offset:0 sc1
    s_add_u32 s47, s46, 983040
    buffer_load_dwordx4 a[124:127], v9, s[40:43], s47 offen offset:1024 sc1
    s_add_u32 s47, s46, 983040
    buffer_load_dwordx4 a[128:131], v9, s[40:43], s47 offen offset:2048 sc1
    s_add_u32 s47, s46, 983040
    buffer_load_dwordx4 a[132:135], v9, s[40:43], s47 offen offset:3072 sc1
    s_add_u32 s47, s46, 983040
    buffer_load_dwordx4 a[136:139], v8, s[40:43], s47 offen offset:0 sc1
    s_add_u32 s47, s46, 1146880
    buffer_load_dwordx4 a[140:143], v9, s[40:43], s47 offen offset:0 sc1
    s_add_u32 s47, s46, 1146880
    buffer_load_dwordx4 a[144:147], v9, s[40:43], s47 offen offset:1024 sc1
    s_add_u32 s47, s46, 1146880
    buffer_load_dwordx4 a[148:151], v9, s[40:43], s47 offen offset:2048 sc1
    s_add_u32 s47, s46, 1146880
    buffer_load_dwordx4 a[152:155], v9, s[40:43], s47 offen offset:3072 sc1
    s_add_u32 s47, s46, 1146880
    buffer_load_dwordx4 a[156:159], v8, s[40:43], s47 offen offset:0 sc1
    s_add_u32 s47, s46, 1310720
    buffer_load_dwordx4 a[160:163], v9, s[40:43], s47 offen offset:0 sc1
    s_add_u32 s47, s46, 1310720
    buffer_load_dwordx4 a[164:167], v9, s[40:43], s47 offen offset:1024 sc1
    s_add_u32 s47, s46, 1310720
    buffer_load_dwordx4 a[168:171], v9, s[40:43], s47 offen offset:2048 sc1
    s_add_u32 s47, s46, 1310720
    buffer_load_dwordx4 a[172:175], v9, s[40:43], s47 offen offset:3072 sc1
    s_add_u32 s47, s46, 1310720
    buffer_load_dwordx4 a[176:179], v8, s[40:43], s47 offen offset:0 sc1
    s_add_u32 s47, s46, 1474560
    buffer_load_dwordx4 a[180:183], v9, s[40:43], s47 offen offset:0 sc1
    s_add_u32 s47, s46, 1474560
    buffer_load_dwordx4 a[184:187], v9, s[40:43], s47 offen offset:1024 sc1
    s_add_u32 s47, s46, 1474560
    buffer_load_dwordx4 a[188:191], v9, s[40:43], s47 offen offset:2048 sc1
    s_add_u32 s47, s46, 1474560
    buffer_load_dwordx4 a[192:195], v9, s[40:43], s47 offen offset:3072 sc1
    s_add_u32 s47, s46, 1474560
    buffer_load_dwordx4 a[196:199], v8, s[40:43], s47 offen offset:0 sc1
    s_add_u32 s47, s46, 1638400
    buffer_load_dwordx4 a[200:203], v9, s[40:43], s47 offen offset:0 sc1
    s_waitcnt vmcnt(30)
    s_add_u32 s47, s46, 1638400
    buffer_load_dwordx4 a[204:207], v9, s[40:43], s47 offen offset:1024 sc1
    s_add_u32 s47, s46, 1638400
    buffer_load_dwordx4 a[208:211], v9, s[40:43], s47 offen offset:2048 sc1
    s_add_u32 s47, s46, 1638400
    buffer_load_dwordx4 a[212:215], v9, s[40:43], s47 offen offset:3072 sc1
    s_add_u32 s47, s46, 1638400
    buffer_load_dwordx4 a[216:219], v8, s[40:43], s47 offen offset:0 sc1
    s_add_u32 s47, s46, 1802240
    buffer_load_dwordx4 a[220:223], v9, s[40:43], s47 offen offset:0 sc1
    s_add_u32 s47, s46, 1802240
    buffer_load_dwordx4 a[224:227], v9, s[40:43], s47 offen offset:1024 sc1
    s_add_u32 s47, s46, 1802240
    buffer_load_dwordx4 a[228:231], v9, s[40:43], s47 offen offset:2048 sc1
    s_add_u32 s47, s46, 1802240
    buffer_load_dwordx4 a[232:235], v9, s[40:43], s47 offen offset:3072 sc1
    s_add_u32 s47, s46, 1802240
    buffer_load_dwordx4 a[236:239], v8, s[40:43], s47 offen offset:0 sc1
    s_add_u32 s47, s46, 1966080
    buffer_load_dwordx4 a[240:243], v9, s[40:43], s47 offen offset:0 sc1
    s_add_u32 s47, s46, 1966080
    buffer_load_dwordx4 a[244:247], v9, s[40:43], s47 offen offset:1024 sc1
    s_sub_u32 s8, s2, 216
    s_mul_i32 s9, s3, 40
    s_add_u32 s9, s9, 1024
    v_add_u32 v55, s9, v0
    v_cmp_gt_u32 vcc, 40, v0
    v_add_u32 v56, 458, v0
    s_nop 0
    v_cndmask_b32 v55, v56, v55, vcc
    v_lshlrev_b32 v54, 7, v55
    v_add_u32 v54, 0, v54
    s_mov_b32 s74, 0x100000
    s_mov_b32 exec_hi, 0x3ffff
poll_58:
    global_load_dwordx2 v[52:53], v54, s[12:13] sc1
    s_waitcnt vmcnt(0)
    v_cmp_ne_u64 vcc, s[70:71], v[52:53]
    s_and_b64 exec, exec, vcc
    s_cbranch_execz polld_59
    s_sleep 1
    s_sub_u32 s74, s74, 1
    s_cbranch_scc0 poll_58
polld_59:
    s_mov_b64 exec, -1
    s_barrier
    s_cmp_ge_u32 s8, 32
    s_cbranch_scc1 idle_rest_57
    v_lshrrev_b32 v2, 3, v0
    v_lshlrev_b32 v2, 12, v2
    v_and_b32 v3, 7, v0
    v_lshl_add_u32 v2, v3, 4, v2
    s_lshl_b32 s9, s3, 15
    s_lshl_b32 s10, s8, 7
    s_add_u32 s9, s9, s10
    s_add_u32 s9, s9, 6262784
    s_add_u32 s14, s12, s9
    s_addc_u32 s15, s13, 0
    global_load_dwordx4 v[100:103], v2, s[14:15] sc1
    s_add_u32 s14, s14, 131072
    s_addc_u32 s15, s15, 0
    global_load_dwordx4 v[104:107], v2, s[14:15] sc1
    s_add_u32 s14, s14, 131072
    s_addc_u32 s15, s15, 0
    global_load_dwordx4 v[108:111], v2, s[14:15] sc1
    s_add_u32 s14, s14, 131072
    s_addc_u32 s15, s15, 0
    global_load_dwordx4 v[112:115], v2, s[14:15] sc1
    s_add_u32 s14, s14, 131072
    s_addc_u32 s15, s15, 0
    global_load_dwordx4 v[116:119], v2, s[14:15] sc1
    s_add_u32 s14, s14, 131072
    s_addc_u32 s15, s15, 0
    global_load_dwordx4 v[120:123], v2, s[14:15] sc1
    s_add_u32 s14, s14, 131072
    s_addc_u32 s15, s15, 0
    global_load_dwordx4 v[124:127], v2, s[14:15] sc1
    s_add_u32 s14, s14, 131072
    s_addc_u32 s15, s15, 0
    global_load_dwordx4 v[128:131], v2, s[14:15] sc1
    s_add_u32 s14, s14, 131072
    s_addc_u32 s15, s15, 0
    global_load_dwordx4 v[132:135], v2, s[14:15] sc1
    s_add_u32 s14, s14, 131072
    s_addc_u32 s15, s15, 0
    global_load_dwordx4 v[136:139], v2, s[14:15] sc1
    s_add_u32 s14, s14, 131072
    s_addc_u32 s15, s15, 0
    global_load_dwordx4 v[140:143], v2, s[14:15] sc1
    s_add_u32 s14, s14, 131072
    s_addc_u32 s15, s15, 0
    global_load_dwordx4 v[144:147], v2, s[14:15] sc1
    s_add_u32 s14, s14, 131072
    s_addc_u32 s15, s15, 0
    global_load_dwordx4 v[148:151], v2, s[14:15] sc1
    s_add_u32 s14, s14, 131072
    s_addc_u32 s15, s15, 0
    global_load_dwordx4 v[152:155], v2, s[14:15] sc1
    s_add_u32 s14, s14, 131072
    s_addc_u32 s15, s15, 0
    global_load_dwordx4 v[156:159], v2, s[14:15] sc1
    s_add_u32 s14, s14, 131072
    s_addc_u32 s15, s15, 0
    global_load_dwordx4 v[160:163], v2, s[14:15] sc1
    s_add_u32 s14, s14, 131072
    s_addc_u32 s15, s15, 0
    global_load_dwordx4 v[164:167], v2, s[14:15] sc1
    s_add_u32 s14, s14, 131072
    s_addc_u32 s15, s15, 0
    global_load_dwordx4 v[168:171], v2, s[14:15] sc1
    s_add_u32 s14, s14, 131072
    s_addc_u32 s15, s15, 0
    global_load_dwordx4 v[172:175], v2, s[14:15] sc1
    s_add_u32 s14, s14, 131072
    s_addc_u32 s15, s15, 0
    global_load_dwordx4 v[176:179], v2, s[14:15] sc1
    s_waitcnt vmcnt(19)
    v_lshlrev_b32 v16, 16, v100
    v_and_b32 v17, s69, v100
    v_lshlrev_b32 v18, 16, v101
    v_and_b32 v19, s69, v101
    v_lshlrev_b32 v20, 16, v102
    v_and_b32 v21, s69, v102
    v_lshlrev_b32 v22, 16, v103
    v_and_b32 v23, s69, v103
    v_pk_mul_f32 v[24:25], v[16:17], v[16:17]
    v_pk_mul_f32 v[26:27], v[18:19], v[18:19]
    v_pk_mul_f32 v[28:29], v[20:21], v[20:21]
    v_pk_mul_f32 v[30:31], v[22:23], v[22:23]
    s_waitcnt vmcnt(18)
    v_lshlrev_b32 v40, 16, v104
    v_and_b32 v41, s69, v104
    v_lshlrev_b32 v42, 16, v105
    v_and_b32 v43, s69, v105
    v_lshlrev_b32 v44, 16, v106
    v_and_b32 v45, s69, v106
    v_lshlrev_b32 v46, 16, v107
    v_and_b32 v47, s69, v107
    v_pk_add_f32 v[16:17], v[16:17], v[40:41]
    v_pk_fma_f32 v[24:25], v[40:41], v[40:41], v[24:25]
    v_pk_add_f32 v[18:19], v[18:19], v[42:43]
    v_pk_fma_f32 v[26:27], v[42:43], v[42:43], v[26:27]
    v_pk_add_f32 v[20:21], v[20:21], v[44:45]
    v_pk_fma_f32 v[28:29], v[44:45], v[44:45], v[28:29]
    v_pk_add_f32 v[22:23], v[22:23], v[46:47]
    v_pk_fma_f32 v[30:31], v[46:47], v[46:47], v[30:31]
    s_waitcnt vmcnt(17)
    v_lshlrev_b32 v32, 16, v108
    v_and_b32 v33, s69, v108
    v_lshlrev_b32 v34, 16, v109
    v_and_b32 v35, s69, v109
    v_lshlrev_b32 v36, 16, v110
    v_and_b32 v37, s69, v110
    v_lshlrev_b32 v38, 16, v111
    v_and_b32 v39, s69, v111
    v_pk_add_f32 v[16:17], v[16:17], v[32:33]
    v_pk_fma_f32 v[24:25], v[32:33], v[32:33], v[24:25]
    v_pk_add_f32 v[18:19], v[18:19], v[34:35]
    v_pk_fma_f32 v[26:27], v[34:35], v[34:35], v[26:27]
    v_pk_add_f32 v[20:21], v[20:21], v[36:37]
    v_pk_fma_f32 v[28:29], v[36:37], v[36:37], v[28:29]
    v_pk_add_f32 v[22:23], v[22:23], v[38:39]
    v_pk_fma_f32 v[30:31], v[38:39], v[38:39], v[30:31]
    s_waitcnt vmcnt(16)
    v_lshlrev_b32 v40, 16, v112
    v_and_b32 v41, s69, v112
    v_lshlrev_b32 v42, 16, v113
    v_and_b32 v43, s69, v113
    v_lshlrev_b32 v44, 16, v114
    v_and_b32 v45, s69, v114
    v_lshlrev_b32 v46, 16, v115
    v_and_b32 v47, s69, v115
    v_pk_add_f32 v[16:17], v[16:17], v[40:41]
    v_pk_fma_f32 v[24:25], v[40:41], v[40:41], v[24:25]
    v_pk_add_f32 v[18:19], v[18:19], v[42:43]
    v_pk_fma_f32 v[26:27], v[42:43], v[42:43], v[26:27]
    v_pk_add_f32 v[20:21], v[20:21], v[44:45]
    v_pk_fma_f32 v[28:29], v[44:45], v[44:45], v[28:29]
    v_pk_add_f32 v[22:23], v[22:23], v[46:47]
    v_pk_fma_f32 v[30:31], v[46:47], v[46:47], v[30:31]
    s_waitcnt vmcnt(15)
    v_lshlrev_b32 v32, 16, v116
    v_and_b32 v33, s69, v116
    v_lshlrev_b32 v34, 16, v117
    v_and_b32 v35, s69, v117
    v_lshlrev_b32 v36, 16, v118
    v_and_b32 v37, s69, v118
    v_lshlrev_b32 v38, 16, v119
    v_and_b32 v39, s69, v119
    v_pk_add_f32 v[16:17], v[16:17], v[32:33]
    v_pk_fma_f32 v[24:25], v[32:33], v[32:33], v[24:25]
    v_pk_add_f32 v[18:19], v[18:19], v[34:35]
    v_pk_fma_f32 v[26:27], v[34:35], v[34:35], v[26:27]
    v_pk_add_f32 v[20:21], v[20:21], v[36:37]
    v_pk_fma_f32 v[28:29], v[36:37], v[36:37], v[28:29]
    v_pk_add_f32 v[22:23], v[22:23], v[38:39]
    v_pk_fma_f32 v[30:31], v[38:39], v[38:39], v[30:31]
    s_waitcnt vmcnt(14)
    v_lshlrev_b32 v40, 16, v120
    v_and_b32 v41, s69, v120
    v_lshlrev_b32 v42, 16, v121
    v_and_b32 v43, s69, v121
    v_lshlrev_b32 v44, 16, v122
    v_and_b32 v45, s69, v122
    v_lshlrev_b32 v46, 16, v123
    v_and_b32 v47, s69, v123
    v_pk_add_f32 v[16:17], v[16:17], v[40:41]
    v_pk_fma_f32 v[24:25], v[40:41], v[40:41], v[24:25]
    v_pk_add_f32 v[18:19], v[18:19], v[42:43]
    v_pk_fma_f32 v[26:27], v[42:43], v[42:43], v[26:27]
    v_pk_add_f32 v[20:21], v[20:21], v[44:45]
    v_pk_fma_f32 v[28:29], v[44:45], v[44:45], v[28:29]
    v_pk_add_f32 v[22:23], v[22:23], v[46:47]
    v_pk_fma_f32 v[30:31], v[46:47], v[46:47], v[30:31]
    s_waitcnt vmcnt(13)
    v_lshlrev_b32 v32, 16, v124
    v_and_b32 v33, s69, v124
    v_lshlrev_b32 v34, 16, v125
    v_and_b32 v35, s69, v125
    v_lshlrev_b32 v36, 16, v126
    v_and_b32 v37, s69, v126
    v_lshlrev_b32 v38, 16, v127
    v_and_b32 v39, s69, v127
    v_pk_add_f32 v[16:17], v[16:17], v[32:33]
    v_pk_fma_f32 v[24:25], v[32:33], v[32:33], v[24:25]
    v_pk_add_f32 v[18:19], v[18:19], v[34:35]
    v_pk_fma_f32 v[26:27], v[34:35], v[34:35], v[26:27]
    v_pk_add_f32 v[20:21], v[20:21], v[36:37]
    v_pk_fma_f32 v[28:29], v[36:37], v[36:37], v[28:29]
    v_pk_add_f32 v[22:23], v[22:23], v[38:39]
    v_pk_fma_f32 v[30:31], v[38:39], v[38:39], v[30:31]
    s_waitcnt vmcnt(12)
    v_lshlrev_b32 v40, 16, v128
    v_and_b32 v41, s69, v128
    v_lshlrev_b32 v42, 16, v129
    v_and_b32 v43, s69, v129
    v_lshlrev_b32 v44, 16, v130
    v_and_b32 v45, s69, v130
    v_lshlrev_b32 v46, 16, v131
    v_and_b32 v47, s69, v131
    v_pk_add_f32 v[16:17], v[16:17], v[40:41]
    v_pk_fma_f32 v[24:25], v[40:41], v[40:41], v[24:25]
    v_pk_add_f32 v[18:19], v[18:19], v[42:43]
    v_pk_fma_f32 v[26:27], v[42:43], v[42:43], v[26:27]
    v_pk_add_f32 v[20:21], v[20:21], v[44:45]
    v_pk_fma_f32 v[28:29], v[44:45], v[44:45], v[28:29]
    v_pk_add_f32 v[22:23], v[22:23], v[46:47]
    v_pk_fma_f32 v[30:31], v[46:47], v[46:47], v[30:31]
    s_waitcnt vmcnt(11)
    v_lshlrev_b32 v32, 16, v132
    v_and_b32 v33, s69, v132
    v_lshlrev_b32 v34, 16, v133
    v_and_b32 v35, s69, v133
    v_lshlrev_b32 v36, 16, v134
    v_and_b32 v37, s69, v134
    v_lshlrev_b32 v38, 16, v135
    v_and_b32 v39, s69, v135
    v_pk_add_f32 v[16:17], v[16:17], v[32:33]
    v_pk_fma_f32 v[24:25], v[32:33], v[32:33], v[24:25]
    v_pk_add_f32 v[18:19], v[18:19], v[34:35]
    v_pk_fma_f32 v[26:27], v[34:35], v[34:35], v[26:27]
    v_pk_add_f32 v[20:21], v[20:21], v[36:37]
    v_pk_fma_f32 v[28:29], v[36:37], v[36:37], v[28:29]
    v_pk_add_f32 v[22:23], v[22:23], v[38:39]
    v_pk_fma_f32 v[30:31], v[38:39], v[38:39], v[30:31]
    s_waitcnt vmcnt(10)
    v_lshlrev_b32 v40, 16, v136
    v_and_b32 v41, s69, v136
    v_lshlrev_b32 v42, 16, v137
    v_and_b32 v43, s69, v137
    v_lshlrev_b32 v44, 16, v138
    v_and_b32 v45, s69, v138
    v_lshlrev_b32 v46, 16, v139
    v_and_b32 v47, s69, v139
    v_pk_add_f32 v[16:17], v[16:17], v[40:41]
    v_pk_fma_f32 v[24:25], v[40:41], v[40:41], v[24:25]
    v_pk_add_f32 v[18:19], v[18:19], v[42:43]
    v_pk_fma_f32 v[26:27], v[42:43], v[42:43], v[26:27]
    v_pk_add_f32 v[20:21], v[20:21], v[44:45]
    v_pk_fma_f32 v[28:29], v[44:45], v[44:45], v[28:29]
    v_pk_add_f32 v[22:23], v[22:23], v[46:47]
    v_pk_fma_f32 v[30:31], v[46:47], v[46:47], v[30:31]
    s_waitcnt vmcnt(9)
    v_lshlrev_b32 v32, 16, v140
    v_and_b32 v33, s69, v140
    v_lshlrev_b32 v34, 16, v141
    v_and_b32 v35, s69, v141
    v_lshlrev_b32 v36, 16, v142
    v_and_b32 v37, s69, v142
    v_lshlrev_b32 v38, 16, v143
    v_and_b32 v39, s69, v143
    v_pk_add_f32 v[16:17], v[16:17], v[32:33]
    v_pk_fma_f32 v[24:25], v[32:33], v[32:33], v[24:25]
    v_pk_add_f32 v[18:19], v[18:19], v[34:35]
    v_pk_fma_f32 v[26:27], v[34:35], v[34:35], v[26:27]
    v_pk_add_f32 v[20:21], v[20:21], v[36:37]
    v_pk_fma_f32 v[28:29], v[36:37], v[36:37], v[28:29]
    v_pk_add_f32 v[22:23], v[22:23], v[38:39]
    v_pk_fma_f32 v[30:31], v[38:39], v[38:39], v[30:31]
    s_waitcnt vmcnt(8)
    v_lshlrev_b32 v40, 16, v144
    v_and_b32 v41, s69, v144
    v_lshlrev_b32 v42, 16, v145
    v_and_b32 v43, s69, v145
    v_lshlrev_b32 v44, 16, v146
    v_and_b32 v45, s69, v146
    v_lshlrev_b32 v46, 16, v147
    v_and_b32 v47, s69, v147
    v_pk_add_f32 v[16:17], v[16:17], v[40:41]
    v_pk_fma_f32 v[24:25], v[40:41], v[40:41], v[24:25]
    v_pk_add_f32 v[18:19], v[18:19], v[42:43]
    v_pk_fma_f32 v[26:27], v[42:43], v[42:43], v[26:27]
    v_pk_add_f32 v[20:21], v[20:21], v[44:45]
    v_pk_fma_f32 v[28:29], v[44:45], v[44:45], v[28:29]
    v_pk_add_f32 v[22:23], v[22:23], v[46:47]
    v_pk_fma_f32 v[30:31], v[46:47], v[46:47], v[30:31]
    s_waitcnt vmcnt(7)
    v_lshlrev_b32 v32, 16, v148
    v_and_b32 v33, s69, v148
    v_lshlrev_b32 v34, 16, v149
    v_and_b32 v35, s69, v149
    v_lshlrev_b32 v36, 16, v150
    v_and_b32 v37, s69, v150
    v_lshlrev_b32 v38, 16, v151
    v_and_b32 v39, s69, v151
    v_pk_add_f32 v[16:17], v[16:17], v[32:33]
    v_pk_fma_f32 v[24:25], v[32:33], v[32:33], v[24:25]
    v_pk_add_f32 v[18:19], v[18:19], v[34:35]
    v_pk_fma_f32 v[26:27], v[34:35], v[34:35], v[26:27]
    v_pk_add_f32 v[20:21], v[20:21], v[36:37]
    v_pk_fma_f32 v[28:29], v[36:37], v[36:37], v[28:29]
    v_pk_add_f32 v[22:23], v[22:23], v[38:39]
    v_pk_fma_f32 v[30:31], v[38:39], v[38:39], v[30:31]
    s_waitcnt vmcnt(6)
    v_lshlrev_b32 v40, 16, v152
    v_and_b32 v41, s69, v152
    v_lshlrev_b32 v42, 16, v153
    v_and_b32 v43, s69, v153
    v_lshlrev_b32 v44, 16, v154
    v_and_b32 v45, s69, v154
    v_lshlrev_b32 v46, 16, v155
    v_and_b32 v47, s69, v155
    v_pk_add_f32 v[16:17], v[16:17], v[40:41]
    v_pk_fma_f32 v[24:25], v[40:41], v[40:41], v[24:25]
    v_pk_add_f32 v[18:19], v[18:19], v[42:43]
    v_pk_fma_f32 v[26:27], v[42:43], v[42:43], v[26:27]
    v_pk_add_f32 v[20:21], v[20:21], v[44:45]
    v_pk_fma_f32 v[28:29], v[44:45], v[44:45], v[28:29]
    v_pk_add_f32 v[22:23], v[22:23], v[46:47]
    v_pk_fma_f32 v[30:31], v[46:47], v[46:47], v[30:31]
    s_waitcnt vmcnt(5)
    v_lshlrev_b32 v32, 16, v156
    v_and_b32 v33, s69, v156
    v_lshlrev_b32 v34, 16, v157
    v_and_b32 v35, s69, v157
    v_lshlrev_b32 v36, 16, v158
    v_and_b32 v37, s69, v158
    v_lshlrev_b32 v38, 16, v159
    v_and_b32 v39, s69, v159
    v_pk_add_f32 v[16:17], v[16:17], v[32:33]
    v_pk_fma_f32 v[24:25], v[32:33], v[32:33], v[24:25]
    v_pk_add_f32 v[18:19], v[18:19], v[34:35]
    v_pk_fma_f32 v[26:27], v[34:35], v[34:35], v[26:27]
    v_pk_add_f32 v[20:21], v[20:21], v[36:37]
    v_pk_fma_f32 v[28:29], v[36:37], v[36:37], v[28:29]
    v_pk_add_f32 v[22:23], v[22:23], v[38:39]
    v_pk_fma_f32 v[30:31], v[38:39], v[38:39], v[30:31]
    s_waitcnt vmcnt(4)
    v_lshlrev_b32 v40, 16, v160
    v_and_b32 v41, s69, v160
    v_lshlrev_b32 v42, 16, v161
    v_and_b32 v43, s69, v161
    v_lshlrev_b32 v44, 16, v162
    v_and_b32 v45, s69, v162
    v_lshlrev_b32 v46, 16, v163
    v_and_b32 v47, s69, v163
    v_pk_add_f32 v[16:17], v[16:17], v[40:41]
    v_pk_fma_f32 v[24:25], v[40:41], v[40:41], v[24:25]
    v_pk_add_f32 v[18:19], v[18:19], v[42:43]
    v_pk_fma_f32 v[26:27], v[42:43], v[42:43], v[26:27]
    v_pk_add_f32 v[20:21], v[20:21], v[44:45]
    v_pk_fma_f32 v[28:29], v[44:45], v[44:45], v[28:29]
    v_pk_add_f32 v[22:23], v[22:23], v[46:47]
    v_pk_fma_f32 v[30:31], v[46:47], v[46:47], v[30:31]
    s_waitcnt vmcnt(3)
    v_lshlrev_b32 v32, 16, v164
    v_and_b32 v33, s69, v164
    v_lshlrev_b32 v34, 16, v165
    v_and_b32 v35, s69, v165
    v_lshlrev_b32 v36, 16, v166
    v_and_b32 v37, s69, v166
    v_lshlrev_b32 v38, 16, v167
    v_and_b32 v39, s69, v167
    v_pk_add_f32 v[16:17], v[16:17], v[32:33]
    v_pk_fma_f32 v[24:25], v[32:33], v[32:33], v[24:25]
    v_pk_add_f32 v[18:19], v[18:19], v[34:35]
    v_pk_fma_f32 v[26:27], v[34:35], v[34:35], v[26:27]
    v_pk_add_f32 v[20:21], v[20:21], v[36:37]
    v_pk_fma_f32 v[28:29], v[36:37], v[36:37], v[28:29]
    v_pk_add_f32 v[22:23], v[22:23], v[38:39]
    v_pk_fma_f32 v[30:31], v[38:39], v[38:39], v[30:31]
    s_waitcnt vmcnt(2)
    v_lshlrev_b32 v40, 16, v168
    v_and_b32 v41, s69, v168
    v_lshlrev_b32 v42, 16, v169
    v_and_b32 v43, s69, v169
    v_lshlrev_b32 v44, 16, v170
    v_and_b32 v45, s69, v170
    v_lshlrev_b32 v46, 16, v171
    v_and_b32 v47, s69, v171
    v_pk_add_f32 v[16:17], v[16:17], v[40:41]
    v_pk_fma_f32 v[24:25], v[40:41], v[40:41], v[24:25]
    v_pk_add_f32 v[18:19], v[18:19], v[42:43]
    v_pk_fma_f32 v[26:27], v[42:43], v[42:43], v[26:27]
    v_pk_add_f32 v[20:21], v[20:21], v[44:45]
    v_pk_fma_f32 v[28:29], v[44:45], v[44:45], v[28:29]
    v_pk_add_f32 v[22:23], v[22:23], v[46:47]
    v_pk_fma_f32 v[30:31], v[46:47], v[46:47], v[30:31]
    s_waitcnt vmcnt(1)
    v_lshlrev_b32 v32, 16, v172
    v_and_b32 v33, s69, v172
    v_lshlrev_b32 v34, 16, v173
    v_and_b32 v35, s69, v173
    v_lshlrev_b32 v36, 16, v174
    v_and_b32 v37, s69, v174
    v_lshlrev_b32 v38, 16, v175
    v_and_b32 v39, s69, v175
    v_pk_add_f32 v[16:17], v[16:17], v[32:33]
    v_pk_fma_f32 v[24:25], v[32:33], v[32:33], v[24:25]
    v_pk_add_f32 v[18:19], v[18:19], v[34:35]
    v_pk_fma_f32 v[26:27], v[34:35], v[34:35], v[26:27]
    v_pk_add_f32 v[20:21], v[20:21], v[36:37]
    v_pk_fma_f32 v[28:29], v[36:37], v[36:37], v[28:29]
    v_pk_add_f32 v[22:23], v[22:23], v[38:39]
    v_pk_fma_f32 v[30:31], v[38:39], v[38:39], v[30:31]
    s_waitcnt vmcnt(0)
    v_lshlrev_b32 v40, 16, v176
    v_and_b32 v41, s69, v176
    v_lshlrev_b32 v42, 16, v177
    v_and_b32 v43, s69, v177
    v_lshlrev_b32 v44, 16, v178
    v_and_b32 v45, s69, v178
    v_lshlrev_b32 v46, 16, v179
    v_and_b32 v47, s69, v179
    v_pk_add_f32 v[16:17], v[16:17], v[40:41]
    v_pk_fma_f32 v[24:25], v[40:41], v[40:41], v[24:25]
    v_pk_add_f32 v[18:19], v[18:19], v[42:43]
    v_pk_fma_f32 v[26:27], v[42:43], v[42:43], v[26:27]
    v_pk_add_f32 v[20:21], v[20:21], v[44:45]
    v_pk_fma_f32 v[28:29], v[44:45], v[44:45], v[28:29]
    v_pk_add_f32 v[22:23], v[22:23], v[46:47]
    v_pk_fma_f32 v[30:31], v[46:47], v[46:47], v[30:31]
    s_nop 1
    v_permlane32_swap_b32 v16, v20
    v_permlane32_swap_b32 v17, v21
    v_permlane32_swap_b32 v18, v22
    v_permlane32_swap_b32 v19, v23
    v_permlane32_swap_b32 v24, v28
    v_permlane32_swap_b32 v25, v29
    v_permlane32_swap_b32 v26, v30
    v_permlane32_swap_b32 v27, v31
    v_add_f32 v16, v16, v20
    v_add_f32 v17, v17, v21
    v_add_f32 v18, v18, v22
    v_add_f32 v19, v19, v23
    v_add_f32 v24, v24, v28
    v_add_f32 v25, v25, v29
    v_add_f32 v26, v26, v30
    v_add_f32 v27, v27, v31
    s_nop 1
    v_permlane16_swap_b32 v16, v18
    v_permlane16_swap_b32 v17, v19
    v_permlane16_swap_b32 v24, v26
    v_permlane16_swap_b32 v25, v27
    v_add_f32 v16, v16, v18
    v_add_f32 v17, v17, v19
    v_add_f32 v24, v24, v26
    v_add_f32 v25, v25, v27
    s_nop 1
    v_add_f32_dpp v16, v16, v16 row_ror:8 row_mask:0xf bank_mask:0xf
    v_add_f32_dpp v17, v17, v17 row_ror:8 row_mask:0xf bank_mask:0xf
    v_add_f32_dpp v24, v24, v24 row_ror:8 row_mask:0xf bank_mask:0xf
    v_add_f32_dpp v25, v25, v25 row_ror:8 row_mask:0xf bank_mask:0xf
    s_lshl_b32 s14, s3, 9
    v_lshrrev_b32 v4, 4, v0
    v_lshlrev_b32 v3, 5, v3
    v_lshl_add_u32 v3, v4, 3, v3
    v_add_u32 v3, s14, v3
    ds_write_b64 v3, v[16:17]
    ds_write_b64 v3, v[24:25] offset:256
    s_waitcnt lgkmcnt(0)
    s_barrier
    s_cmp_lg_u32 s3, 0
    s_cbranch_scc1 idle_pub_53
    v_lshlrev_b32 v2, 2, v0
    ds_read2st64_b32 v[16:17], v2 offset0:0 offset1:1
    ds_read2st64_b32 v[18:19], v2 offset0:2 offset1:3
    ds_read2st64_b32 v[20:21], v2 offset0:4 offset1:5
    ds_read2st64_b32 v[22:23], v2 offset0:6 offset1:7
    s_lshl_b32 s14, s8, 9
    s_add_u32 s14, s14, 11505664
    v_lshl_add_u32 v2, v0, 3, s14
    s_waitcnt lgkmcnt(0)
    v_pk_add_f32 v[16:17], v[16:17], v[18:19]
    v_pk_add_f32 v[20:21], v[20:21], v[22:23]
    v_pk_add_f32 v[16:17], v[16:17], v[20:21]
    v_mul_f32 v16, 0.00156250000, v16
    v_mul_f32 v17, 0.00156250000, v17
    v_fma_f32 v17, -v16, v16, v17
    v_max_f32 v17, 0, v17
    v_add_f32 v17, 0x3727c5ac, v17
    v_rsq_f32 v18, v17
    s_nop 0
    v_mul_f32 v19, -v16, v18
    global_store_dwordx2 v2, v[18:19], s[12:13] sc1
idle_pub_53:
    s_waitcnt vmcnt(0)
    s_barrier
    s_cmp_lg_u32 s3, 0
    s_cbranch_scc1 pub_60
    s_lshl_b32 s74, s2, 7
    s_add_u32 s74, s74, 131072
    v_lshl_add_u32 v54, v0, 3, s74
    v_mov_b32 v52, s70
    v_mov_b32 v53, s71
    s_mov_b64 exec, 0xffff
    global_store_dwordx2 v54, v[52:53], s[12:13] sc1
    s_mov_b64 exec, -1
pub_60:
idle_rest_57:
    s_waitcnt vmcnt(0)
    s_branch g2_42
g2_42:
    s_add_u32 s47, s46, 1966080
    buffer_load_dwordx4 a[248:251], v9, s[40:43], s47 offen offset:2048 sc1
    s_add_u32 s47, s46, 1966080
    buffer_load_dwordx4 a[252:255], v9, s[40:43], s47 offen offset:3072 sc1
    s_add_u32 s47, s46, 1966080
    buffer_load_dwordx4 v[232:235], v8, s[40:43], s47 offen offset:0 sc1
    s_add_u32 s47, s46, 2129920
    buffer_load_dwordx4 v[236:239], v9, s[40:43], s47 offen offset:0 sc1
    s_add_u32 s47, s46, 2129920
    buffer_load_dwordx4 v[240:243], v9, s[40:43], s47 offen offset:1024 sc1
    s_add_u32 s47, s46, 2129920
    buffer_load_dwordx4 v[244:247], v9, s[40:43], s47 offen offset:2048 sc1
    s_load_dwordx2 s[30:31], s[0:1], 96
    s_add_u32 s7, s3, 0
    s_and_b32 s7, s7, 3
    s_lshl_b32 s8, s7, 10
    v_add_u32 v10, s8, v9
    s_add_u32 s7, s3, 1
    s_and_b32 s7, s7, 3
    s_lshl_b32 s8, s7, 10
    v_add_u32 v11, s8, v9
    s_mul_i32 s8, s7, 15360
    s_add_u32 s8, s8, 0
    v_add_u32 v14, s8, v9
    s_add_u32 s7, s3, 2
    s_and_b32 s7, s7, 3
    s_lshl_b32 s8, s7, 10
    v_add_u32 v12, s8, v9
    s_mul_i32 s8, s7, 15360
    s_add_u32 s8, s8, 5120
    v_add_u32 v15, s8, v9
    s_add_u32 s7, s3, 3
    s_and_b32 s7, s7, 3
    s_lshl_b32 s8, s7, 10
    v_add_u32 v13, s8, v9
    s_mul_i32 s8, s7, 15360
    s_add_u32 s8, s8, 10240
    v_add_u32 v16, s8, v9
    s_mul_i32 s8, s44, 221184
    s_add_u32 s8, s8, 13762560
    s_add_u32 s14, s12, s8
    s_addc_u32 s15, s13, 0
    s_mov_b32 s16, s14
    s_and_b32 s17, s15, 0xffff
    s_mov_b32 s18, 221184
    s_mov_b32 s19, 0x20000
    v_and_b32 v2, 15, v0
    v_lshrrev_b32 v3, 4, v0
    v_lshlrev_b32 v4, 12, v2
    v_lshl_add_u32 v4, v3, 4, v4
    v_lshlrev_b32 v18, 4, v3
    s_mul_i32 s8, s45, 327680
    s_lshl_b32 s9, s44, 7
    s_add_u32 s8, s8, s9
    s_lshr_b32 s9, s3, 1
    s_lshl_b32 s9, s9, 6
    s_add_u32 s8, s8, s9
    s_add_u32 s8, s8, 6262784
    s_add_u32 s14, s12, s8
    s_addc_u32 s15, s13, 0
    s_mul_i32 s8, s45, 320
    s_add_u32 s8, s8, 6259200
    s_add_u32 s26, s12, s8
    s_addc_u32 s27, s13, 0
    s_and_b32 s8, s3, 1
    s_lshl_b32 s8, s8, 4
    v_lshlrev_b32 v5, 3, v3
    v_sub_u32 v5, v2, v5
    v_add_u32 v5, s8, v5
    v_mov_b32 v6, 0x3f80
    v_mov_b32 v7, 0x3f800000
    v_cmp_eq_u32 vcc, 0, v5
    v_cmp_eq_u32 s[28:29], 1, v5
    s_nop 1
    v_cndmask_b32 v60, 0, v6, vcc
    v_cndmask_b32 v60, v60, v7, s[28:29]
    v_cmp_eq_u32 vcc, 2, v5
    v_cmp_eq_u32 s[28:29], 3, v5
    s_nop 1
    v_cndmask_b32 v61, 0, v6, vcc
    v_cndmask_b32 v61, v61, v7, s[28:29]
    v_cmp_eq_u32 vcc, 4, v5
    v_cmp_eq_u32 s[28:29], 5, v5
    s_nop 1
    v_cndmask_b32 v62, 0, v6, vcc
    v_cndmask_b32 v62, v62, v7, s[28:29]
    v_cmp_eq_u32 vcc, 6, v5
    v_cmp_eq_u32 s[28:29], 7, v5
    s_nop 1
    v_cndmask_b32 v63, 0, v6, vcc
    v_cndmask_b32 v63, v63, v7, s[28:29]
    v_mov_b32 v147, v0
    s_bfe_u32 s8, s44, 0x20002
    v_lshl_add_u32 v147, v147, 2, s8
    v_mul_u32_u24 v146, 2428, v147
    v_lshrrev_b32 v146, 16, v146
    v_lshlrev_b32 v147, 3, v147
    v_mul_u32_u24 v145, 215, v146
    v_sub_u32 v147, v147, v145
    s_lshr_b32 s8, s44, 4
    s_lshl_b32 s8, s8, 2
    v_add_u32 v147, s8, v147
    s_lshl_b32 s24, s3, 12
    s_waitcnt vmcnt(6)
    s_barrier
    s_cmp_lg_u32 s3, 0
    s_cbranch_scc1 pub_61
    s_lshl_b32 s74, s2, 7
    s_add_u32 s74, s74, 98304
    v_lshl_add_u32 v150, v0, 3, s74
    v_mov_b32 v148, s70
    v_mov_b32 v149, s71
    s_mov_b64 exec, 0xffff
    global_store_dwordx2 v150, v[148:149], s[12:13] sc1
    s_mov_b64 exec, -1
pub_61:
    s_add_u32 s47, s46, 2129920
    buffer_load_dwordx4 v[248:251], v9, s[40:43], s47 offen offset:3072 sc1
    s_add_u32 s47, s46, 2129920
    buffer_load_dwordx4 v[252:255], v8, s[40:43], s47 offen offset:0 sc1
    v_lshrrev_b32 v4, 2, v0
    v_lshlrev_b32 v4, 12, v4
    v_bfe_u32 v19, v0, 4, 2
    v_xor_b32 v19, v19, v0
    v_and_b32 v19, 3, v19
    v_lshl_add_u32 v4, v19, 4, v4
    s_mul_i32 s9, s3, 5120
    s_add_u32 s9, s9, 135168
    v_bfe_u32 v19, v0, 2, 2
    v_xor_b32 v19, v19, v3
    v_lshl_add_u32 v19, v2, 2, v19
    v_lshl_add_u32 v19, v19, 4, s9
    s_add_u32 m0, s9, 0
    s_nop 0
    global_load_lds_dwordx4 v4, s[14:15] sc1
    s_add_u32 s14, s14, 0x10000
    s_addc_u32 s15, s15, 0
    s_add_u32 m0, s9, 1024
    s_nop 0
    global_load_lds_dwordx4 v4, s[14:15] sc1
    s_add_u32 s14, s14, 0x10000
    s_addc_u32 s15, s15, 0
    s_add_u32 m0, s9, 2048
    s_nop 0
    global_load_lds_dwordx4 v4, s[14:15] sc1
    s_add_u32 s14, s14, 0x10000
    s_addc_u32 s15, s15, 0
    s_add_u32 m0, s9, 3072
    s_nop 0
    global_load_lds_dwordx4 v4, s[14:15] sc1
    s_add_u32 s14, s14, 0x10000
    s_addc_u32 s15, s15, 0
    s_add_u32 m0, s9, 4096
    s_nop 0
    global_load_lds_dwordx4 v4, s[14:15] sc1
    s_add_u32 s14, s14, 0x10000
    s_addc_u32 s15, s15, 0
    s_lshl_b32 s8, s3, 9
    s_add_u32 m0, s8, 159744
    v_add_u32 v18, m0, v18
    s_mov_b64 exec, 0xfffff
    global_load_lds_dwordx4 v9, s[26:27] sc1
    s_mov_b64 exec, -1
    s_mul_i32 s8, s3, 2816
    s_add_u32 s8, s8, 65536
    v_mul_u32_u24 v5, 176, v2
    v_lshl_add_u32 v5, v3, 3, v5
    v_add_u32 v5, s8, v5
    v_add_u32 v6, 0, v0
    v_min_u32 v6, 159, v6
    v_mul_u32_u24 v7, 6554, v6
    v_lshrrev_b32 v7, 16, v7
    v_lshlrev_b32 v6, 4, v6
    v_lshl_add_u32 v148, v7, 4, v6
    v_add_u32 v148, s8, v148
    v_mul_u32_u24 v7, 1120, v7
    v_add_u32 v151, v6, v7
    v_add_u32 v6, 64, v0
    v_min_u32 v6, 159, v6
    v_mul_u32_u24 v7, 6554, v6
    v_lshrrev_b32 v7, 16, v7
    v_lshlrev_b32 v6, 4, v6
    v_lshl_add_u32 v149, v7, 4, v6
    v_add_u32 v149, s8, v149
    v_mul_u32_u24 v7, 1120, v7
    v_add_u32 v1, v6, v7
    v_add_u32 v6, 128, v0
    v_min_u32 v6, 159, v6
    v_mul_u32_u24 v7, 6554, v6
    v_lshrrev_b32 v7, 16, v7
    v_lshlrev_b32 v6, 4, v6
    v_lshl_add_u32 v150, v7, 4, v6
    v_add_u32 v150, s8, v150
    v_mul_u32_u24 v7, 1120, v7
    v_add_u32 v4, v6, v7
    s_mul_i32 s8, s3, 15360
    v_add_u32 v17, s8, v9
    s_lshl_b32 s8, s44, 2
    s_add_u32 s8, s8, s3
    s_mul_i32 s8, s8, 20480
    s_mul_i32 s9, s45, 160
    s_add_u32 s8, s8, s9
    s_waitcnt lgkmcnt(0)
    s_add_u32 s30, s30, s8
    s_addc_u32 s31, s31, 0
    s_waitcnt vmcnt(0)
    s_cmp_lg_u32 s3, 3
    s_cbranch_scc1 p1_62
    v_lshlrev_b32 v146, 7, v147
    v_add_u32 v146, 98304, v146
    s_mov_b32 s74, 0x100000
    s_mov_b64 exec, 0x7ffffff
poll_63:
    global_load_dwordx2 v[144:145], v146, s[12:13] sc1
    s_waitcnt vmcnt(0)
    v_cmp_ne_u64 vcc, s[70:71], v[144:145]
    s_and_b64 exec, exec, vcc
    s_cbranch_execz polld_64
    s_sleep 1
    s_sub_u32 s74, s74, 1
    s_cbranch_scc0 poll_63
polld_64:
    s_mov_b64 exec, -1
p1_62:
    s_barrier
    s_add_u32 s25, s24, 0
    buffer_load_dwordx4 v[64:67], v10, s[16:19], s25 offen sc1
    buffer_load_dwordx4 v[68:71], v11, s[16:19], s25 offen sc1
    buffer_load_dwordx4 v[72:75], v12, s[16:19], s25 offen sc1
    buffer_load_dwordx4 v[76:79], v13, s[16:19], s25 offen sc1
    s_add_u32 s25, s24, 16384
    buffer_load_dwordx4 v[80:83], v10, s[16:19], s25 offen sc1
    buffer_load_dwordx4 v[84:87], v11, s[16:19], s25 offen sc1
    buffer_load_dwordx4 v[88:91], v12, s[16:19], s25 offen sc1
    buffer_load_dwordx4 v[92:95], v13, s[16:19], s25 offen sc1
    s_add_u32 s25, s24, 32768
    buffer_load_dwordx4 v[96:99], v10, s[16:19], s25 offen sc1
    buffer_load_dwordx4 v[100:103], v11, s[16:19], s25 offen sc1
    buffer_load_dwordx4 v[104:107], v12, s[16:19], s25 offen sc1
    buffer_load_dwordx4 v[108:111], v13, s[16:19], s25 offen sc1
    s_add_u32 s25, s24, 49152
    buffer_load_dwordx4 v[112:115], v10, s[16:19], s25 offen sc1
    buffer_load_dwordx4 v[116:119], v11, s[16:19], s25 offen sc1
    buffer_load_dwordx4 v[120:123], v12, s[16:19], s25 offen sc1
    buffer_load_dwordx4 v[124:127], v13, s[16:19], s25 offen sc1
    ds_read_b128 v[128:131], v19 offset:0
    ds_read_b128 v[132:135], v19 offset:1024
    ds_read_b128 v[136:139], v19 offset:2048
    ds_read_b128 v[140:143], v19 offset:3072
    ds_read_b128 v[144:147], v19 offset:4096
    ds_read_b128 v[40:43], v18 offset:0
    ds_read_b128 v[44:47], v18 offset:64
    ds_read_b128 v[48:51], v18 offset:128
    ds_read_b128 v[52:55], v18 offset:192
    ds_read_b128 v[56:59], v18 offset:256
    s_waitcnt lgkmcnt(5)
    v_mfma_f32_16x16x32_bf16 v[20:23], v[128:131], v[60:63], 0
    v_mfma_f32_16x16x32_bf16 v[24:27], v[132:135], v[60:63], 0
    v_mfma_f32_16x16x32_bf16 v[28:31], v[136:139], v[60:63], 0
    v_mfma_f32_16x16x32_bf16 v[32:35], v[140:143], v[60:63], 0
    v_mfma_f32_16x16x32_bf16 v[36:39], v[144:147], v[60:63], 0
    s_waitcnt vmcnt(12)
    v_mfma_f32_16x16x32_bf16 v[152:155], a[0:3], v[64:67], 0
    s_add_u32 s25, s24, 65536
    buffer_load_dwordx4 v[128:131], v10, s[16:19], s25 offen sc1
    v_mfma_f32_16x16x32_bf16 v[156:159], a[4:7], v[64:67], 0
    v_mfma_f32_16x16x32_bf16 v[160:163], a[8:11], v[64:67], 0
    v_mfma_f32_16x16x32_bf16 v[164:167], a[12:15], v[64:67], 0
    v_mfma_f32_16x16x32_bf16 v[168:171], a[16:19], v[64:67], 0
    v_mfma_f32_16x16x32_bf16 v[172:175], a[0:3], v[68:71], 0
    buffer_load_dwordx4 v[132:135], v11, s[16:19], s25 offen sc1
    v_mfma_f32_16x16x32_bf16 v[176:179], a[4:7], v[68:71], 0
    v_mfma_f32_16x16x32_bf16 v[180:183], a[8:11], v[68:71], 0
    v_mfma_f32_16x16x32_bf16 v[184:187], a[12:15], v[68:71], 0
    v_mfma_f32_16x16x32_bf16 v[188:191], a[16:19], v[68:71], 0
    v_mfma_f32_16x16x32_bf16 v[192:195], a[0:3], v[72:75], 0
    buffer_load_dwordx4 v[136:139], v12, s[16:19], s25 offen sc1
    v_mfma_f32_16x16x32_bf16 v[196:199], a[4:7], v[72:75], 0
    v_mfma_f32_16x16x32_bf16 v[200:203], a[8:11], v[72:75], 0
    v_mfma_f32_16x16x32_bf16 v[204:207], a[12:15], v[72:75], 0
    v_mfma_f32_16x16x32_bf16 v[208:211], a[16:19], v[72:75], 0
    v_mfma_f32_16x16x32_bf16 v[212:215], a[0:3], v[76:79], 0
    buffer_load_dwordx4 v[140:143], v13, s[16:19], s25 offen sc1
    v_mfma_f32_16x16x32_bf16 v[216:219], a[4:7], v[76:79], 0
    v_mfma_f32_16x16x32_bf16 v[220:223], a[8:11], v[76:79], 0
    v_mfma_f32_16x16x32_bf16 v[224:227], a[12:15], v[76:79], 0
    v_mfma_f32_16x16x32_bf16 v[228:231], a[16:19], v[76:79], 0
    s_waitcnt vmcnt(12)
    v_mfma_f32_16x16x32_bf16 v[152:155], a[20:23], v[80:83], v[152:155]
    s_add_u32 s25, s24, 81920
    buffer_load_dwordx4 v[64:67], v10, s[16:19], s25 offen sc1
    v_mfma_f32_16x16x32_bf16 v[156:159], a[24:27], v[80:83], v[156:159]
    v_mfma_f32_16x16x32_bf16 v[160:163], a[28:31], v[80:83], v[160:163]
    v_mfma_f32_16x16x32_bf16 v[164:167], a[32:35], v[80:83], v[164:167]
    v_mfma_f32_16x16x32_bf16 v[168:171], a[36:39], v[80:83], v[168:171]
    v_mfma_f32_16x16x32_bf16 v[172:175], a[20:23], v[84:87], v[172:175]
    buffer_load_dwordx4 v[68:71], v11, s[16:19], s25 offen sc1
    v_mfma_f32_16x16x32_bf16 v[176:179], a[24:27], v[84:87], v[176:179]
    v_mfma_f32_16x16x32_bf16 v[180:183], a[28:31], v[84:87], v[180:183]
    v_mfma_f32_16x16x32_bf16 v[184:187], a[32:35], v[84:87], v[184:187]
    v_mfma_f32_16x16x32_bf16 v[188:191], a[36:39], v[84:87], v[188:191]
    v_mfma_f32_16x16x32_bf16 v[192:195], a[20:23], v[88:91], v[192:195]
    buffer_load_dwordx4 v[72:75], v12, s[16:19], s25 offen sc1
    v_mfma_f32_16x16x32_bf16 v[196:199], a[24:27], v[88:91], v[196:199]
    v_mfma_f32_16x16x32_bf16 v[200:203], a[28:31], v[88:91], v[200:203]
    v_mfma_f32_16x16x32_bf16 v[204:207], a[32:35], v[88:91], v[204:207]
    v_mfma_f32_16x16x32_bf16 v[208:211], a[36:39], v[88:91], v[208:211]
    v_mfma_f32_16x16x32_bf16 v[212:215], a[20:23], v[92:95], v[212:215]
    buffer_load_dwordx4 v[76:79], v13, s[16:19], s25 offen sc1
    v_mfma_f32_16x16x32_bf16 v[216:219], a[24:27], v[92:95], v[216:219]
    v_mfma_f32_16x16x32_bf16 v[220:223], a[28:31], v[92:95], v[220:223]
    v_mfma_f32_16x16x32_bf16 v[224:227], a[32:35], v[92:95], v[224:227]
    v_mfma_f32_16x16x32_bf16 v[228:231], a[36:39], v[92:95], v[228:231]
    s_waitcnt vmcnt(12)
    v_mfma_f32_16x16x32_bf16 v[152:155], a[40:43], v[96:99], v[152:155]
    s_add_u32 s25, s24, 98304
    buffer_load_dwordx4 v[80:83], v10, s[16:19], s25 offen sc1
    v_mfma_f32_16x16x32_bf16 v[156:159], a[44:47], v[96:99], v[156:159]
    v_mfma_f32_16x16x32_bf16 v[160:163], a[48:51], v[96:99], v[160:163]
    v_mfma_f32_16x16x32_bf16 v[164:167], a[52:55], v[96:99], v[164:167]
    v_mfma_f32_16x16x32_bf16 v[168:171], a[56:59], v[96:99], v[168:171]
    v_mfma_f32_16x16x32_bf16 v[172:175], a[40:43], v[100:103], v[172:175]
    buffer_load_dwordx4 v[84:87], v11, s[16:19], s25 offen sc1
    v_mfma_f32_16x16x32_bf16 v[176:179], a[44:47], v[100:103], v[176:179]
    v_mfma_f32_16x16x32_bf16 v[180:183], a[48:51], v[100:103], v[180:183]
    v_mfma_f32_16x16x32_bf16 v[184:187], a[52:55], v[100:103], v[184:187]
    v_mfma_f32_16x16x32_bf16 v[188:191], a[56:59], v[100:103], v[188:191]
    v_mfma_f32_16x16x32_bf16 v[192:195], a[40:43], v[104:107], v[192:195]
    buffer_load_dwordx4 v[88:91], v12, s[16:19], s25 offen sc1
    v_mfma_f32_16x16x32_bf16 v[196:199], a[44:47], v[104:107], v[196:199]
    v_mfma_f32_16x16x32_bf16 v[200:203], a[48:51], v[104:107], v[200:203]
    v_mfma_f32_16x16x32_bf16 v[204:207], a[52:55], v[104:107], v[204:207]
    v_mfma_f32_16x16x32_bf16 v[208:211], a[56:59], v[104:107], v[208:211]
    v_mfma_f32_16x16x32_bf16 v[212:215], a[40:43], v[108:111], v[212:215]
    buffer_load_dwordx4 v[92:95], v13, s[16:19], s25 offen sc1
    v_mfma_f32_16x16x32_bf16 v[216:219], a[44:47], v[108:111], v[216:219]
    v_mfma_f32_16x16x32_bf16 v[220:223], a[48:51], v[108:111], v[220:223]
    v_mfma_f32_16x16x32_bf16 v[224:227], a[52:55], v[108:111], v[224:227]
    v_mfma_f32_16x16x32_bf16 v[228:231], a[56:59], v[108:111], v[228:231]
    s_waitcnt vmcnt(12)
    v_mfma_f32_16x16x32_bf16 v[152:155], a[60:63], v[112:115], v[152:155]
    s_add_u32 s25, s24, 114688
    buffer_load_dwordx4 v[96:99], v10, s[16:19], s25 offen sc1
    v_mfma_f32_16x16x32_bf16 v[156:159], a[64:67], v[112:115], v[156:159]
    v_mfma_f32_16x16x32_bf16 v[160:163], a[68:71], v[112:115], v[160:163]
    v_mfma_f32_16x16x32_bf16 v[164:167], a[72:75], v[112:115], v[164:167]
    v_mfma_f32_16x16x32_bf16 v[168:171], a[76:79], v[112:115], v[168:171]
    v_mfma_f32_16x16x32_bf16 v[172:175], a[60:63], v[116:119], v[172:175]
    buffer_load_dwordx4 v[100:103], v11, s[16:19], s25 offen sc1
    v_mfma_f32_16x16x32_bf16 v[176:179], a[64:67], v[116:119], v[176:179]
    v_mfma_f32_16x16x32_bf16 v[180:183], a[68:71], v[116:119], v[180:183]
    v_mfma_f32_16x16x32_bf16 v[184:187], a[72:75], v[116:119], v[184:187]
    v_mfma_f32_16x16x32_bf16 v[188:191], a[76:79], v[116:119], v[188:191]
    v_mfma_f32_16x16x32_bf16 v[192:195], a[60:63], v[120:123], v[192:195]
    buffer_load_dwordx4 v[104:107], v12, s[16:19], s25 offen sc1
    v_mfma_f32_16x16x32_bf16 v[196:199], a[64:67], v[120:123], v[196:199]
    v_mfma_f32_16x16x32_bf16 v[200:203], a[68:71], v[120:123], v[200:203]
    v_mfma_f32_16x16x32_bf16 v[204:207], a[72:75], v[120:123], v[204:207]
    v_mfma_f32_16x16x32_bf16 v[208:211], a[76:79], v[120:123], v[208:211]
    v_mfma_f32_16x16x32_bf16 v[212:215], a[60:63], v[124:127], v[212:215]
    buffer_load_dwordx4 v[108:111], v13, s[16:19], s25 offen sc1
    v_mfma_f32_16x16x32_bf16 v[216:219], a[64:67], v[124:127], v[216:219]
    v_mfma_f32_16x16x32_bf16 v[220:223], a[68:71], v[124:127], v[220:223]
    v_mfma_f32_16x16x32_bf16 v[224:227], a[72:75], v[124:127], v[224:227]
    v_mfma_f32_16x16x32_bf16 v[228:231], a[76:79], v[124:127], v[228:231]
    s_waitcnt vmcnt(12)
    v_mfma_f32_16x16x32_bf16 v[152:155], a[80:83], v[128:131], v[152:155]
    s_add_u32 s25, s24, 131072
    buffer_load_dwordx4 v[112:115], v10, s[16:19], s25 offen sc1
    v_mfma_f32_16x16x32_bf16 v[156:159], a[84:87], v[128:131], v[156:159]
    v_mfma_f32_16x16x32_bf16 v[160:163], a[88:91], v[128:131], v[160:163]
    v_mfma_f32_16x16x32_bf16 v[164:167], a[92:95], v[128:131], v[164:167]
    v_mfma_f32_16x16x32_bf16 v[168:171], a[96:99], v[128:131], v[168:171]
    v_mfma_f32_16x16x32_bf16 v[172:175], a[80:83], v[132:135], v[172:175]
    buffer_load_dwordx4 v[116:119], v11, s[16:19], s25 offen sc1
    v_mfma_f32_16x16x32_bf16 v[176:179], a[84:87], v[132:135], v[176:179]
    v_mfma_f32_16x16x32_bf16 v[180:183], a[88:91], v[132:135], v[180:183]
    v_mfma_f32_16x16x32_bf16 v[184:187], a[92:95], v[132:135], v[184:187]
    v_mfma_f32_16x16x32_bf16 v[188:191], a[96:99], v[132:135], v[188:191]
    v_mfma_f32_16x16x32_bf16 v[192:195], a[80:83], v[136:139], v[192:195]
    buffer_load_dwordx4 v[120:123], v12, s[16:19], s25 offen sc1
    v_mfma_f32_16x16x32_bf16 v[196:199], a[84:87], v[136:139], v[196:199]
    v_mfma_f32_16x16x32_bf16 v[200:203], a[88:91], v[136:139], v[200:203]
    v_mfma_f32_16x16x32_bf16 v[204:207], a[92:95], v[136:139], v[204:207]
    v_mfma_f32_16x16x32_bf16 v[208:211], a[96:99], v[136:139], v[208:211]
    v_mfma_f32_16x16x32_bf16 v[212:215], a[80:83], v[140:143], v[212:215]
    buffer_load_dwordx4 v[124:127], v13, s[16:19], s25 offen sc1
    v_mfma_f32_16x16x32_bf16 v[216:219], a[84:87], v[140:143], v[216:219]
    v_mfma_f32_16x16x32_bf16 v[220:223], a[88:91], v[140:143], v[220:223]
    v_mfma_f32_16x16x32_bf16 v[224:227], a[92:95], v[140:143], v[224:227]
    v_mfma_f32_16x16x32_bf16 v[228:231], a[96:99], v[140:143], v[228:231]
    s_waitcnt vmcnt(12)
    v_mfma_f32_16x16x32_bf16 v[152:155], a[100:103], v[64:67], v[152:155]
    s_add_u32 s25, s24, 147456
    buffer_load_dwordx4 v[128:131], v10, s[16:19], s25 offen sc1
    v_mfma_f32_16x16x32_bf16 v[156:159], a[104:107], v[64:67], v[156:159]
    v_mfma_f32_16x16x32_bf16 v[160:163], a[108:111], v[64:67], v[160:163]
    v_mfma_f32_16x16x32_bf16 v[164:167], a[112:115], v[64:67], v[164:167]
    v_mfma_f32_16x16x32_bf16 v[168:171], a[116:119], v[64:67], v[168:171]
    v_mfma_f32_16x16x32_bf16 v[172:175], a[100:103], v[68:71], v[172:175]
    buffer_load_dwordx4 v[132:135], v11, s[16:19], s25 offen sc1
    v_mfma_f32_16x16x32_bf16 v[176:179], a[104:107], v[68:71], v[176:179]
    v_mfma_f32_16x16x32_bf16 v[180:183], a[108:111], v[68:71], v[180:183]
    v_mfma_f32_16x16x32_bf16 v[184:187], a[112:115], v[68:71], v[184:187]
    v_mfma_f32_16x16x32_bf16 v[188:191], a[116:119], v[68:71], v[188:191]
    v_mfma_f32_16x16x32_bf16 v[192:195], a[100:103], v[72:75], v[192:195]
    buffer_load_dwordx4 v[136:139], v12, s[16:19], s25 offen sc1
    v_mfma_f32_16x16x32_bf16 v[196:199], a[104:107], v[72:75], v[196:199]
    v_mfma_f32_16x16x32_bf16 v[200:203], a[108:111], v[72:75], v[200:203]
    v_mfma_f32_16x16x32_bf16 v[204:207], a[112:115], v[72:75], v[204:207]
    v_mfma_f32_16x16x32_bf16 v[208:211], a[116:119], v[72:75], v[208:211]
    v_mfma_f32_16x16x32_bf16 v[212:215], a[100:103], v[76:79], v[212:215]
    buffer_load_dwordx4 v[140:143], v13, s[16:19], s25 offen sc1
    v_mfma_f32_16x16x32_bf16 v[216:219], a[104:107], v[76:79], v[216:219]
    v_mfma_f32_16x16x32_bf16 v[220:223], a[108:111], v[76:79], v[220:223]
    v_mfma_f32_16x16x32_bf16 v[224:227], a[112:115], v[76:79], v[224:227]
    v_mfma_f32_16x16x32_bf16 v[228:231], a[116:119], v[76:79], v[228:231]
    s_waitcnt vmcnt(12)
    v_mfma_f32_16x16x32_bf16 v[152:155], a[120:123], v[80:83], v[152:155]
    s_add_u32 s25, s24, 163840
    buffer_load_dwordx4 v[64:67], v10, s[16:19], s25 offen sc1
    v_mfma_f32_16x16x32_bf16 v[156:159], a[124:127], v[80:83], v[156:159]
    v_mfma_f32_16x16x32_bf16 v[160:163], a[128:131], v[80:83], v[160:163]
    v_mfma_f32_16x16x32_bf16 v[164:167], a[132:135], v[80:83], v[164:167]
    v_mfma_f32_16x16x32_bf16 v[168:171], a[136:139], v[80:83], v[168:171]
    v_mfma_f32_16x16x32_bf16 v[172:175], a[120:123], v[84:87], v[172:175]
    buffer_load_dwordx4 v[68:71], v11, s[16:19], s25 offen sc1
    v_mfma_f32_16x16x32_bf16 v[176:179], a[124:127], v[84:87], v[176:179]
    v_mfma_f32_16x16x32_bf16 v[180:183], a[128:131], v[84:87], v[180:183]
    v_mfma_f32_16x16x32_bf16 v[184:187], a[132:135], v[84:87], v[184:187]
    v_mfma_f32_16x16x32_bf16 v[188:191], a[136:139], v[84:87], v[188:191]
    v_mfma_f32_16x16x32_bf16 v[192:195], a[120:123], v[88:91], v[192:195]
    buffer_load_dwordx4 v[72:75], v12, s[16:19], s25 offen sc1
    v_mfma_f32_16x16x32_bf16 v[196:199], a[124:127], v[88:91], v[196:199]
    v_mfma_f32_16x16x32_bf16 v[200:203], a[128:131], v[88:91], v[200:203]
    v_mfma_f32_16x16x32_bf16 v[204:207], a[132:135], v[88:91], v[204:207]
    v_mfma_f32_16x16x32_bf16 v[208:211], a[136:139], v[88:91], v[208:211]
    v_mfma_f32_16x16x32_bf16 v[212:215], a[120:123], v[92:95], v[212:215]
    buffer_load_dwordx4 v[76:79], v13, s[16:19], s25 offen sc1
    v_mfma_f32_16x16x32_bf16 v[216:219], a[124:127], v[92:95], v[216:219]
    v_mfma_f32_16x16x32_bf16 v[220:223], a[128:131], v[92:95], v[220:223]
    v_mfma_f32_16x16x32_bf16 v[224:227], a[132:135], v[92:95], v[224:227]
    v_mfma_f32_16x16x32_bf16 v[228:231], a[136:139], v[92:95], v[228:231]
    s_waitcnt vmcnt(12)
    v_mfma_f32_16x16x32_bf16 v[152:155], a[140:143], v[96:99], v[152:155]
    s_add_u32 s25, s24, 180224
    buffer_load_dwordx4 v[80:83], v10, s[16:19], s25 offen sc1
    v_mfma_f32_16x16x32_bf16 v[156:159], a[144:147], v[96:99], v[156:159]
    v_mfma_f32_16x16x32_bf16 v[160:163], a[148:151], v[96:99], v[160:163]
    v_mfma_f32_16x16x32_bf16 v[164:167], a[152:155], v[96:99], v[164:167]
    v_mfma_f32_16x16x32_bf16 v[168:171], a[156:159], v[96:99], v[168:171]
    v_mfma_f32_16x16x32_bf16 v[172:175], a[140:143], v[100:103], v[172:175]
    buffer_load_dwordx4 v[84:87], v11, s[16:19], s25 offen sc1
    v_mfma_f32_16x16x32_bf16 v[176:179], a[144:147], v[100:103], v[176:179]
    v_mfma_f32_16x16x32_bf16 v[180:183], a[148:151], v[100:103], v[180:183]
    v_mfma_f32_16x16x32_bf16 v[184:187], a[152:155], v[100:103], v[184:187]
    v_mfma_f32_16x16x32_bf16 v[188:191], a[156:159], v[100:103], v[188:191]
    v_mfma_f32_16x16x32_bf16 v[192:195], a[140:143], v[104:107], v[192:195]
    buffer_load_dwordx4 v[88:91], v12, s[16:19], s25 offen sc1
    v_mfma_f32_16x16x32_bf16 v[196:199], a[144:147], v[104:107], v[196:199]
    v_mfma_f32_16x16x32_bf16 v[200:203], a[148:151], v[104:107], v[200:203]
    v_mfma_f32_16x16x32_bf16 v[204:207], a[152:155], v[104:107], v[204:207]
    v_mfma_f32_16x16x32_bf16 v[208:211], a[156:159], v[104:107], v[208:211]
    v_mfma_f32_16x16x32_bf16 v[212:215], a[140:143], v[108:111], v[212:215]
    buffer_load_dwordx4 v[92:95], v13, s[16:19], s25 offen sc1
    v_mfma_f32_16x16x32_bf16 v[216:219], a[144:147], v[108:111], v[216:219]
    v_mfma_f32_16x16x32_bf16 v[220:223], a[148:151], v[108:111], v[220:223]
    v_mfma_f32_16x16x32_bf16 v[224:227], a[152:155], v[108:111], v[224:227]
    v_mfma_f32_16x16x32_bf16 v[228:231], a[156:159], v[108:111], v[228:231]
    s_waitcnt vmcnt(12)
    v_mfma_f32_16x16x32_bf16 v[152:155], a[160:163], v[112:115], v[152:155]
    s_add_u32 s25, s24, 196608
    buffer_load_dwordx4 v[96:99], v10, s[16:19], s25 offen sc1
    v_mfma_f32_16x16x32_bf16 v[156:159], a[164:167], v[112:115], v[156:159]
    v_mfma_f32_16x16x32_bf16 v[160:163], a[168:171], v[112:115], v[160:163]
    v_mfma_f32_16x16x32_bf16 v[164:167], a[172:175], v[112:115], v[164:167]
    v_mfma_f32_16x16x32_bf16 v[168:171], a[176:179], v[112:115], v[168:171]
    v_mfma_f32_16x16x32_bf16 v[172:175], a[160:163], v[116:119], v[172:175]
    buffer_load_dwordx4 v[100:103], v11, s[16:19], s25 offen sc1
    v_mfma_f32_16x16x32_bf16 v[176:179], a[164:167], v[116:119], v[176:179]
    v_mfma_f32_16x16x32_bf16 v[180:183], a[168:171], v[116:119], v[180:183]
    v_mfma_f32_16x16x32_bf16 v[184:187], a[172:175], v[116:119], v[184:187]
    v_mfma_f32_16x16x32_bf16 v[188:191], a[176:179], v[116:119], v[188:191]
    v_mfma_f32_16x16x32_bf16 v[192:195], a[160:163], v[120:123], v[192:195]
    buffer_load_dwordx4 v[104:107], v12, s[16:19], s25 offen sc1
    v_mfma_f32_16x16x32_bf16 v[196:199], a[164:167], v[120:123], v[196:199]
    v_mfma_f32_16x16x32_bf16 v[200:203], a[168:171], v[120:123], v[200:203]
    v_mfma_f32_16x16x32_bf16 v[204:207], a[172:175], v[120:123], v[204:207]
    v_mfma_f32_16x16x32_bf16 v[208:211], a[176:179], v[120:123], v[208:211]
    v_mfma_f32_16x16x32_bf16 v[212:215], a[160:163], v[124:127], v[212:215]
    buffer_load_dwordx4 v[108:111], v13, s[16:19], s25 offen sc1
    v_mfma_f32_16x16x32_bf16 v[216:219], a[164:167], v[124:127], v[216:219]
    v_mfma_f32_16x16x32_bf16 v[220:223], a[168:171], v[124:127], v[220:223]
    v_mfma_f32_16x16x32_bf16 v[224:227], a[172:175], v[124:127], v[224:227]
    v_mfma_f32_16x16x32_bf16 v[228:231], a[176:179], v[124:127], v[228:231]
    s_waitcnt vmcnt(12)
    v_mfma_f32_16x16x32_bf16 v[152:155], a[180:183], v[128:131], v[152:155]
    s_add_u32 s25, s24, 212992
    buffer_load_dwordx4 v[112:115], v10, s[16:19], s25 offen sc1
    v_mfma_f32_16x16x32_bf16 v[156:159], a[184:187], v[128:131], v[156:159]
    v_mfma_f32_16x16x32_bf16 v[160:163], a[188:191], v[128:131], v[160:163]
    v_mfma_f32_16x16x32_bf16 v[164:167], a[192:195], v[128:131], v[164:167]
    v_mfma_f32_16x16x32_bf16 v[168:171], a[196:199], v[128:131], v[168:171]
    v_mfma_f32_16x16x32_bf16 v[172:175], a[180:183], v[132:135], v[172:175]
    buffer_load_dwordx4 v[116:119], v11, s[16:19], s25 offen sc1
    v_mfma_f32_16x16x32_bf16 v[176:179], a[184:187], v[132:135], v[176:179]
    v_mfma_f32_16x16x32_bf16 v[180:183], a[188:191], v[132:135], v[180:183]
    v_mfma_f32_16x16x32_bf16 v[184:187], a[192:195], v[132:135], v[184:187]
    v_mfma_f32_16x16x32_bf16 v[188:191], a[196:199], v[132:135], v[188:191]
    v_mfma_f32_16x16x32_bf16 v[192:195], a[180:183], v[136:139], v[192:195]
    buffer_load_dwordx4 v[120:123], v12, s[16:19], s25 offen sc1
    v_mfma_f32_16x16x32_bf16 v[196:199], a[184:187], v[136:139], v[196:199]
    v_mfma_f32_16x16x32_bf16 v[200:203], a[188:191], v[136:139], v[200:203]
    v_mfma_f32_16x16x32_bf16 v[204:207], a[192:195], v[136:139], v[204:207]
    v_mfma_f32_16x16x32_bf16 v[208:211], a[196:199], v[136:139], v[208:211]
    v_mfma_f32_16x16x32_bf16 v[212:215], a[180:183], v[140:143], v[212:215]
    buffer_load_dwordx4 v[124:127], v13, s[16:19], s25 offen sc1
    v_mfma_f32_16x16x32_bf16 v[216:219], a[184:187], v[140:143], v[216:219]
    v_mfma_f32_16x16x32_bf16 v[220:223], a[188:191], v[140:143], v[220:223]
    v_mfma_f32_16x16x32_bf16 v[224:227], a[192:195], v[140:143], v[224:227]
    v_mfma_f32_16x16x32_bf16 v[228:231], a[196:199], v[140:143], v[228:231]
    s_waitcnt vmcnt(12)
    v_mfma_f32_16x16x32_bf16 v[152:155], a[200:203], v[64:67], v[152:155]
    v_mfma_f32_16x16x32_bf16 v[156:159], a[204:207], v[64:67], v[156:159]
    v_mfma_f32_16x16x32_bf16 v[160:163], a[208:211], v[64:67], v[160:163]
    v_mfma_f32_16x16x32_bf16 v[164:167], a[212:215], v[64:67], v[164:167]
    v_mfma_f32_16x16x32_bf16 v[168:171], a[216:219], v[64:67], v[168:171]
    v_mfma_f32_16x16x32_bf16 v[172:175], a[200:203], v[68:71], v[172:175]
    v_mfma_f32_16x16x32_bf16 v[176:179], a[204:207], v[68:71], v[176:179]
    v_mfma_f32_16x16x32_bf16 v[180:183], a[208:211], v[68:71], v[180:183]
    v_mfma_f32_16x16x32_bf16 v[184:187], a[212:215], v[68:71], v[184:187]
    v_mfma_f32_16x16x32_bf16 v[188:191], a[216:219], v[68:71], v[188:191]
    v_mfma_f32_16x16x32_bf16 v[192:195], a[200:203], v[72:75], v[192:195]
    v_mfma_f32_16x16x32_bf16 v[196:199], a[204:207], v[72:75], v[196:199]
    v_mfma_f32_16x16x32_bf16 v[200:203], a[208:211], v[72:75], v[200:203]
    v_mfma_f32_16x16x32_bf16 v[204:207], a[212:215], v[72:75], v[204:207]
    v_mfma_f32_16x16x32_bf16 v[208:211], a[216:219], v[72:75], v[208:211]
    v_mfma_f32_16x16x32_bf16 v[212:215], a[200:203], v[76:79], v[212:215]
    v_mfma_f32_16x16x32_bf16 v[216:219], a[204:207], v[76:79], v[216:219]
    v_mfma_f32_16x16x32_bf16 v[220:223], a[208:211], v[76:79], v[220:223]
    v_mfma_f32_16x16x32_bf16 v[224:227], a[212:215], v[76:79], v[224:227]
    v_mfma_f32_16x16x32_bf16 v[228:231], a[216:219], v[76:79], v[228:231]
    s_waitcnt vmcnt(8)
    v_mfma_f32_16x16x32_bf16 v[152:155], a[220:223], v[80:83], v[152:155]
    v_mfma_f32_16x16x32_bf16 v[156:159], a[224:227], v[80:83], v[156:159]
    v_mfma_f32_16x16x32_bf16 v[160:163], a[228:231], v[80:83], v[160:163]
    v_mfma_f32_16x16x32_bf16 v[164:167], a[232:235], v[80:83], v[164:167]
    v_mfma_f32_16x16x32_bf16 v[168:171], a[236:239], v[80:83], v[168:171]
    v_mfma_f32_16x16x32_bf16 v[172:175], a[220:223], v[84:87], v[172:175]
    v_mfma_f32_16x16x32_bf16 v[176:179], a[224:227], v[84:87], v[176:179]
    v_mfma_f32_16x16x32_bf16 v[180:183], a[228:231], v[84:87], v[180:183]
    v_mfma_f32_16x16x32_bf16 v[184:187], a[232:235], v[84:87], v[184:187]
    v_mfma_f32_16x16x32_bf16 v[188:191], a[236:239], v[84:87], v[188:191]
    v_mfma_f32_16x16x32_bf16 v[192:195], a[220:223], v[88:91], v[192:195]
    v_mfma_f32_16x16x32_bf16 v[196:199], a[224:227], v[88:91], v[196:199]
    v_mfma_f32_16x16x32_bf16 v[200:203], a[228:231], v[88:91], v[200:203]
    v_mfma_f32_16x16x32_bf16 v[204:207], a[232:235], v[88:91], v[204:207]
    v_mfma_f32_16x16x32_bf16 v[208:211], a[236:239], v[88:91], v[208:211]
    v_mfma_f32_16x16x32_bf16 v[212:215], a[220:223], v[92:95], v[212:215]
    v_mfma_f32_16x16x32_bf16 v[216:219], a[224:227], v[92:95], v[216:219]
    v_mfma_f32_16x16x32_bf16 v[220:223], a[228:231], v[92:95], v[220:223]
    v_mfma_f32_16x16x32_bf16 v[224:227], a[232:235], v[92:95], v[224:227]
    v_mfma_f32_16x16x32_bf16 v[228:231], a[236:239], v[92:95], v[228:231]
    s_waitcnt vmcnt(4)
    v_mfma_f32_16x16x32_bf16 v[152:155], a[240:243], v[96:99], v[152:155]
    v_mfma_f32_16x16x32_bf16 v[156:159], a[244:247], v[96:99], v[156:159]
    v_mfma_f32_16x16x32_bf16 v[160:163], a[248:251], v[96:99], v[160:163]
    v_mfma_f32_16x16x32_bf16 v[164:167], a[252:255], v[96:99], v[164:167]
    v_mfma_f32_16x16x32_bf16 v[168:171], v[232:235], v[96:99], v[168:171]
    v_mfma_f32_16x16x32_bf16 v[172:175], a[240:243], v[100:103], v[172:175]
    v_mfma_f32_16x16x32_bf16 v[176:179], a[244:247], v[100:103], v[176:179]
    v_mfma_f32_16x16x32_bf16 v[180:183], a[248:251], v[100:103], v[180:183]
    v_mfma_f32_16x16x32_bf16 v[184:187], a[252:255], v[100:103], v[184:187]
    v_mfma_f32_16x16x32_bf16 v[188:191], v[232:235], v[100:103], v[188:191]
    v_mfma_f32_16x16x32_bf16 v[192:195], a[240:243], v[104:107], v[192:195]
    v_mfma_f32_16x16x32_bf16 v[196:199], a[244:247], v[104:107], v[196:199]
    v_mfma_f32_16x16x32_bf16 v[200:203], a[248:251], v[104:107], v[200:203]
    v_mfma_f32_16x16x32_bf16 v[204:207], a[252:255], v[104:107], v[204:207]
    v_mfma_f32_16x16x32_bf16 v[208:211], v[232:235], v[104:107], v[208:211]
    v_mfma_f32_16x16x32_bf16 v[212:215], a[240:243], v[108:111], v[212:215]
    v_mfma_f32_16x16x32_bf16 v[216:219], a[244:247], v[108:111], v[216:219]
    v_mfma_f32_16x16x32_bf16 v[220:223], a[248:251], v[108:111], v[220:223]
    v_mfma_f32_16x16x32_bf16 v[224:227], a[252:255], v[108:111], v[224:227]
    v_mfma_f32_16x16x32_bf16 v[228:231], v[232:235], v[108:111], v[228:231]
    s_cmp_ge_u32 s3, 2
    s_cbranch_scc1 g2_skip_65
    s_waitcnt vmcnt(0)
    v_mfma_f32_16x16x32_bf16 v[172:175], v[236:239], v[116:119], v[172:175]
    v_mfma_f32_16x16x32_bf16 v[176:179], v[240:243], v[116:119], v[176:179]
    v_mfma_f32_16x16x32_bf16 v[180:183], v[244:247], v[116:119], v[180:183]
    v_mfma_f32_16x16x32_bf16 v[184:187], v[248:251], v[116:119], v[184:187]
    v_mfma_f32_16x16x32_bf16 v[188:191], v[252:255], v[116:119], v[188:191]
    v_mfma_f32_16x16x32_bf16 v[192:195], v[236:239], v[120:123], v[192:195]
    v_mfma_f32_16x16x32_bf16 v[196:199], v[240:243], v[120:123], v[196:199]
    v_mfma_f32_16x16x32_bf16 v[200:203], v[244:247], v[120:123], v[200:203]
    v_mfma_f32_16x16x32_bf16 v[204:207], v[248:251], v[120:123], v[204:207]
    v_mfma_f32_16x16x32_bf16 v[208:211], v[252:255], v[120:123], v[208:211]
    v_mfma_f32_16x16x32_bf16 v[212:215], v[236:239], v[124:127], v[212:215]
    ds_write_b128 v14, v[172:175] offset:0
    v_mfma_f32_16x16x32_bf16 v[216:219], v[240:243], v[124:127], v[216:219]
    ds_write_b128 v14, v[176:179] offset:1024
    v_mfma_f32_16x16x32_bf16 v[220:223], v[244:247], v[124:127], v[220:223]
    ds_write_b128 v14, v[180:183] offset:2048
    v_mfma_f32_16x16x32_bf16 v[224:227], v[248:251], v[124:127], v[224:227]
    ds_write_b128 v14, v[184:187] offset:3072
    v_mfma_f32_16x16x32_bf16 v[228:231], v[252:255], v[124:127], v[228:231]
    ds_write_b128 v14, v[188:191] offset:4096
    v_mfma_f32_16x16x32_bf16 v[152:155], v[236:239], v[112:115], v[152:155]
    ds_write_b128 v15, v[192:195] offset:0
    v_mfma_f32_16x16x32_bf16 v[156:159], v[240:243], v[112:115], v[156:159]
    ds_write_b128 v15, v[196:199] offset:1024
    v_mfma_f32_16x16x32_bf16 v[160:163], v[244:247], v[112:115], v[160:163]
    ds_write_b128 v15, v[200:203] offset:2048
    v_mfma_f32_16x16x32_bf16 v[164:167], v[248:251], v[112:115], v[164:167]
    ds_write_b128 v15, v[204:207] offset:3072
    v_mfma_f32_16x16x32_bf16 v[168:171], v[252:255], v[112:115], v[168:171]
    ds_write_b128 v15, v[208:211] offset:4096
    ds_write_b128 v16, v[212:215] offset:0
    ds_write_b128 v16, v[216:219] offset:1024
    ds_write_b128 v16, v[220:223] offset:2048
    ds_write_b128 v16, v[224:227] offset:3072
    ds_write_b128 v16, v[228:231] offset:4096
g2_join_66:
    s_waitcnt lgkmcnt(0)
    s_barrier
    ds_read_b128 v[172:175], v17 offset:0
    ds_read_b128 v[192:195], v17 offset:5120
    ds_read_b128 v[212:215], v17 offset:10240
    ds_read_b128 v[176:179], v17 offset:1024
    ds_read_b128 v[196:199], v17 offset:6144
    ds_read_b128 v[216:219], v17 offset:11264
    ds_read_b128 v[180:183], v17 offset:2048
    ds_read_b128 v[200:203], v17 offset:7168
    ds_read_b128 v[220:223], v17 offset:12288
    ds_read_b128 v[184:187], v17 offset:3072
    ds_read_b128 v[204:207], v17 offset:8192
    ds_read_b128 v[224:227], v17 offset:13312
    ds_read_b128 v[188:191], v17 offset:4096
    ds_read_b128 v[208:211], v17 offset:9216
    ds_read_b128 v[228:231], v17 offset:14336
    s_waitcnt lgkmcnt(12)
    v_pk_add_f32 v[152:153], v[152:153], v[172:173]
    v_pk_add_f32 v[192:193], v[192:193], v[212:213]
    v_pk_add_f32 v[154:155], v[154:155], v[174:175]
    v_pk_add_f32 v[194:195], v[194:195], v[214:215]
    v_pk_add_f32 v[152:153], v[152:153], v[192:193]
    v_pk_add_f32 v[154:155], v[154:155], v[194:195]
    v_pk_fma_f32 v[152:153], v[152:153], v[40:41], v[20:21]
    v_pk_fma_f32 v[154:155], v[154:155], v[42:43], v[22:23]
    v_cvt_pk_bf16_f32 v152, v152, v153
    v_cvt_pk_bf16_f32 v153, v154, v155
    ds_write_b64 v5, v[152:153] offset:0
    s_waitcnt lgkmcnt(10)
    v_pk_add_f32 v[156:157], v[156:157], v[176:177]
    v_pk_add_f32 v[196:197], v[196:197], v[216:217]
    v_pk_add_f32 v[158:159], v[158:159], v[178:179]
    v_pk_add_f32 v[198:199], v[198:199], v[218:219]
    v_pk_add_f32 v[156:157], v[156:157], v[196:197]
    v_pk_add_f32 v[158:159], v[158:159], v[198:199]
    v_pk_fma_f32 v[156:157], v[156:157], v[44:45], v[24:25]
    v_pk_fma_f32 v[158:159], v[158:159], v[46:47], v[26:27]
    v_cvt_pk_bf16_f32 v156, v156, v157
    v_cvt_pk_bf16_f32 v157, v158, v159
    ds_write_b64 v5, v[156:157] offset:32
    s_waitcnt lgkmcnt(8)
    v_pk_add_f32 v[160:161], v[160:161], v[180:181]
    v_pk_add_f32 v[200:201], v[200:201], v[220:221]
    v_pk_add_f32 v[162:163], v[162:163], v[182:183]
    v_pk_add_f32 v[202:203], v[202:203], v[222:223]
    v_pk_add_f32 v[160:161], v[160:161], v[200:201]
    v_pk_add_f32 v[162:163], v[162:163], v[202:203]
    v_pk_fma_f32 v[160:161], v[160:161], v[48:49], v[28:29]
    v_pk_fma_f32 v[162:163], v[162:163], v[50:51], v[30:31]
    v_cvt_pk_bf16_f32 v160, v160, v161
    v_cvt_pk_bf16_f32 v161, v162, v163
    ds_write_b64 v5, v[160:161] offset:64
    s_waitcnt lgkmcnt(6)
    v_pk_add_f32 v[164:165], v[164:165], v[184:185]
    v_pk_add_f32 v[204:205], v[204:205], v[224:225]
    v_pk_add_f32 v[166:167], v[166:167], v[186:187]
    v_pk_add_f32 v[206:207], v[206:207], v[226:227]
    v_pk_add_f32 v[164:165], v[164:165], v[204:205]
    v_pk_add_f32 v[166:167], v[166:167], v[206:207]
    v_pk_fma_f32 v[164:165], v[164:165], v[52:53], v[32:33]
    v_pk_fma_f32 v[166:167], v[166:167], v[54:55], v[34:35]
    v_cvt_pk_bf16_f32 v164, v164, v165
    v_cvt_pk_bf16_f32 v165, v166, v167
    ds_write_b64 v5, v[164:165] offset:96
    s_waitcnt lgkmcnt(4)
    v_pk_add_f32 v[168:169], v[168:169], v[188:189]
    v_pk_add_f32 v[208:209], v[208:209], v[228:229]
    v_pk_add_f32 v[170:171], v[170:171], v[190:191]
    v_pk_add_f32 v[210:211], v[210:211], v[230:231]
    v_pk_add_f32 v[168:169], v[168:169], v[208:209]
    v_pk_add_f32 v[170:171], v[170:171], v[210:211]
    v_pk_fma_f32 v[168:169], v[168:169], v[56:57], v[36:37]
    v_pk_fma_f32 v[170:171], v[170:171], v[58:59], v[38:39]
    v_cvt_pk_bf16_f32 v168, v168, v169
    v_cvt_pk_bf16_f32 v169, v170, v171
    ds_write_b64 v5, v[168:169] offset:128
    ds_read_b128 v[100:103], v148
    ds_read_b128 v[104:107], v149
    ds_read_b128 v[108:111], v150
    s_waitcnt lgkmcnt(2)
    global_store_dwordx4 v151, v[100:103], s[30:31]
    s_waitcnt lgkmcnt(1)
    global_store_dwordx4 v1, v[104:107], s[30:31]
    s_waitcnt lgkmcnt(0)
    s_mov_b32 exec_hi, 0
    global_store_dwordx4 v4, v[108:111], s[30:31]
end_1:
    s_endpgm
g2_skip_65:
    ds_write_b128 v14, v[172:175] offset:0
    ds_write_b128 v14, v[176:179] offset:1024
    ds_write_b128 v14, v[180:183] offset:2048
    ds_write_b128 v14, v[184:187] offset:3072
    ds_write_b128 v14, v[188:191] offset:4096
    ds_write_b128 v15, v[192:195] offset:0
    ds_write_b128 v15, v[196:199] offset:1024
    ds_write_b128 v15, v[200:203] offset:2048
    ds_write_b128 v15, v[204:207] offset:3072
    ds_write_b128 v15, v[208:211] offset:4096
    ds_write_b128 v16, v[212:215] offset:0
    ds_write_b128 v16, v[216:219] offset:1024
    ds_write_b128 v16, v[220:223] offset:2048
    ds_write_b128 v16, v[224:227] offset:3072
    ds_write_b128 v16, v[228:231] offset:4096
    s_branch g2_join_66
code_end:
.section .rodata,"a"
.p2align 6
.amdhsa_kernel adaLN_cond__ssm_conv_h3__glu_gated_reglu__prompt_kernel
  .amdhsa_next_free_vgpr 512
  .amdhsa_next_free_sgpr 102
  .amdhsa_accum_offset 256
  .amdhsa_group_segment_fixed_size 0
  .amdhsa_kernarg_size 120
  .amdhsa_user_sgpr_count 2
  .amdhsa_user_sgpr_kernarg_segment_ptr 1
  .amdhsa_system_sgpr_workgroup_id_x 1
.end_amdhsa_kernel
```
